```python
import torch

def _softmax(x, axis=-1):
    return torch.softmax(x, dim=axis)
def _gelu(x):
    return torch.nn.functional.gelu(x, approximate="tanh")
def _silu(x):
    return torch.nn.functional.silu(x)
def _sigmoid(x):
    return torch.sigmoid(x)
def _layernorm(x, axis=-1, eps=1e-5):
    m = x.mean(dim=axis, keepdim=True)
    v = x.var(dim=axis, keepdim=True, unbiased=False)
    return (x - m) / torch.sqrt(v + eps)
def _scatter_add(tgt, idx, src, axis=0):
    return tgt.clone().index_add_(axis, idx, src)
def _segment_sum(src, seg, n):
    out = torch.zeros((n,) + src.shape[1:], dtype=src.dtype)
    return out.index_add_(0, seg, src)
def _pad(x, pw):
    flat = tuple(v for pair in reversed(pw) for v in pair)
    return torch.nn.functional.pad(x, flat)

kernel_name = 'concat_heads__mha_block_cached__gqa_block_cached__near_ridge'

def setup_inputs():

    _w = (lambda a: (lambda t: t.to(torch.bfloat16) if t.is_floating_point() else t)(torch.as_tensor(a)))
    def _A_setup():
        B, Sq, D = 8, 192, 512
        H, Sk, Dh = 32, 1024, 128
        return {
            "x": _w((lambda *s: torch.randn(*s, dtype=torch.bfloat16) * 0.8)(B, Sq, D)),
            "k_cache": _w((lambda *s: torch.randn(*s, dtype=torch.bfloat16) * 0.8)(B, H, Sk, Dh)),
            "v_cache": _w((lambda *s: torch.randn(*s, dtype=torch.bfloat16) * 0.05)(B, H, Sk, Dh)),
            "wq": _w((lambda *s: torch.randn(*s, dtype=torch.bfloat16) * 0.8)(D, H * Dh) * (D ** -0.5)),
            "wo": _w((lambda *s: torch.randn(*s, dtype=torch.bfloat16) * 0.05)(H * Dh, D) * ((H * Dh) ** -0.5)),
        }
    _A_in = _A_setup()

    def _B_setup():
        B, Sq, D = 8, 192, 512
        Hq, Hkv, Sk, Dh = 32, 32, 1024, 128
        assert Hq % Hkv == 0, (Hq, Hkv)
        return {
            "x": _w((lambda *s: torch.randn(*s, dtype=torch.bfloat16) * 0.8)(B, Sq, D)),
            "k_cache": _w((lambda *s: torch.randn(*s, dtype=torch.bfloat16) * 0.8)(B, Hkv, Sk, Dh)),
            "v_cache": _w((lambda *s: torch.randn(*s, dtype=torch.bfloat16) * 0.05)(B, Hkv, Sk, Dh)),
            "wq": _w((lambda *s: torch.randn(*s, dtype=torch.bfloat16) * 0.8)(D, Hq * Dh) * (D ** -0.5)),
            "wo": _w((lambda *s: torch.randn(*s, dtype=torch.bfloat16) * 0.05)(Hq * Dh, D) * ((Hq * Dh) ** -0.5)),
        }
    _B_in = _B_setup()

    return {
        "A_x": _A_in["x"],
        "A_k_cache": _A_in["k_cache"],
        "A_v_cache": _A_in["v_cache"],
        "A_wq": _A_in["wq"],
        "A_wo": _A_in["wo"],
        "B_x": _B_in["x"],
        "B_k_cache": _B_in["k_cache"],
        "B_v_cache": _B_in["v_cache"],
        "B_wq": _B_in["wq"],
        "B_wo": _B_in["wo"],
    }

def reference(A_x, A_k_cache, A_v_cache, A_wq, A_wo, B_x, B_k_cache, B_v_cache, B_wq, B_wo):
    def _A_ref(x, k_cache, v_cache, wq, wo):
        B, Sq, D = x.shape
        H, Dh = 32, 128
        q = (lambda x, *d: x.permute(*d))((x @ wq).reshape(B, Sq, H, Dh), 0, 2, 1, 3)
        scores = torch.einsum("bhqd,bhkd->bhqk", q, k_cache) * (Dh ** -0.5)
        p = _softmax(scores, axis=-1)
        o = torch.einsum("bhqk,bhkd->bhqd", p, v_cache)
        return (lambda x, *d: x.permute(*d))(o, 0, 2, 1, 3).reshape(B, Sq, H * Dh) @ wo

    def _B_ref(x, k_cache, v_cache, wq, wo):
        B, Sq, D = x.shape
        Hq, Dh = 32, 128
        Hkv = k_cache.shape[1]
        rep = Hq // Hkv
        q = (lambda x, *d: x.permute(*d))((x @ wq).reshape(B, Sq, Hq, Dh), 0, 2, 1, 3)
        k = (lambda x, n, axis: torch.repeat_interleave(x, n, dim=axis))(k_cache, rep, axis=1)
        v = (lambda x, n, axis: torch.repeat_interleave(x, n, dim=axis))(v_cache, rep, axis=1)
        scores = torch.einsum("bhqd,bhkd->bhqk", q, k) * (Dh ** -0.5)
        p = _softmax(scores, axis=-1)
        o = torch.einsum("bhqk,bhkd->bhqd", p, v)
        return (lambda x, *d: x.permute(*d))(o, 0, 2, 1, 3).reshape(B, Sq, Hq * Dh) @ wo

    a = _A_ref(A_x, A_k_cache, A_v_cache, A_wq, A_wo)
    b = _B_ref(B_x, B_k_cache, B_v_cache, B_wq, B_wo)
    return torch.concatenate([a, b], axis=-1)
```

```asm
; @launch kernel=concat_heads__mha_block_cached__gqa_block_cached__near_ridge_kernel grid=(512,1,1) block=(256,1,1) lds=65536
; @launch kernel=oproj_kernel grid=(256,1,1) block=(256,1,1) lds=131072
; @launch kernel=reduce_kernel grid=(768,1,1) block=(256,1,1) lds=0
.amdgcn_target "amdgcn-amd-amdhsa--gfx950"
.text
.globl concat_heads__mha_block_cached__gqa_block_cached__near_ridge_kernel
.p2align 8
.type concat_heads__mha_block_cached__gqa_block_cached__near_ridge_kernel,@function
concat_heads__mha_block_cached__gqa_block_cached__near_ridge_kernel:
    s_cmp_ge_u32 s2, 512
    s_cbranch_scc1 L_attn_done
    s_lshr_b32 s3, s2, 8
    s_and_b32 s4, s2, 255
    s_lshr_b32 s5, s4, 5
    s_and_b32 s6, s4, 31
    s_mul_i32 s7, s3, 40
    s_add_u32 s42, s0, s7
    s_addc_u32 s43, s1, 0
    s_load_dwordx2 s[44:45], s[42:43], 0
    s_load_dwordx2 s[46:47], s[42:43], 8
    s_load_dwordx2 s[48:49], s[42:43], 16
    s_load_dwordx2 s[50:51], s[42:43], 24
    s_load_dwordx2 s[52:53], s[0:1], 96
    v_lshrrev_b32 v3, 6, v0
    v_and_b32 v0, 63, v0
    s_nop 0
    v_readfirstlane_b32 s28, v3
    v_and_b32 v249, 15, v0
    v_lshrrev_b32 v250, 4, v0
    s_waitcnt lgkmcnt(0)
    s_mul_i32 s7, s5, 196608
    s_add_u32 s8, s44, s7
    s_addc_u32 s9, s45, 0
    s_and_b32 s9, s9, 0xffff
    s_mov_b32 s10, 196608
    s_mov_b32 s11, 0x00020000
    s_lshl_b32 s7, s6, 8
    s_add_u32 s12, s50, s7
    s_addc_u32 s13, s51, 0
    s_and_b32 s13, s13, 0xffff
    s_sub_u32 s14, 4194304, s7
    s_mov_b32 s15, 0x00020000
    s_lshl_b32 s7, s4, 18
    s_add_u32 s16, s46, s7
    s_addc_u32 s17, s47, 0
    s_and_b32 s17, s17, 0xffff
    s_mov_b32 s18, 262144
    s_mov_b32 s19, 0x00020000
    s_add_u32 s20, s48, s7
    s_addc_u32 s21, s49, 0
    s_and_b32 s21, s21, 0xffff
    s_mov_b32 s22, 262144
    s_mov_b32 s23, 0x00020000
    s_mul_i32 s7, s3, 12582912
    s_mul_i32 s41, s5, 1572864
    s_add_u32 s7, s7, s41
    s_lshl_b32 s41, s6, 8
    s_add_u32 s7, s7, s41
    s_add_u32 s24, s52, s7
    s_addc_u32 s25, s53, 0
    s_and_b32 s25, s25, 0xffff
    s_sub_u32 s26, 1572864, s41
    s_mov_b32 s27, 0x00020000
    s_mov_b32 s29, 0x3e0293ee
    s_mov_b32 s30, 0x41000000
    s_lshl_b32 s38, s28, 10
    v_lshlrev_b32 v251, 8, v249
    v_add_u32 v252, 0, v250
    v_xor_b32 v252, v252, v249
    v_lshlrev_b32 v252, 4, v252
    v_add_u32 v228, v251, v252
    v_add_u32 v252, 4, v250
    v_xor_b32 v252, v252, v249
    v_lshlrev_b32 v252, 4, v252
    v_add_u32 v229, v251, v252
    v_add_u32 v252, 8, v250
    v_xor_b32 v252, v252, v249
    v_lshlrev_b32 v252, 4, v252
    v_add_u32 v230, v251, v252
    v_add_u32 v252, 12, v250
    v_xor_b32 v252, v252, v249
    v_lshlrev_b32 v252, 4, v252
    v_add_u32 v231, v251, v252
    v_lshrrev_b32 v251, 2, v249
    v_lshlrev_b32 v252, 2, v250
    v_add_u32 v252, v252, v251
    v_lshlrev_b32 v252, 8, v252
    v_and_b32 v253, 1, v249
    v_lshlrev_b32 v253, 3, v253
    v_add_u32 v252, v252, v253
    v_and_b32 v253, 1, v250
    v_lshlrev_b32 v253, 3, v253
    v_lshlrev_b32 v251, 1, v251
    v_add_u32 v253, v253, v251
    v_bfe_u32 v251, v249, 1, 1
    v_xor_b32 v253, v253, v251
    v_lshlrev_b32 v253, 4, v253
    v_add_u32 v232, v252, v253
    v_xor_b32 v233, 32, v232
    v_xor_b32 v234, 64, v232
    v_xor_b32 v235, 96, v232
    v_xor_b32 v236, 128, v232
    v_xor_b32 v237, 160, v232
    v_xor_b32 v238, 192, v232
    v_xor_b32 v239, 224, v232
    s_lshl_b32 s7, s28, 2
    v_add_u32 v251, s7, v250
    v_xor_b32 v252, v251, v249
    v_lshlrev_b32 v252, 4, v252
    v_lshlrev_b32 v253, 8, v251
    v_add_u32 v240, v253, v252
    v_and_b32 v252, 7, v251
    v_lshlrev_b32 v252, 1, v252
    v_xor_b32 v252, v252, v249
    v_lshlrev_b32 v252, 4, v252
    v_add_u32 v241, v253, v252
    s_lshl_b32 s7, s28, 3
    v_add_u32 v253, s7, v250
    v_lshlrev_b32 v253, 13, v253
    v_add_u32 v242, v253, v252
    s_mul_i32 s7, s28, 48
    v_add_u32 v251, s7, v249
    v_lshlrev_b32 v252, 10, v251
    v_lshlrev_b32 v253, 4, v250
    v_add_u32 v1, v252, v253
    v_lshlrev_b32 v252, 13, v251
    v_lshlrev_b32 v253, 3, v250
    v_add_u32 v2, v252, v253
    v_lshrrev_b32 v251, 1, v250
    v_xor_b32 v251, v251, v249
    v_lshlrev_b32 v251, 4, v251
    v_lshlrev_b32 v252, 8, v249
    v_add_u32 v251, v251, v252
    v_and_b32 v252, 1, v250
    v_lshlrev_b32 v252, 3, v252
    v_add_u32 v3, v251, v252
    v_mov_b32 v52, 0
    v_mov_b32 v53, 0
    v_mov_b32 v54, 0
    v_mov_b32 v55, 0
    v_mov_b32 v56, 0
    v_mov_b32 v57, 0
    v_mov_b32 v58, 0
    v_mov_b32 v59, 0
    v_mov_b32 v60, 0
    v_mov_b32 v61, 0
    v_mov_b32 v62, 0
    v_mov_b32 v63, 0
    v_mov_b32 v64, 0
    v_mov_b32 v65, 0
    v_mov_b32 v66, 0
    v_mov_b32 v67, 0
    v_mov_b32 v68, 0
    v_mov_b32 v69, 0
    v_mov_b32 v70, 0
    v_mov_b32 v71, 0
    v_mov_b32 v72, 0
    v_mov_b32 v73, 0
    v_mov_b32 v74, 0
    v_mov_b32 v75, 0
    v_mov_b32 v76, 0
    v_mov_b32 v77, 0
    v_mov_b32 v78, 0
    v_mov_b32 v79, 0
    v_mov_b32 v80, 0
    v_mov_b32 v81, 0
    v_mov_b32 v82, 0
    v_mov_b32 v83, 0
    v_mov_b32 v84, 0
    v_mov_b32 v85, 0
    v_mov_b32 v86, 0
    v_mov_b32 v87, 0
    v_mov_b32 v88, 0
    v_mov_b32 v89, 0
    v_mov_b32 v90, 0
    v_mov_b32 v91, 0
    v_mov_b32 v92, 0
    v_mov_b32 v93, 0
    v_mov_b32 v94, 0
    v_mov_b32 v95, 0
    v_mov_b32 v96, 0
    v_mov_b32 v97, 0
    v_mov_b32 v98, 0
    v_mov_b32 v99, 0
    v_mov_b32 v100, 0
    v_mov_b32 v101, 0
    v_mov_b32 v102, 0
    v_mov_b32 v103, 0
    v_mov_b32 v104, 0
    v_mov_b32 v105, 0
    v_mov_b32 v106, 0
    v_mov_b32 v107, 0
    v_mov_b32 v108, 0
    v_mov_b32 v109, 0
    v_mov_b32 v110, 0
    v_mov_b32 v111, 0
    v_mov_b32 v112, 0
    v_mov_b32 v113, 0
    v_mov_b32 v114, 0
    v_mov_b32 v115, 0
    v_mov_b32 v116, 0
    v_mov_b32 v117, 0
    v_mov_b32 v118, 0
    v_mov_b32 v119, 0
    v_mov_b32 v120, 0
    v_mov_b32 v121, 0
    v_mov_b32 v122, 0
    v_mov_b32 v123, 0
    v_mov_b32 v124, 0
    v_mov_b32 v125, 0
    v_mov_b32 v126, 0
    v_mov_b32 v127, 0
    v_mov_b32 v128, 0
    v_mov_b32 v129, 0
    v_mov_b32 v130, 0
    v_mov_b32 v131, 0
    v_mov_b32 v132, 0
    v_mov_b32 v133, 0
    v_mov_b32 v134, 0
    v_mov_b32 v135, 0
    v_mov_b32 v136, 0
    v_mov_b32 v137, 0
    v_mov_b32 v138, 0
    v_mov_b32 v139, 0
    v_mov_b32 v140, 0
    v_mov_b32 v141, 0
    v_mov_b32 v142, 0
    v_mov_b32 v143, 0
    v_mov_b32 v144, 0
    v_mov_b32 v145, 0
    v_mov_b32 v146, 0
    v_mov_b32 v147, 0
    v_mov_b32 v243, 0xff800000
    v_mov_b32 v246, 0
    v_mov_b32 v244, 0xff800000
    v_mov_b32 v247, 0
    v_mov_b32 v245, 0xff800000
    v_mov_b32 v248, 0
    s_mov_b32 s32, 0
    s_mov_b32 s33, 0
    s_mov_b32 s40, 0
    s_mov_b32 s35, 0
    s_mov_b32 s36, 16384
    s_mov_b32 s37, 32768
    s_add_u32 m0, s38, 0
    s_add_u32 s31, s40, 0
    buffer_load_dwordx4 v242, s[12:15], s31 offen lds
    s_add_u32 m0, s38, 4096
    s_add_u32 s31, s40, 32768
    buffer_load_dwordx4 v242, s[12:15], s31 offen lds
    s_add_u32 m0, s38, 8192
    s_add_u32 s31, s40, 262144
    buffer_load_dwordx4 v242, s[12:15], s31 offen lds
    s_add_u32 m0, s38, 12288
    s_add_u32 s31, s40, 294912
    buffer_load_dwordx4 v242, s[12:15], s31 offen lds
    s_add_u32 s40, s40, 524288
    buffer_load_dwordx4 v[148:151], v1, s[8:11], s35 offen offset:0
    buffer_load_dwordx4 v[152:155], v1, s[8:11], s35 offen offset:64
    buffer_load_dwordx4 v[156:159], v1, s[8:11], s36 offen offset:0
    buffer_load_dwordx4 v[160:163], v1, s[8:11], s36 offen offset:64
    buffer_load_dwordx4 v[164:167], v1, s[8:11], s37 offen offset:0
    buffer_load_dwordx4 v[168:171], v1, s[8:11], s37 offen offset:64
    s_add_u32 s35, s35, 128
    s_add_u32 s36, s36, 128
    s_add_u32 s37, s37, 128
    s_add_u32 m0, s38, 16384
    s_add_u32 s31, s40, 0
    buffer_load_dwordx4 v242, s[12:15], s31 offen lds
    s_add_u32 m0, s38, 20480
    s_add_u32 s31, s40, 32768
    buffer_load_dwordx4 v242, s[12:15], s31 offen lds
    s_add_u32 m0, s38, 24576
    s_add_u32 s31, s40, 262144
    buffer_load_dwordx4 v242, s[12:15], s31 offen lds
    s_add_u32 m0, s38, 28672
    s_add_u32 s31, s40, 294912
    buffer_load_dwordx4 v242, s[12:15], s31 offen lds
    s_add_u32 s40, s40, 524288
    buffer_load_dwordx4 v[172:175], v1, s[8:11], s35 offen offset:0
    buffer_load_dwordx4 v[176:179], v1, s[8:11], s35 offen offset:64
    buffer_load_dwordx4 v[180:183], v1, s[8:11], s36 offen offset:0
    buffer_load_dwordx4 v[184:187], v1, s[8:11], s36 offen offset:64
    buffer_load_dwordx4 v[188:191], v1, s[8:11], s37 offen offset:0
    buffer_load_dwordx4 v[192:195], v1, s[8:11], s37 offen offset:64
    s_add_u32 s35, s35, 128
    s_add_u32 s36, s36, 128
    s_add_u32 s37, s37, 128
    s_add_u32 m0, s38, 32768
    s_add_u32 s31, s40, 0
    buffer_load_dwordx4 v242, s[12:15], s31 offen lds
    s_add_u32 m0, s38, 36864
    s_add_u32 s31, s40, 32768
    buffer_load_dwordx4 v242, s[12:15], s31 offen lds
    s_add_u32 m0, s38, 40960
    s_add_u32 s31, s40, 262144
    buffer_load_dwordx4 v242, s[12:15], s31 offen lds
    s_add_u32 m0, s38, 45056
    s_add_u32 s31, s40, 294912
    buffer_load_dwordx4 v242, s[12:15], s31 offen lds
    s_add_u32 s40, s40, 524288
    buffer_load_dwordx4 v[4:7], v1, s[8:11], s35 offen offset:0
    buffer_load_dwordx4 v[8:11], v1, s[8:11], s35 offen offset:64
    buffer_load_dwordx4 v[12:15], v1, s[8:11], s36 offen offset:0
    buffer_load_dwordx4 v[16:19], v1, s[8:11], s36 offen offset:64
    buffer_load_dwordx4 v[20:23], v1, s[8:11], s37 offen offset:0
    buffer_load_dwordx4 v[24:27], v1, s[8:11], s37 offen offset:64
    s_add_u32 s35, s35, 128
    s_add_u32 s36, s36, 128
    s_add_u32 s37, s37, 128
    s_waitcnt vmcnt(20)
    s_barrier
    buffer_load_dwordx4 v[28:31], v1, s[8:11], s35 offen offset:0
    buffer_load_dwordx4 v[32:35], v1, s[8:11], s35 offen offset:64
    buffer_load_dwordx4 v[36:39], v1, s[8:11], s36 offen offset:0
    buffer_load_dwordx4 v[40:43], v1, s[8:11], s36 offen offset:64
    buffer_load_dwordx4 v[44:47], v1, s[8:11], s37 offen offset:0
    buffer_load_dwordx4 v[48:51], v1, s[8:11], s37 offen offset:64
    s_add_u32 s35, s35, 128
    s_add_u32 s36, s36, 128
    s_add_u32 s37, s37, 128
    s_add_u32 m0, s38, 49152
    s_add_u32 s31, s40, 0
    buffer_load_dwordx4 v242, s[12:15], s31 offen lds
    s_add_u32 m0, s38, 53248
    s_add_u32 s31, s40, 32768
    buffer_load_dwordx4 v242, s[12:15], s31 offen lds
    s_add_u32 m0, s38, 57344
    s_add_u32 s31, s40, 262144
    buffer_load_dwordx4 v242, s[12:15], s31 offen lds
    s_add_u32 m0, s38, 61440
    s_add_u32 s31, s40, 294912
    buffer_load_dwordx4 v242, s[12:15], s31 offen lds
    s_add_u32 s40, s40, 524288
    ds_read_b64_tr_b16 v[196:197], v232 offset:0
    ds_read_b64_tr_b16 v[198:199], v232 offset:4096
    ds_read_b64_tr_b16 v[200:201], v232 offset:8192
    ds_read_b64_tr_b16 v[202:203], v232 offset:12288
    ds_read_b64_tr_b16 v[204:205], v233 offset:0
    ds_read_b64_tr_b16 v[206:207], v233 offset:4096
    ds_read_b64_tr_b16 v[208:209], v233 offset:8192
    ds_read_b64_tr_b16 v[210:211], v233 offset:12288
    ds_read_b64_tr_b16 v[212:213], v234 offset:0
    ds_read_b64_tr_b16 v[214:215], v234 offset:4096
    s_waitcnt lgkmcnt(8)
    v_mfma_f32_16x16x32_bf16 v[52:55], v[196:199], v[148:151], v[52:55]
    v_mfma_f32_16x16x32_bf16 v[84:87], v[196:199], v[156:159], v[84:87]
    v_mfma_f32_16x16x32_bf16 v[116:119], v[196:199], v[164:167], v[116:119]
    ds_read_b64_tr_b16 v[216:217], v234 offset:8192
    ds_read_b64_tr_b16 v[218:219], v234 offset:12288
    s_waitcnt lgkmcnt(8)
    v_mfma_f32_16x16x32_bf16 v[52:55], v[200:203], v[152:155], v[52:55]
    v_mfma_f32_16x16x32_bf16 v[84:87], v[200:203], v[160:163], v[84:87]
    v_mfma_f32_16x16x32_bf16 v[116:119], v[200:203], v[168:171], v[116:119]
    ds_read_b64_tr_b16 v[220:221], v235 offset:0
    ds_read_b64_tr_b16 v[222:223], v235 offset:4096
    s_waitcnt lgkmcnt(8)
    v_mfma_f32_16x16x32_bf16 v[56:59], v[204:207], v[148:151], v[56:59]
    v_mfma_f32_16x16x32_bf16 v[88:91], v[204:207], v[156:159], v[88:91]
    v_mfma_f32_16x16x32_bf16 v[120:123], v[204:207], v[164:167], v[120:123]
    ds_read_b64_tr_b16 v[224:225], v235 offset:8192
    ds_read_b64_tr_b16 v[226:227], v235 offset:12288
    s_waitcnt lgkmcnt(8)
    v_mfma_f32_16x16x32_bf16 v[56:59], v[208:211], v[152:155], v[56:59]
    v_mfma_f32_16x16x32_bf16 v[88:91], v[208:211], v[160:163], v[88:91]
    v_mfma_f32_16x16x32_bf16 v[120:123], v[208:211], v[168:171], v[120:123]
    ds_read_b64_tr_b16 v[196:197], v236 offset:0
    ds_read_b64_tr_b16 v[198:199], v236 offset:4096
    s_waitcnt lgkmcnt(8)
    v_mfma_f32_16x16x32_bf16 v[60:63], v[212:215], v[148:151], v[60:63]
    v_mfma_f32_16x16x32_bf16 v[92:95], v[212:215], v[156:159], v[92:95]
    v_mfma_f32_16x16x32_bf16 v[124:127], v[212:215], v[164:167], v[124:127]
    ds_read_b64_tr_b16 v[200:201], v236 offset:8192
    ds_read_b64_tr_b16 v[202:203], v236 offset:12288
    s_waitcnt lgkmcnt(8)
    v_mfma_f32_16x16x32_bf16 v[60:63], v[216:219], v[152:155], v[60:63]
    v_mfma_f32_16x16x32_bf16 v[92:95], v[216:219], v[160:163], v[92:95]
    v_mfma_f32_16x16x32_bf16 v[124:127], v[216:219], v[168:171], v[124:127]
    ds_read_b64_tr_b16 v[204:205], v237 offset:0
    ds_read_b64_tr_b16 v[206:207], v237 offset:4096
    s_waitcnt lgkmcnt(8)
    v_mfma_f32_16x16x32_bf16 v[64:67], v[220:223], v[148:151], v[64:67]
    v_mfma_f32_16x16x32_bf16 v[96:99], v[220:223], v[156:159], v[96:99]
    v_mfma_f32_16x16x32_bf16 v[128:131], v[220:223], v[164:167], v[128:131]
    ds_read_b64_tr_b16 v[208:209], v237 offset:8192
    ds_read_b64_tr_b16 v[210:211], v237 offset:12288
    s_waitcnt lgkmcnt(8)
    v_mfma_f32_16x16x32_bf16 v[64:67], v[224:227], v[152:155], v[64:67]
    v_mfma_f32_16x16x32_bf16 v[96:99], v[224:227], v[160:163], v[96:99]
    v_mfma_f32_16x16x32_bf16 v[128:131], v[224:227], v[168:171], v[128:131]
    ds_read_b64_tr_b16 v[212:213], v238 offset:0
    ds_read_b64_tr_b16 v[214:215], v238 offset:4096
    s_waitcnt lgkmcnt(8)
    v_mfma_f32_16x16x32_bf16 v[68:71], v[196:199], v[148:151], v[68:71]
    v_mfma_f32_16x16x32_bf16 v[100:103], v[196:199], v[156:159], v[100:103]
    v_mfma_f32_16x16x32_bf16 v[132:135], v[196:199], v[164:167], v[132:135]
    ds_read_b64_tr_b16 v[216:217], v238 offset:8192
    ds_read_b64_tr_b16 v[218:219], v238 offset:12288
    s_waitcnt lgkmcnt(8)
    v_mfma_f32_16x16x32_bf16 v[68:71], v[200:203], v[152:155], v[68:71]
    v_mfma_f32_16x16x32_bf16 v[100:103], v[200:203], v[160:163], v[100:103]
    v_mfma_f32_16x16x32_bf16 v[132:135], v[200:203], v[168:171], v[132:135]
    ds_read_b64_tr_b16 v[220:221], v239 offset:0
    ds_read_b64_tr_b16 v[222:223], v239 offset:4096
    s_waitcnt lgkmcnt(8)
    v_mfma_f32_16x16x32_bf16 v[72:75], v[204:207], v[148:151], v[72:75]
    v_mfma_f32_16x16x32_bf16 v[104:107], v[204:207], v[156:159], v[104:107]
    v_mfma_f32_16x16x32_bf16 v[136:139], v[204:207], v[164:167], v[136:139]
    ds_read_b64_tr_b16 v[224:225], v239 offset:8192
    ds_read_b64_tr_b16 v[226:227], v239 offset:12288
    s_waitcnt lgkmcnt(8)
    v_mfma_f32_16x16x32_bf16 v[72:75], v[208:211], v[152:155], v[72:75]
    v_mfma_f32_16x16x32_bf16 v[104:107], v[208:211], v[160:163], v[104:107]
    v_mfma_f32_16x16x32_bf16 v[136:139], v[208:211], v[168:171], v[136:139]
    s_waitcnt lgkmcnt(6)
    v_mfma_f32_16x16x32_bf16 v[76:79], v[212:215], v[148:151], v[76:79]
    v_mfma_f32_16x16x32_bf16 v[108:111], v[212:215], v[156:159], v[108:111]
    v_mfma_f32_16x16x32_bf16 v[140:143], v[212:215], v[164:167], v[140:143]
    s_waitcnt lgkmcnt(4)
    v_mfma_f32_16x16x32_bf16 v[76:79], v[216:219], v[152:155], v[76:79]
    v_mfma_f32_16x16x32_bf16 v[108:111], v[216:219], v[160:163], v[108:111]
    v_mfma_f32_16x16x32_bf16 v[140:143], v[216:219], v[168:171], v[140:143]
    s_waitcnt lgkmcnt(2)
    v_mfma_f32_16x16x32_bf16 v[80:83], v[220:223], v[148:151], v[80:83]
    v_mfma_f32_16x16x32_bf16 v[112:115], v[220:223], v[156:159], v[112:115]
    v_mfma_f32_16x16x32_bf16 v[144:147], v[220:223], v[164:167], v[144:147]
    s_waitcnt lgkmcnt(0)
    v_mfma_f32_16x16x32_bf16 v[80:83], v[224:227], v[152:155], v[80:83]
    v_mfma_f32_16x16x32_bf16 v[112:115], v[224:227], v[160:163], v[112:115]
    v_mfma_f32_16x16x32_bf16 v[144:147], v[224:227], v[168:171], v[144:147]
    s_waitcnt vmcnt(20)
    s_barrier
    buffer_load_dwordx4 v[148:151], v1, s[8:11], s35 offen offset:0
    buffer_load_dwordx4 v[152:155], v1, s[8:11], s35 offen offset:64
    buffer_load_dwordx4 v[156:159], v1, s[8:11], s36 offen offset:0
    buffer_load_dwordx4 v[160:163], v1, s[8:11], s36 offen offset:64
    buffer_load_dwordx4 v[164:167], v1, s[8:11], s37 offen offset:0
    buffer_load_dwordx4 v[168:171], v1, s[8:11], s37 offen offset:64
    s_add_u32 s35, s35, 128
    s_add_u32 s36, s36, 128
    s_add_u32 s37, s37, 128
    s_add_u32 m0, s38, 0
    s_add_u32 s31, s40, 0
    buffer_load_dwordx4 v242, s[12:15], s31 offen lds
    s_add_u32 m0, s38, 4096
    s_add_u32 s31, s40, 32768
    buffer_load_dwordx4 v242, s[12:15], s31 offen lds
    s_add_u32 m0, s38, 8192
    s_add_u32 s31, s40, 262144
    buffer_load_dwordx4 v242, s[12:15], s31 offen lds
    s_add_u32 m0, s38, 12288
    s_add_u32 s31, s40, 294912
    buffer_load_dwordx4 v242, s[12:15], s31 offen lds
    s_add_u32 s40, s40, 524288
    ds_read_b64_tr_b16 v[196:197], v232 offset:16384
    ds_read_b64_tr_b16 v[198:199], v232 offset:20480
    ds_read_b64_tr_b16 v[200:201], v232 offset:24576
    ds_read_b64_tr_b16 v[202:203], v232 offset:28672
    ds_read_b64_tr_b16 v[204:205], v233 offset:16384
    ds_read_b64_tr_b16 v[206:207], v233 offset:20480
    ds_read_b64_tr_b16 v[208:209], v233 offset:24576
    ds_read_b64_tr_b16 v[210:211], v233 offset:28672
    ds_read_b64_tr_b16 v[212:213], v234 offset:16384
    ds_read_b64_tr_b16 v[214:215], v234 offset:20480
    s_waitcnt lgkmcnt(8)
    v_mfma_f32_16x16x32_bf16 v[52:55], v[196:199], v[172:175], v[52:55]
    v_mfma_f32_16x16x32_bf16 v[84:87], v[196:199], v[180:183], v[84:87]
    v_mfma_f32_16x16x32_bf16 v[116:119], v[196:199], v[188:191], v[116:119]
    ds_read_b64_tr_b16 v[216:217], v234 offset:24576
    ds_read_b64_tr_b16 v[218:219], v234 offset:28672
    s_waitcnt lgkmcnt(8)
    v_mfma_f32_16x16x32_bf16 v[52:55], v[200:203], v[176:179], v[52:55]
    v_mfma_f32_16x16x32_bf16 v[84:87], v[200:203], v[184:187], v[84:87]
    v_mfma_f32_16x16x32_bf16 v[116:119], v[200:203], v[192:195], v[116:119]
    ds_read_b64_tr_b16 v[220:221], v235 offset:16384
    ds_read_b64_tr_b16 v[222:223], v235 offset:20480
    s_waitcnt lgkmcnt(8)
    v_mfma_f32_16x16x32_bf16 v[56:59], v[204:207], v[172:175], v[56:59]
    v_mfma_f32_16x16x32_bf16 v[88:91], v[204:207], v[180:183], v[88:91]
    v_mfma_f32_16x16x32_bf16 v[120:123], v[204:207], v[188:191], v[120:123]
    ds_read_b64_tr_b16 v[224:225], v235 offset:24576
    ds_read_b64_tr_b16 v[226:227], v235 offset:28672
    s_waitcnt lgkmcnt(8)
    v_mfma_f32_16x16x32_bf16 v[56:59], v[208:211], v[176:179], v[56:59]
    v_mfma_f32_16x16x32_bf16 v[88:91], v[208:211], v[184:187], v[88:91]
    v_mfma_f32_16x16x32_bf16 v[120:123], v[208:211], v[192:195], v[120:123]
    ds_read_b64_tr_b16 v[196:197], v236 offset:16384
    ds_read_b64_tr_b16 v[198:199], v236 offset:20480
    s_waitcnt lgkmcnt(8)
    v_mfma_f32_16x16x32_bf16 v[60:63], v[212:215], v[172:175], v[60:63]
    v_mfma_f32_16x16x32_bf16 v[92:95], v[212:215], v[180:183], v[92:95]
    v_mfma_f32_16x16x32_bf16 v[124:127], v[212:215], v[188:191], v[124:127]
    ds_read_b64_tr_b16 v[200:201], v236 offset:24576
    ds_read_b64_tr_b16 v[202:203], v236 offset:28672
    s_waitcnt lgkmcnt(8)
    v_mfma_f32_16x16x32_bf16 v[60:63], v[216:219], v[176:179], v[60:63]
    v_mfma_f32_16x16x32_bf16 v[92:95], v[216:219], v[184:187], v[92:95]
    v_mfma_f32_16x16x32_bf16 v[124:127], v[216:219], v[192:195], v[124:127]
    ds_read_b64_tr_b16 v[204:205], v237 offset:16384
    ds_read_b64_tr_b16 v[206:207], v237 offset:20480
    s_waitcnt lgkmcnt(8)
    v_mfma_f32_16x16x32_bf16 v[64:67], v[220:223], v[172:175], v[64:67]
    v_mfma_f32_16x16x32_bf16 v[96:99], v[220:223], v[180:183], v[96:99]
    v_mfma_f32_16x16x32_bf16 v[128:131], v[220:223], v[188:191], v[128:131]
    ds_read_b64_tr_b16 v[208:209], v237 offset:24576
    ds_read_b64_tr_b16 v[210:211], v237 offset:28672
    s_waitcnt lgkmcnt(8)
    v_mfma_f32_16x16x32_bf16 v[64:67], v[224:227], v[176:179], v[64:67]
    v_mfma_f32_16x16x32_bf16 v[96:99], v[224:227], v[184:187], v[96:99]
    v_mfma_f32_16x16x32_bf16 v[128:131], v[224:227], v[192:195], v[128:131]
    ds_read_b64_tr_b16 v[212:213], v238 offset:16384
    ds_read_b64_tr_b16 v[214:215], v238 offset:20480
    s_waitcnt lgkmcnt(8)
    v_mfma_f32_16x16x32_bf16 v[68:71], v[196:199], v[172:175], v[68:71]
    v_mfma_f32_16x16x32_bf16 v[100:103], v[196:199], v[180:183], v[100:103]
    v_mfma_f32_16x16x32_bf16 v[132:135], v[196:199], v[188:191], v[132:135]
    ds_read_b64_tr_b16 v[216:217], v238 offset:24576
    ds_read_b64_tr_b16 v[218:219], v238 offset:28672
    s_waitcnt lgkmcnt(8)
    v_mfma_f32_16x16x32_bf16 v[68:71], v[200:203], v[176:179], v[68:71]
    v_mfma_f32_16x16x32_bf16 v[100:103], v[200:203], v[184:187], v[100:103]
    v_mfma_f32_16x16x32_bf16 v[132:135], v[200:203], v[192:195], v[132:135]
    ds_read_b64_tr_b16 v[220:221], v239 offset:16384
    ds_read_b64_tr_b16 v[222:223], v239 offset:20480
    s_waitcnt lgkmcnt(8)
    v_mfma_f32_16x16x32_bf16 v[72:75], v[204:207], v[172:175], v[72:75]
    v_mfma_f32_16x16x32_bf16 v[104:107], v[204:207], v[180:183], v[104:107]
    v_mfma_f32_16x16x32_bf16 v[136:139], v[204:207], v[188:191], v[136:139]
    ds_read_b64_tr_b16 v[224:225], v239 offset:24576
    ds_read_b64_tr_b16 v[226:227], v239 offset:28672
    s_waitcnt lgkmcnt(8)
    v_mfma_f32_16x16x32_bf16 v[72:75], v[208:211], v[176:179], v[72:75]
    v_mfma_f32_16x16x32_bf16 v[104:107], v[208:211], v[184:187], v[104:107]
    v_mfma_f32_16x16x32_bf16 v[136:139], v[208:211], v[192:195], v[136:139]
    s_waitcnt lgkmcnt(6)
    v_mfma_f32_16x16x32_bf16 v[76:79], v[212:215], v[172:175], v[76:79]
    v_mfma_f32_16x16x32_bf16 v[108:111], v[212:215], v[180:183], v[108:111]
    v_mfma_f32_16x16x32_bf16 v[140:143], v[212:215], v[188:191], v[140:143]
    s_waitcnt lgkmcnt(4)
    v_mfma_f32_16x16x32_bf16 v[76:79], v[216:219], v[176:179], v[76:79]
    v_mfma_f32_16x16x32_bf16 v[108:111], v[216:219], v[184:187], v[108:111]
    v_mfma_f32_16x16x32_bf16 v[140:143], v[216:219], v[192:195], v[140:143]
    s_waitcnt lgkmcnt(2)
    v_mfma_f32_16x16x32_bf16 v[80:83], v[220:223], v[172:175], v[80:83]
    v_mfma_f32_16x16x32_bf16 v[112:115], v[220:223], v[180:183], v[112:115]
    v_mfma_f32_16x16x32_bf16 v[144:147], v[220:223], v[188:191], v[144:147]
    s_waitcnt lgkmcnt(0)
    v_mfma_f32_16x16x32_bf16 v[80:83], v[224:227], v[176:179], v[80:83]
    v_mfma_f32_16x16x32_bf16 v[112:115], v[224:227], v[184:187], v[112:115]
    v_mfma_f32_16x16x32_bf16 v[144:147], v[224:227], v[192:195], v[144:147]
    s_waitcnt vmcnt(20)
    s_barrier
    buffer_load_dwordx4 v[172:175], v1, s[8:11], s35 offen offset:0
    buffer_load_dwordx4 v[176:179], v1, s[8:11], s35 offen offset:64
    buffer_load_dwordx4 v[180:183], v1, s[8:11], s36 offen offset:0
    buffer_load_dwordx4 v[184:187], v1, s[8:11], s36 offen offset:64
    buffer_load_dwordx4 v[188:191], v1, s[8:11], s37 offen offset:0
    buffer_load_dwordx4 v[192:195], v1, s[8:11], s37 offen offset:64
    s_add_u32 s35, s35, 128
    s_add_u32 s36, s36, 128
    s_add_u32 s37, s37, 128
    s_add_u32 m0, s38, 16384
    s_add_u32 s31, s40, 0
    buffer_load_dwordx4 v242, s[12:15], s31 offen lds
    s_add_u32 m0, s38, 20480
    s_add_u32 s31, s40, 32768
    buffer_load_dwordx4 v242, s[12:15], s31 offen lds
    s_add_u32 m0, s38, 24576
    s_add_u32 s31, s40, 262144
    buffer_load_dwordx4 v242, s[12:15], s31 offen lds
    s_add_u32 m0, s38, 28672
    s_add_u32 s31, s40, 294912
    buffer_load_dwordx4 v242, s[12:15], s31 offen lds
    s_add_u32 s40, s40, 524288
    ds_read_b64_tr_b16 v[196:197], v232 offset:32768
    ds_read_b64_tr_b16 v[198:199], v232 offset:36864
    ds_read_b64_tr_b16 v[200:201], v232 offset:40960
    ds_read_b64_tr_b16 v[202:203], v232 offset:45056
    ds_read_b64_tr_b16 v[204:205], v233 offset:32768
    ds_read_b64_tr_b16 v[206:207], v233 offset:36864
    ds_read_b64_tr_b16 v[208:209], v233 offset:40960
    ds_read_b64_tr_b16 v[210:211], v233 offset:45056
    ds_read_b64_tr_b16 v[212:213], v234 offset:32768
    ds_read_b64_tr_b16 v[214:215], v234 offset:36864
    s_waitcnt lgkmcnt(8)
    v_mfma_f32_16x16x32_bf16 v[52:55], v[196:199], v[4:7], v[52:55]
    v_mfma_f32_16x16x32_bf16 v[84:87], v[196:199], v[12:15], v[84:87]
    v_mfma_f32_16x16x32_bf16 v[116:119], v[196:199], v[20:23], v[116:119]
    ds_read_b64_tr_b16 v[216:217], v234 offset:40960
    ds_read_b64_tr_b16 v[218:219], v234 offset:45056
    s_waitcnt lgkmcnt(8)
    v_mfma_f32_16x16x32_bf16 v[52:55], v[200:203], v[8:11], v[52:55]
    v_mfma_f32_16x16x32_bf16 v[84:87], v[200:203], v[16:19], v[84:87]
    v_mfma_f32_16x16x32_bf16 v[116:119], v[200:203], v[24:27], v[116:119]
    ds_read_b64_tr_b16 v[220:221], v235 offset:32768
    ds_read_b64_tr_b16 v[222:223], v235 offset:36864
    s_waitcnt lgkmcnt(8)
    v_mfma_f32_16x16x32_bf16 v[56:59], v[204:207], v[4:7], v[56:59]
    v_mfma_f32_16x16x32_bf16 v[88:91], v[204:207], v[12:15], v[88:91]
    v_mfma_f32_16x16x32_bf16 v[120:123], v[204:207], v[20:23], v[120:123]
    ds_read_b64_tr_b16 v[224:225], v235 offset:40960
    ds_read_b64_tr_b16 v[226:227], v235 offset:45056
    s_waitcnt lgkmcnt(8)
    v_mfma_f32_16x16x32_bf16 v[56:59], v[208:211], v[8:11], v[56:59]
    v_mfma_f32_16x16x32_bf16 v[88:91], v[208:211], v[16:19], v[88:91]
    v_mfma_f32_16x16x32_bf16 v[120:123], v[208:211], v[24:27], v[120:123]
    ds_read_b64_tr_b16 v[196:197], v236 offset:32768
    ds_read_b64_tr_b16 v[198:199], v236 offset:36864
    s_waitcnt lgkmcnt(8)
    v_mfma_f32_16x16x32_bf16 v[60:63], v[212:215], v[4:7], v[60:63]
    v_mfma_f32_16x16x32_bf16 v[92:95], v[212:215], v[12:15], v[92:95]
    v_mfma_f32_16x16x32_bf16 v[124:127], v[212:215], v[20:23], v[124:127]
    ds_read_b64_tr_b16 v[200:201], v236 offset:40960
    ds_read_b64_tr_b16 v[202:203], v236 offset:45056
    s_waitcnt lgkmcnt(8)
    v_mfma_f32_16x16x32_bf16 v[60:63], v[216:219], v[8:11], v[60:63]
    v_mfma_f32_16x16x32_bf16 v[92:95], v[216:219], v[16:19], v[92:95]
    v_mfma_f32_16x16x32_bf16 v[124:127], v[216:219], v[24:27], v[124:127]
    ds_read_b64_tr_b16 v[204:205], v237 offset:32768
    ds_read_b64_tr_b16 v[206:207], v237 offset:36864
    s_waitcnt lgkmcnt(8)
    v_mfma_f32_16x16x32_bf16 v[64:67], v[220:223], v[4:7], v[64:67]
    v_mfma_f32_16x16x32_bf16 v[96:99], v[220:223], v[12:15], v[96:99]
    v_mfma_f32_16x16x32_bf16 v[128:131], v[220:223], v[20:23], v[128:131]
    ds_read_b64_tr_b16 v[208:209], v237 offset:40960
    ds_read_b64_tr_b16 v[210:211], v237 offset:45056
    s_waitcnt lgkmcnt(8)
    v_mfma_f32_16x16x32_bf16 v[64:67], v[224:227], v[8:11], v[64:67]
    v_mfma_f32_16x16x32_bf16 v[96:99], v[224:227], v[16:19], v[96:99]
    v_mfma_f32_16x16x32_bf16 v[128:131], v[224:227], v[24:27], v[128:131]
    ds_read_b64_tr_b16 v[212:213], v238 offset:32768
    ds_read_b64_tr_b16 v[214:215], v238 offset:36864
    s_waitcnt lgkmcnt(8)
    v_mfma_f32_16x16x32_bf16 v[68:71], v[196:199], v[4:7], v[68:71]
    v_mfma_f32_16x16x32_bf16 v[100:103], v[196:199], v[12:15], v[100:103]
    v_mfma_f32_16x16x32_bf16 v[132:135], v[196:199], v[20:23], v[132:135]
    ds_read_b64_tr_b16 v[216:217], v238 offset:40960
    ds_read_b64_tr_b16 v[218:219], v238 offset:45056
    s_waitcnt lgkmcnt(8)
    v_mfma_f32_16x16x32_bf16 v[68:71], v[200:203], v[8:11], v[68:71]
    v_mfma_f32_16x16x32_bf16 v[100:103], v[200:203], v[16:19], v[100:103]
    v_mfma_f32_16x16x32_bf16 v[132:135], v[200:203], v[24:27], v[132:135]
    ds_read_b64_tr_b16 v[220:221], v239 offset:32768
    ds_read_b64_tr_b16 v[222:223], v239 offset:36864
    s_waitcnt lgkmcnt(8)
    v_mfma_f32_16x16x32_bf16 v[72:75], v[204:207], v[4:7], v[72:75]
    v_mfma_f32_16x16x32_bf16 v[104:107], v[204:207], v[12:15], v[104:107]
    v_mfma_f32_16x16x32_bf16 v[136:139], v[204:207], v[20:23], v[136:139]
    ds_read_b64_tr_b16 v[224:225], v239 offset:40960
    ds_read_b64_tr_b16 v[226:227], v239 offset:45056
    s_waitcnt lgkmcnt(8)
    v_mfma_f32_16x16x32_bf16 v[72:75], v[208:211], v[8:11], v[72:75]
    v_mfma_f32_16x16x32_bf16 v[104:107], v[208:211], v[16:19], v[104:107]
    v_mfma_f32_16x16x32_bf16 v[136:139], v[208:211], v[24:27], v[136:139]
    s_waitcnt lgkmcnt(6)
    v_mfma_f32_16x16x32_bf16 v[76:79], v[212:215], v[4:7], v[76:79]
    v_mfma_f32_16x16x32_bf16 v[108:111], v[212:215], v[12:15], v[108:111]
    v_mfma_f32_16x16x32_bf16 v[140:143], v[212:215], v[20:23], v[140:143]
    s_waitcnt lgkmcnt(4)
    v_mfma_f32_16x16x32_bf16 v[76:79], v[216:219], v[8:11], v[76:79]
    v_mfma_f32_16x16x32_bf16 v[108:111], v[216:219], v[16:19], v[108:111]
    v_mfma_f32_16x16x32_bf16 v[140:143], v[216:219], v[24:27], v[140:143]
    s_waitcnt lgkmcnt(2)
    v_mfma_f32_16x16x32_bf16 v[80:83], v[220:223], v[4:7], v[80:83]
    v_mfma_f32_16x16x32_bf16 v[112:115], v[220:223], v[12:15], v[112:115]
    v_mfma_f32_16x16x32_bf16 v[144:147], v[220:223], v[20:23], v[144:147]
    s_waitcnt lgkmcnt(0)
    v_mfma_f32_16x16x32_bf16 v[80:83], v[224:227], v[8:11], v[80:83]
    v_mfma_f32_16x16x32_bf16 v[112:115], v[224:227], v[16:19], v[112:115]
    v_mfma_f32_16x16x32_bf16 v[144:147], v[224:227], v[24:27], v[144:147]
    s_waitcnt vmcnt(20)
    s_barrier
    buffer_load_dwordx4 v[4:7], v1, s[8:11], s35 offen offset:0
    buffer_load_dwordx4 v[8:11], v1, s[8:11], s35 offen offset:64
    buffer_load_dwordx4 v[12:15], v1, s[8:11], s36 offen offset:0
    buffer_load_dwordx4 v[16:19], v1, s[8:11], s36 offen offset:64
    buffer_load_dwordx4 v[20:23], v1, s[8:11], s37 offen offset:0
    buffer_load_dwordx4 v[24:27], v1, s[8:11], s37 offen offset:64
    s_add_u32 s35, s35, 128
    s_add_u32 s36, s36, 128
    s_add_u32 s37, s37, 128
    s_add_u32 m0, s38, 32768
    s_add_u32 s31, s40, 0
    buffer_load_dwordx4 v242, s[12:15], s31 offen lds
    s_add_u32 m0, s38, 36864
    s_add_u32 s31, s40, 32768
    buffer_load_dwordx4 v242, s[12:15], s31 offen lds
    s_add_u32 m0, s38, 40960
    s_add_u32 s31, s40, 262144
    buffer_load_dwordx4 v242, s[12:15], s31 offen lds
    s_add_u32 m0, s38, 45056
    s_add_u32 s31, s40, 294912
    buffer_load_dwordx4 v242, s[12:15], s31 offen lds
    s_add_u32 s40, s40, 524288
    ds_read_b64_tr_b16 v[196:197], v232 offset:49152
    ds_read_b64_tr_b16 v[198:199], v232 offset:53248
    ds_read_b64_tr_b16 v[200:201], v232 offset:57344
    ds_read_b64_tr_b16 v[202:203], v232 offset:61440
    ds_read_b64_tr_b16 v[204:205], v233 offset:49152
    ds_read_b64_tr_b16 v[206:207], v233 offset:53248
    ds_read_b64_tr_b16 v[208:209], v233 offset:57344
    ds_read_b64_tr_b16 v[210:211], v233 offset:61440
    ds_read_b64_tr_b16 v[212:213], v234 offset:49152
    ds_read_b64_tr_b16 v[214:215], v234 offset:53248
    s_waitcnt lgkmcnt(8)
    v_mfma_f32_16x16x32_bf16 v[52:55], v[196:199], v[28:31], v[52:55]
    v_mfma_f32_16x16x32_bf16 v[84:87], v[196:199], v[36:39], v[84:87]
    v_mfma_f32_16x16x32_bf16 v[116:119], v[196:199], v[44:47], v[116:119]
    ds_read_b64_tr_b16 v[216:217], v234 offset:57344
    ds_read_b64_tr_b16 v[218:219], v234 offset:61440
    s_waitcnt lgkmcnt(8)
    v_mfma_f32_16x16x32_bf16 v[52:55], v[200:203], v[32:35], v[52:55]
    v_mfma_f32_16x16x32_bf16 v[84:87], v[200:203], v[40:43], v[84:87]
    v_mfma_f32_16x16x32_bf16 v[116:119], v[200:203], v[48:51], v[116:119]
    ds_read_b64_tr_b16 v[220:221], v235 offset:49152
    ds_read_b64_tr_b16 v[222:223], v235 offset:53248
    s_waitcnt lgkmcnt(8)
    v_mfma_f32_16x16x32_bf16 v[56:59], v[204:207], v[28:31], v[56:59]
    v_mfma_f32_16x16x32_bf16 v[88:91], v[204:207], v[36:39], v[88:91]
    v_mfma_f32_16x16x32_bf16 v[120:123], v[204:207], v[44:47], v[120:123]
    ds_read_b64_tr_b16 v[224:225], v235 offset:57344
    ds_read_b64_tr_b16 v[226:227], v235 offset:61440
    s_waitcnt lgkmcnt(8)
    v_mfma_f32_16x16x32_bf16 v[56:59], v[208:211], v[32:35], v[56:59]
    v_mfma_f32_16x16x32_bf16 v[88:91], v[208:211], v[40:43], v[88:91]
    v_mfma_f32_16x16x32_bf16 v[120:123], v[208:211], v[48:51], v[120:123]
    ds_read_b64_tr_b16 v[196:197], v236 offset:49152
    ds_read_b64_tr_b16 v[198:199], v236 offset:53248
    s_waitcnt lgkmcnt(8)
    v_mfma_f32_16x16x32_bf16 v[60:63], v[212:215], v[28:31], v[60:63]
    v_mfma_f32_16x16x32_bf16 v[92:95], v[212:215], v[36:39], v[92:95]
    v_mfma_f32_16x16x32_bf16 v[124:127], v[212:215], v[44:47], v[124:127]
    ds_read_b64_tr_b16 v[200:201], v236 offset:57344
    ds_read_b64_tr_b16 v[202:203], v236 offset:61440
    s_waitcnt lgkmcnt(8)
    v_mfma_f32_16x16x32_bf16 v[60:63], v[216:219], v[32:35], v[60:63]
    v_mfma_f32_16x16x32_bf16 v[92:95], v[216:219], v[40:43], v[92:95]
    v_mfma_f32_16x16x32_bf16 v[124:127], v[216:219], v[48:51], v[124:127]
    ds_read_b64_tr_b16 v[204:205], v237 offset:49152
    ds_read_b64_tr_b16 v[206:207], v237 offset:53248
    s_waitcnt lgkmcnt(8)
    v_mfma_f32_16x16x32_bf16 v[64:67], v[220:223], v[28:31], v[64:67]
    v_mfma_f32_16x16x32_bf16 v[96:99], v[220:223], v[36:39], v[96:99]
    v_mfma_f32_16x16x32_bf16 v[128:131], v[220:223], v[44:47], v[128:131]
    ds_read_b64_tr_b16 v[208:209], v237 offset:57344
    ds_read_b64_tr_b16 v[210:211], v237 offset:61440
    s_waitcnt lgkmcnt(8)
    v_mfma_f32_16x16x32_bf16 v[64:67], v[224:227], v[32:35], v[64:67]
    v_mfma_f32_16x16x32_bf16 v[96:99], v[224:227], v[40:43], v[96:99]
    v_mfma_f32_16x16x32_bf16 v[128:131], v[224:227], v[48:51], v[128:131]
    ds_read_b64_tr_b16 v[212:213], v238 offset:49152
    ds_read_b64_tr_b16 v[214:215], v238 offset:53248
    s_waitcnt lgkmcnt(8)
    v_mfma_f32_16x16x32_bf16 v[68:71], v[196:199], v[28:31], v[68:71]
    v_mfma_f32_16x16x32_bf16 v[100:103], v[196:199], v[36:39], v[100:103]
    v_mfma_f32_16x16x32_bf16 v[132:135], v[196:199], v[44:47], v[132:135]
    ds_read_b64_tr_b16 v[216:217], v238 offset:57344
    ds_read_b64_tr_b16 v[218:219], v238 offset:61440
    s_waitcnt lgkmcnt(8)
    v_mfma_f32_16x16x32_bf16 v[68:71], v[200:203], v[32:35], v[68:71]
    v_mfma_f32_16x16x32_bf16 v[100:103], v[200:203], v[40:43], v[100:103]
    v_mfma_f32_16x16x32_bf16 v[132:135], v[200:203], v[48:51], v[132:135]
    ds_read_b64_tr_b16 v[220:221], v239 offset:49152
    ds_read_b64_tr_b16 v[222:223], v239 offset:53248
    s_waitcnt lgkmcnt(8)
    v_mfma_f32_16x16x32_bf16 v[72:75], v[204:207], v[28:31], v[72:75]
    v_mfma_f32_16x16x32_bf16 v[104:107], v[204:207], v[36:39], v[104:107]
    v_mfma_f32_16x16x32_bf16 v[136:139], v[204:207], v[44:47], v[136:139]
    ds_read_b64_tr_b16 v[224:225], v239 offset:57344
    ds_read_b64_tr_b16 v[226:227], v239 offset:61440
    s_waitcnt lgkmcnt(8)
    v_mfma_f32_16x16x32_bf16 v[72:75], v[208:211], v[32:35], v[72:75]
    v_mfma_f32_16x16x32_bf16 v[104:107], v[208:211], v[40:43], v[104:107]
    v_mfma_f32_16x16x32_bf16 v[136:139], v[208:211], v[48:51], v[136:139]
    s_waitcnt lgkmcnt(6)
    v_mfma_f32_16x16x32_bf16 v[76:79], v[212:215], v[28:31], v[76:79]
    v_mfma_f32_16x16x32_bf16 v[108:111], v[212:215], v[36:39], v[108:111]
    v_mfma_f32_16x16x32_bf16 v[140:143], v[212:215], v[44:47], v[140:143]
    s_waitcnt lgkmcnt(4)
    v_mfma_f32_16x16x32_bf16 v[76:79], v[216:219], v[32:35], v[76:79]
    v_mfma_f32_16x16x32_bf16 v[108:111], v[216:219], v[40:43], v[108:111]
    v_mfma_f32_16x16x32_bf16 v[140:143], v[216:219], v[48:51], v[140:143]
    s_waitcnt lgkmcnt(2)
    v_mfma_f32_16x16x32_bf16 v[80:83], v[220:223], v[28:31], v[80:83]
    v_mfma_f32_16x16x32_bf16 v[112:115], v[220:223], v[36:39], v[112:115]
    v_mfma_f32_16x16x32_bf16 v[144:147], v[220:223], v[44:47], v[144:147]
    s_waitcnt lgkmcnt(0)
    v_mfma_f32_16x16x32_bf16 v[80:83], v[224:227], v[32:35], v[80:83]
    v_mfma_f32_16x16x32_bf16 v[112:115], v[224:227], v[40:43], v[112:115]
    v_mfma_f32_16x16x32_bf16 v[144:147], v[224:227], v[48:51], v[144:147]
    s_waitcnt vmcnt(20)
    s_barrier
    buffer_load_dwordx4 v[28:31], v1, s[8:11], s35 offen offset:0
    buffer_load_dwordx4 v[32:35], v1, s[8:11], s35 offen offset:64
    buffer_load_dwordx4 v[36:39], v1, s[8:11], s36 offen offset:0
    buffer_load_dwordx4 v[40:43], v1, s[8:11], s36 offen offset:64
    buffer_load_dwordx4 v[44:47], v1, s[8:11], s37 offen offset:0
    buffer_load_dwordx4 v[48:51], v1, s[8:11], s37 offen offset:64
    s_add_u32 s35, s35, 128
    s_add_u32 s36, s36, 128
    s_add_u32 s37, s37, 128
    s_add_u32 m0, s38, 49152
    s_add_u32 s31, s40, 0
    buffer_load_dwordx4 v242, s[12:15], s31 offen lds
    s_add_u32 m0, s38, 53248
    s_add_u32 s31, s40, 32768
    buffer_load_dwordx4 v242, s[12:15], s31 offen lds
    s_add_u32 m0, s38, 57344
    s_add_u32 s31, s40, 262144
    buffer_load_dwordx4 v242, s[12:15], s31 offen lds
    s_add_u32 m0, s38, 61440
    s_add_u32 s31, s40, 294912
    buffer_load_dwordx4 v242, s[12:15], s31 offen lds
    s_add_u32 s40, s40, 524288
    ds_read_b64_tr_b16 v[196:197], v232 offset:0
    ds_read_b64_tr_b16 v[198:199], v232 offset:4096
    ds_read_b64_tr_b16 v[200:201], v232 offset:8192
    ds_read_b64_tr_b16 v[202:203], v232 offset:12288
    ds_read_b64_tr_b16 v[204:205], v233 offset:0
    ds_read_b64_tr_b16 v[206:207], v233 offset:4096
    ds_read_b64_tr_b16 v[208:209], v233 offset:8192
    ds_read_b64_tr_b16 v[210:211], v233 offset:12288
    ds_read_b64_tr_b16 v[212:213], v234 offset:0
    ds_read_b64_tr_b16 v[214:215], v234 offset:4096
    s_waitcnt lgkmcnt(8)
    v_mfma_f32_16x16x32_bf16 v[52:55], v[196:199], v[148:151], v[52:55]
    v_mfma_f32_16x16x32_bf16 v[84:87], v[196:199], v[156:159], v[84:87]
    v_mfma_f32_16x16x32_bf16 v[116:119], v[196:199], v[164:167], v[116:119]
    ds_read_b64_tr_b16 v[216:217], v234 offset:8192
    ds_read_b64_tr_b16 v[218:219], v234 offset:12288
    s_waitcnt lgkmcnt(8)
    v_mfma_f32_16x16x32_bf16 v[52:55], v[200:203], v[152:155], v[52:55]
    v_mfma_f32_16x16x32_bf16 v[84:87], v[200:203], v[160:163], v[84:87]
    v_mfma_f32_16x16x32_bf16 v[116:119], v[200:203], v[168:171], v[116:119]
    ds_read_b64_tr_b16 v[220:221], v235 offset:0
    ds_read_b64_tr_b16 v[222:223], v235 offset:4096
    s_waitcnt lgkmcnt(8)
    v_mfma_f32_16x16x32_bf16 v[56:59], v[204:207], v[148:151], v[56:59]
    v_mfma_f32_16x16x32_bf16 v[88:91], v[204:207], v[156:159], v[88:91]
    v_mfma_f32_16x16x32_bf16 v[120:123], v[204:207], v[164:167], v[120:123]
    ds_read_b64_tr_b16 v[224:225], v235 offset:8192
    ds_read_b64_tr_b16 v[226:227], v235 offset:12288
    s_waitcnt lgkmcnt(8)
    v_mfma_f32_16x16x32_bf16 v[56:59], v[208:211], v[152:155], v[56:59]
    v_mfma_f32_16x16x32_bf16 v[88:91], v[208:211], v[160:163], v[88:91]
    v_mfma_f32_16x16x32_bf16 v[120:123], v[208:211], v[168:171], v[120:123]
    ds_read_b64_tr_b16 v[196:197], v236 offset:0
    ds_read_b64_tr_b16 v[198:199], v236 offset:4096
    s_waitcnt lgkmcnt(8)
    v_mfma_f32_16x16x32_bf16 v[60:63], v[212:215], v[148:151], v[60:63]
    v_mfma_f32_16x16x32_bf16 v[92:95], v[212:215], v[156:159], v[92:95]
    v_mfma_f32_16x16x32_bf16 v[124:127], v[212:215], v[164:167], v[124:127]
    ds_read_b64_tr_b16 v[200:201], v236 offset:8192
    ds_read_b64_tr_b16 v[202:203], v236 offset:12288
    s_waitcnt lgkmcnt(8)
    v_mfma_f32_16x16x32_bf16 v[60:63], v[216:219], v[152:155], v[60:63]
    v_mfma_f32_16x16x32_bf16 v[92:95], v[216:219], v[160:163], v[92:95]
    v_mfma_f32_16x16x32_bf16 v[124:127], v[216:219], v[168:171], v[124:127]
    ds_read_b64_tr_b16 v[204:205], v237 offset:0
    ds_read_b64_tr_b16 v[206:207], v237 offset:4096
    s_waitcnt lgkmcnt(8)
    v_mfma_f32_16x16x32_bf16 v[64:67], v[220:223], v[148:151], v[64:67]
    v_mfma_f32_16x16x32_bf16 v[96:99], v[220:223], v[156:159], v[96:99]
    v_mfma_f32_16x16x32_bf16 v[128:131], v[220:223], v[164:167], v[128:131]
    ds_read_b64_tr_b16 v[208:209], v237 offset:8192
    ds_read_b64_tr_b16 v[210:211], v237 offset:12288
    s_waitcnt lgkmcnt(8)
    v_mfma_f32_16x16x32_bf16 v[64:67], v[224:227], v[152:155], v[64:67]
    v_mfma_f32_16x16x32_bf16 v[96:99], v[224:227], v[160:163], v[96:99]
    v_mfma_f32_16x16x32_bf16 v[128:131], v[224:227], v[168:171], v[128:131]
    ds_read_b64_tr_b16 v[212:213], v238 offset:0
    ds_read_b64_tr_b16 v[214:215], v238 offset:4096
    s_waitcnt lgkmcnt(8)
    v_mfma_f32_16x16x32_bf16 v[68:71], v[196:199], v[148:151], v[68:71]
    v_mfma_f32_16x16x32_bf16 v[100:103], v[196:199], v[156:159], v[100:103]
    v_mfma_f32_16x16x32_bf16 v[132:135], v[196:199], v[164:167], v[132:135]
    ds_read_b64_tr_b16 v[216:217], v238 offset:8192
    ds_read_b64_tr_b16 v[218:219], v238 offset:12288
    s_waitcnt lgkmcnt(8)
    v_mfma_f32_16x16x32_bf16 v[68:71], v[200:203], v[152:155], v[68:71]
    v_mfma_f32_16x16x32_bf16 v[100:103], v[200:203], v[160:163], v[100:103]
    v_mfma_f32_16x16x32_bf16 v[132:135], v[200:203], v[168:171], v[132:135]
    ds_read_b64_tr_b16 v[220:221], v239 offset:0
    ds_read_b64_tr_b16 v[222:223], v239 offset:4096
    s_waitcnt lgkmcnt(8)
    v_mfma_f32_16x16x32_bf16 v[72:75], v[204:207], v[148:151], v[72:75]
    v_mfma_f32_16x16x32_bf16 v[104:107], v[204:207], v[156:159], v[104:107]
    v_mfma_f32_16x16x32_bf16 v[136:139], v[204:207], v[164:167], v[136:139]
    ds_read_b64_tr_b16 v[224:225], v239 offset:8192
    ds_read_b64_tr_b16 v[226:227], v239 offset:12288
    s_waitcnt lgkmcnt(8)
    v_mfma_f32_16x16x32_bf16 v[72:75], v[208:211], v[152:155], v[72:75]
    v_mfma_f32_16x16x32_bf16 v[104:107], v[208:211], v[160:163], v[104:107]
    v_mfma_f32_16x16x32_bf16 v[136:139], v[208:211], v[168:171], v[136:139]
    s_waitcnt lgkmcnt(6)
    v_mfma_f32_16x16x32_bf16 v[76:79], v[212:215], v[148:151], v[76:79]
    v_mfma_f32_16x16x32_bf16 v[108:111], v[212:215], v[156:159], v[108:111]
    v_mfma_f32_16x16x32_bf16 v[140:143], v[212:215], v[164:167], v[140:143]
    s_waitcnt lgkmcnt(4)
    v_mfma_f32_16x16x32_bf16 v[76:79], v[216:219], v[152:155], v[76:79]
    v_mfma_f32_16x16x32_bf16 v[108:111], v[216:219], v[160:163], v[108:111]
    v_mfma_f32_16x16x32_bf16 v[140:143], v[216:219], v[168:171], v[140:143]
    s_waitcnt lgkmcnt(2)
    v_mfma_f32_16x16x32_bf16 v[80:83], v[220:223], v[148:151], v[80:83]
    v_mfma_f32_16x16x32_bf16 v[112:115], v[220:223], v[156:159], v[112:115]
    v_mfma_f32_16x16x32_bf16 v[144:147], v[220:223], v[164:167], v[144:147]
    s_waitcnt lgkmcnt(0)
    v_mfma_f32_16x16x32_bf16 v[80:83], v[224:227], v[152:155], v[80:83]
    v_mfma_f32_16x16x32_bf16 v[112:115], v[224:227], v[160:163], v[112:115]
    v_mfma_f32_16x16x32_bf16 v[144:147], v[224:227], v[168:171], v[144:147]
    s_waitcnt vmcnt(20)
    s_barrier
    s_add_u32 m0, s38, 0
    s_add_u32 s31, s32, 0
    buffer_load_dwordx4 v240, s[16:19], s31 offen nt lds
    s_add_u32 m0, s38, 4096
    s_add_u32 s31, s32, 4096
    buffer_load_dwordx4 v240, s[16:19], s31 offen nt lds
    s_add_u32 m0, s38, 8192
    s_add_u32 s31, s32, 8192
    buffer_load_dwordx4 v240, s[16:19], s31 offen nt lds
    s_add_u32 m0, s38, 12288
    s_add_u32 s31, s32, 12288
    buffer_load_dwordx4 v240, s[16:19], s31 offen nt lds
    s_add_u32 s32, s32, 16384
    ds_read_b64_tr_b16 v[196:197], v232 offset:16384
    ds_read_b64_tr_b16 v[198:199], v232 offset:20480
    ds_read_b64_tr_b16 v[200:201], v232 offset:24576
    ds_read_b64_tr_b16 v[202:203], v232 offset:28672
    ds_read_b64_tr_b16 v[204:205], v233 offset:16384
    ds_read_b64_tr_b16 v[206:207], v233 offset:20480
    ds_read_b64_tr_b16 v[208:209], v233 offset:24576
    ds_read_b64_tr_b16 v[210:211], v233 offset:28672
    ds_read_b64_tr_b16 v[212:213], v234 offset:16384
    ds_read_b64_tr_b16 v[214:215], v234 offset:20480
    s_waitcnt lgkmcnt(8)
    v_mfma_f32_16x16x32_bf16 v[52:55], v[196:199], v[172:175], v[52:55]
    v_mfma_f32_16x16x32_bf16 v[84:87], v[196:199], v[180:183], v[84:87]
    v_mfma_f32_16x16x32_bf16 v[116:119], v[196:199], v[188:191], v[116:119]
    ds_read_b64_tr_b16 v[216:217], v234 offset:24576
    ds_read_b64_tr_b16 v[218:219], v234 offset:28672
    s_waitcnt lgkmcnt(8)
    v_mfma_f32_16x16x32_bf16 v[52:55], v[200:203], v[176:179], v[52:55]
    v_mfma_f32_16x16x32_bf16 v[84:87], v[200:203], v[184:187], v[84:87]
    v_mfma_f32_16x16x32_bf16 v[116:119], v[200:203], v[192:195], v[116:119]
    ds_read_b64_tr_b16 v[220:221], v235 offset:16384
    ds_read_b64_tr_b16 v[222:223], v235 offset:20480
    s_waitcnt lgkmcnt(8)
    v_mfma_f32_16x16x32_bf16 v[56:59], v[204:207], v[172:175], v[56:59]
    v_mfma_f32_16x16x32_bf16 v[88:91], v[204:207], v[180:183], v[88:91]
    v_mfma_f32_16x16x32_bf16 v[120:123], v[204:207], v[188:191], v[120:123]
    ds_read_b64_tr_b16 v[224:225], v235 offset:24576
    ds_read_b64_tr_b16 v[226:227], v235 offset:28672
    s_waitcnt lgkmcnt(8)
    v_mfma_f32_16x16x32_bf16 v[56:59], v[208:211], v[176:179], v[56:59]
    v_mfma_f32_16x16x32_bf16 v[88:91], v[208:211], v[184:187], v[88:91]
    v_mfma_f32_16x16x32_bf16 v[120:123], v[208:211], v[192:195], v[120:123]
    ds_read_b64_tr_b16 v[196:197], v236 offset:16384
    ds_read_b64_tr_b16 v[198:199], v236 offset:20480
    s_waitcnt lgkmcnt(8)
    v_mfma_f32_16x16x32_bf16 v[60:63], v[212:215], v[172:175], v[60:63]
    v_mfma_f32_16x16x32_bf16 v[92:95], v[212:215], v[180:183], v[92:95]
    v_mfma_f32_16x16x32_bf16 v[124:127], v[212:215], v[188:191], v[124:127]
    ds_read_b64_tr_b16 v[200:201], v236 offset:24576
    ds_read_b64_tr_b16 v[202:203], v236 offset:28672
    s_waitcnt lgkmcnt(8)
    v_mfma_f32_16x16x32_bf16 v[60:63], v[216:219], v[176:179], v[60:63]
    v_mfma_f32_16x16x32_bf16 v[92:95], v[216:219], v[184:187], v[92:95]
    v_mfma_f32_16x16x32_bf16 v[124:127], v[216:219], v[192:195], v[124:127]
    ds_read_b64_tr_b16 v[204:205], v237 offset:16384
    ds_read_b64_tr_b16 v[206:207], v237 offset:20480
    s_waitcnt lgkmcnt(8)
    v_mfma_f32_16x16x32_bf16 v[64:67], v[220:223], v[172:175], v[64:67]
    v_mfma_f32_16x16x32_bf16 v[96:99], v[220:223], v[180:183], v[96:99]
    v_mfma_f32_16x16x32_bf16 v[128:131], v[220:223], v[188:191], v[128:131]
    ds_read_b64_tr_b16 v[208:209], v237 offset:24576
    ds_read_b64_tr_b16 v[210:211], v237 offset:28672
    s_waitcnt lgkmcnt(8)
    v_mfma_f32_16x16x32_bf16 v[64:67], v[224:227], v[176:179], v[64:67]
    v_mfma_f32_16x16x32_bf16 v[96:99], v[224:227], v[184:187], v[96:99]
    v_mfma_f32_16x16x32_bf16 v[128:131], v[224:227], v[192:195], v[128:131]
    ds_read_b64_tr_b16 v[212:213], v238 offset:16384
    ds_read_b64_tr_b16 v[214:215], v238 offset:20480
    s_waitcnt lgkmcnt(8)
    v_mfma_f32_16x16x32_bf16 v[68:71], v[196:199], v[172:175], v[68:71]
    v_mfma_f32_16x16x32_bf16 v[100:103], v[196:199], v[180:183], v[100:103]
    v_mfma_f32_16x16x32_bf16 v[132:135], v[196:199], v[188:191], v[132:135]
    ds_read_b64_tr_b16 v[216:217], v238 offset:24576
    ds_read_b64_tr_b16 v[218:219], v238 offset:28672
    s_waitcnt lgkmcnt(8)
    v_mfma_f32_16x16x32_bf16 v[68:71], v[200:203], v[176:179], v[68:71]
    v_mfma_f32_16x16x32_bf16 v[100:103], v[200:203], v[184:187], v[100:103]
    v_mfma_f32_16x16x32_bf16 v[132:135], v[200:203], v[192:195], v[132:135]
    ds_read_b64_tr_b16 v[220:221], v239 offset:16384
    ds_read_b64_tr_b16 v[222:223], v239 offset:20480
    s_waitcnt lgkmcnt(8)
    v_mfma_f32_16x16x32_bf16 v[72:75], v[204:207], v[172:175], v[72:75]
    v_mfma_f32_16x16x32_bf16 v[104:107], v[204:207], v[180:183], v[104:107]
    v_mfma_f32_16x16x32_bf16 v[136:139], v[204:207], v[188:191], v[136:139]
    ds_read_b64_tr_b16 v[224:225], v239 offset:24576
    ds_read_b64_tr_b16 v[226:227], v239 offset:28672
    s_waitcnt lgkmcnt(8)
    v_mfma_f32_16x16x32_bf16 v[72:75], v[208:211], v[176:179], v[72:75]
    v_mfma_f32_16x16x32_bf16 v[104:107], v[208:211], v[184:187], v[104:107]
    v_mfma_f32_16x16x32_bf16 v[136:139], v[208:211], v[192:195], v[136:139]
    s_waitcnt lgkmcnt(6)
    v_mfma_f32_16x16x32_bf16 v[76:79], v[212:215], v[172:175], v[76:79]
    v_mfma_f32_16x16x32_bf16 v[108:111], v[212:215], v[180:183], v[108:111]
    v_mfma_f32_16x16x32_bf16 v[140:143], v[212:215], v[188:191], v[140:143]
    s_waitcnt lgkmcnt(4)
    v_mfma_f32_16x16x32_bf16 v[76:79], v[216:219], v[176:179], v[76:79]
    v_mfma_f32_16x16x32_bf16 v[108:111], v[216:219], v[184:187], v[108:111]
    v_mfma_f32_16x16x32_bf16 v[140:143], v[216:219], v[192:195], v[140:143]
    s_waitcnt lgkmcnt(2)
    v_mfma_f32_16x16x32_bf16 v[80:83], v[220:223], v[172:175], v[80:83]
    v_mfma_f32_16x16x32_bf16 v[112:115], v[220:223], v[180:183], v[112:115]
    v_mfma_f32_16x16x32_bf16 v[144:147], v[220:223], v[188:191], v[144:147]
    s_waitcnt lgkmcnt(0)
    v_mfma_f32_16x16x32_bf16 v[80:83], v[224:227], v[176:179], v[80:83]
    v_mfma_f32_16x16x32_bf16 v[112:115], v[224:227], v[184:187], v[112:115]
    v_mfma_f32_16x16x32_bf16 v[144:147], v[224:227], v[192:195], v[144:147]
    s_waitcnt vmcnt(14)
    s_barrier
    s_add_u32 m0, s38, 16384
    s_add_u32 s31, s33, 0
    buffer_load_dwordx4 v241, s[20:23], s31 offen nt lds
    s_add_u32 m0, s38, 20480
    s_add_u32 s31, s33, 4096
    buffer_load_dwordx4 v241, s[20:23], s31 offen nt lds
    s_add_u32 m0, s38, 24576
    s_add_u32 s31, s33, 8192
    buffer_load_dwordx4 v241, s[20:23], s31 offen nt lds
    s_add_u32 m0, s38, 28672
    s_add_u32 s31, s33, 12288
    buffer_load_dwordx4 v241, s[20:23], s31 offen nt lds
    s_add_u32 s33, s33, 16384
    ds_read_b64_tr_b16 v[196:197], v232 offset:32768
    ds_read_b64_tr_b16 v[198:199], v232 offset:36864
    ds_read_b64_tr_b16 v[200:201], v232 offset:40960
    ds_read_b64_tr_b16 v[202:203], v232 offset:45056
    ds_read_b64_tr_b16 v[204:205], v233 offset:32768
    ds_read_b64_tr_b16 v[206:207], v233 offset:36864
    ds_read_b64_tr_b16 v[208:209], v233 offset:40960
    ds_read_b64_tr_b16 v[210:211], v233 offset:45056
    ds_read_b64_tr_b16 v[212:213], v234 offset:32768
    ds_read_b64_tr_b16 v[214:215], v234 offset:36864
    s_waitcnt lgkmcnt(8)
    v_mfma_f32_16x16x32_bf16 v[52:55], v[196:199], v[4:7], v[52:55]
    v_mfma_f32_16x16x32_bf16 v[84:87], v[196:199], v[12:15], v[84:87]
    v_mfma_f32_16x16x32_bf16 v[116:119], v[196:199], v[20:23], v[116:119]
    ds_read_b64_tr_b16 v[216:217], v234 offset:40960
    ds_read_b64_tr_b16 v[218:219], v234 offset:45056
    s_waitcnt lgkmcnt(8)
    v_mfma_f32_16x16x32_bf16 v[52:55], v[200:203], v[8:11], v[52:55]
    v_mfma_f32_16x16x32_bf16 v[84:87], v[200:203], v[16:19], v[84:87]
    v_mfma_f32_16x16x32_bf16 v[116:119], v[200:203], v[24:27], v[116:119]
    ds_read_b64_tr_b16 v[220:221], v235 offset:32768
    ds_read_b64_tr_b16 v[222:223], v235 offset:36864
    s_waitcnt lgkmcnt(8)
    v_mfma_f32_16x16x32_bf16 v[56:59], v[204:207], v[4:7], v[56:59]
    v_mfma_f32_16x16x32_bf16 v[88:91], v[204:207], v[12:15], v[88:91]
    v_mfma_f32_16x16x32_bf16 v[120:123], v[204:207], v[20:23], v[120:123]
    ds_read_b64_tr_b16 v[224:225], v235 offset:40960
    ds_read_b64_tr_b16 v[226:227], v235 offset:45056
    s_waitcnt lgkmcnt(8)
    v_mfma_f32_16x16x32_bf16 v[56:59], v[208:211], v[8:11], v[56:59]
    v_mfma_f32_16x16x32_bf16 v[88:91], v[208:211], v[16:19], v[88:91]
    v_mfma_f32_16x16x32_bf16 v[120:123], v[208:211], v[24:27], v[120:123]
    ds_read_b64_tr_b16 v[196:197], v236 offset:32768
    ds_read_b64_tr_b16 v[198:199], v236 offset:36864
    s_waitcnt lgkmcnt(8)
    v_mfma_f32_16x16x32_bf16 v[60:63], v[212:215], v[4:7], v[60:63]
    v_mfma_f32_16x16x32_bf16 v[92:95], v[212:215], v[12:15], v[92:95]
    v_mfma_f32_16x16x32_bf16 v[124:127], v[212:215], v[20:23], v[124:127]
    ds_read_b64_tr_b16 v[200:201], v236 offset:40960
    ds_read_b64_tr_b16 v[202:203], v236 offset:45056
    s_waitcnt lgkmcnt(8)
    v_mfma_f32_16x16x32_bf16 v[60:63], v[216:219], v[8:11], v[60:63]
    v_mfma_f32_16x16x32_bf16 v[92:95], v[216:219], v[16:19], v[92:95]
    v_mfma_f32_16x16x32_bf16 v[124:127], v[216:219], v[24:27], v[124:127]
    ds_read_b64_tr_b16 v[204:205], v237 offset:32768
    ds_read_b64_tr_b16 v[206:207], v237 offset:36864
    s_waitcnt lgkmcnt(8)
    v_mfma_f32_16x16x32_bf16 v[64:67], v[220:223], v[4:7], v[64:67]
    v_mfma_f32_16x16x32_bf16 v[96:99], v[220:223], v[12:15], v[96:99]
    v_mfma_f32_16x16x32_bf16 v[128:131], v[220:223], v[20:23], v[128:131]
    ds_read_b64_tr_b16 v[208:209], v237 offset:40960
    ds_read_b64_tr_b16 v[210:211], v237 offset:45056
    s_waitcnt lgkmcnt(8)
    v_mfma_f32_16x16x32_bf16 v[64:67], v[224:227], v[8:11], v[64:67]
    v_mfma_f32_16x16x32_bf16 v[96:99], v[224:227], v[16:19], v[96:99]
    v_mfma_f32_16x16x32_bf16 v[128:131], v[224:227], v[24:27], v[128:131]
    ds_read_b64_tr_b16 v[212:213], v238 offset:32768
    ds_read_b64_tr_b16 v[214:215], v238 offset:36864
    s_waitcnt lgkmcnt(8)
    v_mfma_f32_16x16x32_bf16 v[68:71], v[196:199], v[4:7], v[68:71]
    v_mfma_f32_16x16x32_bf16 v[100:103], v[196:199], v[12:15], v[100:103]
    v_mfma_f32_16x16x32_bf16 v[132:135], v[196:199], v[20:23], v[132:135]
    ds_read_b64_tr_b16 v[216:217], v238 offset:40960
    ds_read_b64_tr_b16 v[218:219], v238 offset:45056
    s_waitcnt lgkmcnt(8)
    v_mfma_f32_16x16x32_bf16 v[68:71], v[200:203], v[8:11], v[68:71]
    v_mfma_f32_16x16x32_bf16 v[100:103], v[200:203], v[16:19], v[100:103]
    v_mfma_f32_16x16x32_bf16 v[132:135], v[200:203], v[24:27], v[132:135]
    ds_read_b64_tr_b16 v[220:221], v239 offset:32768
    ds_read_b64_tr_b16 v[222:223], v239 offset:36864
    s_waitcnt lgkmcnt(8)
    v_mfma_f32_16x16x32_bf16 v[72:75], v[204:207], v[4:7], v[72:75]
    v_mfma_f32_16x16x32_bf16 v[104:107], v[204:207], v[12:15], v[104:107]
    v_mfma_f32_16x16x32_bf16 v[136:139], v[204:207], v[20:23], v[136:139]
    ds_read_b64_tr_b16 v[224:225], v239 offset:40960
    ds_read_b64_tr_b16 v[226:227], v239 offset:45056
    s_waitcnt lgkmcnt(8)
    v_mfma_f32_16x16x32_bf16 v[72:75], v[208:211], v[8:11], v[72:75]
    v_mfma_f32_16x16x32_bf16 v[104:107], v[208:211], v[16:19], v[104:107]
    v_mfma_f32_16x16x32_bf16 v[136:139], v[208:211], v[24:27], v[136:139]
    s_waitcnt lgkmcnt(6)
    v_mfma_f32_16x16x32_bf16 v[76:79], v[212:215], v[4:7], v[76:79]
    v_mfma_f32_16x16x32_bf16 v[108:111], v[212:215], v[12:15], v[108:111]
    v_mfma_f32_16x16x32_bf16 v[140:143], v[212:215], v[20:23], v[140:143]
    s_waitcnt lgkmcnt(4)
    v_mfma_f32_16x16x32_bf16 v[76:79], v[216:219], v[8:11], v[76:79]
    v_mfma_f32_16x16x32_bf16 v[108:111], v[216:219], v[16:19], v[108:111]
    v_mfma_f32_16x16x32_bf16 v[140:143], v[216:219], v[24:27], v[140:143]
    s_waitcnt lgkmcnt(2)
    v_mfma_f32_16x16x32_bf16 v[80:83], v[220:223], v[4:7], v[80:83]
    v_mfma_f32_16x16x32_bf16 v[112:115], v[220:223], v[12:15], v[112:115]
    v_mfma_f32_16x16x32_bf16 v[144:147], v[220:223], v[20:23], v[144:147]
    s_waitcnt lgkmcnt(0)
    v_mfma_f32_16x16x32_bf16 v[80:83], v[224:227], v[8:11], v[80:83]
    v_mfma_f32_16x16x32_bf16 v[112:115], v[224:227], v[16:19], v[112:115]
    v_mfma_f32_16x16x32_bf16 v[144:147], v[224:227], v[24:27], v[144:147]
    s_waitcnt vmcnt(8)
    s_barrier
    s_add_u32 m0, s38, 32768
    s_add_u32 s31, s32, 0
    buffer_load_dwordx4 v240, s[16:19], s31 offen nt lds
    s_add_u32 m0, s38, 36864
    s_add_u32 s31, s32, 4096
    buffer_load_dwordx4 v240, s[16:19], s31 offen nt lds
    s_add_u32 m0, s38, 40960
    s_add_u32 s31, s32, 8192
    buffer_load_dwordx4 v240, s[16:19], s31 offen nt lds
    s_add_u32 m0, s38, 45056
    s_add_u32 s31, s32, 12288
    buffer_load_dwordx4 v240, s[16:19], s31 offen nt lds
    s_add_u32 s32, s32, 16384
    ds_read_b64_tr_b16 v[196:197], v232 offset:49152
    ds_read_b64_tr_b16 v[198:199], v232 offset:53248
    ds_read_b64_tr_b16 v[200:201], v232 offset:57344
    ds_read_b64_tr_b16 v[202:203], v232 offset:61440
    ds_read_b64_tr_b16 v[204:205], v233 offset:49152
    ds_read_b64_tr_b16 v[206:207], v233 offset:53248
    ds_read_b64_tr_b16 v[208:209], v233 offset:57344
    ds_read_b64_tr_b16 v[210:211], v233 offset:61440
    ds_read_b64_tr_b16 v[212:213], v234 offset:49152
    ds_read_b64_tr_b16 v[214:215], v234 offset:53248
    s_waitcnt lgkmcnt(8)
    v_mfma_f32_16x16x32_bf16 v[52:55], v[196:199], v[28:31], v[52:55]
    v_mfma_f32_16x16x32_bf16 v[84:87], v[196:199], v[36:39], v[84:87]
    v_mfma_f32_16x16x32_bf16 v[116:119], v[196:199], v[44:47], v[116:119]
    ds_read_b64_tr_b16 v[216:217], v234 offset:57344
    ds_read_b64_tr_b16 v[218:219], v234 offset:61440
    s_waitcnt lgkmcnt(8)
    v_mfma_f32_16x16x32_bf16 v[52:55], v[200:203], v[32:35], v[52:55]
    v_mfma_f32_16x16x32_bf16 v[84:87], v[200:203], v[40:43], v[84:87]
    v_mfma_f32_16x16x32_bf16 v[116:119], v[200:203], v[48:51], v[116:119]
    ds_read_b64_tr_b16 v[220:221], v235 offset:49152
    ds_read_b64_tr_b16 v[222:223], v235 offset:53248
    s_waitcnt lgkmcnt(8)
    v_mfma_f32_16x16x32_bf16 v[56:59], v[204:207], v[28:31], v[56:59]
    v_mfma_f32_16x16x32_bf16 v[88:91], v[204:207], v[36:39], v[88:91]
    v_mfma_f32_16x16x32_bf16 v[120:123], v[204:207], v[44:47], v[120:123]
    ds_read_b64_tr_b16 v[224:225], v235 offset:57344
    ds_read_b64_tr_b16 v[226:227], v235 offset:61440
    s_waitcnt lgkmcnt(8)
    v_mfma_f32_16x16x32_bf16 v[56:59], v[208:211], v[32:35], v[56:59]
    v_mfma_f32_16x16x32_bf16 v[88:91], v[208:211], v[40:43], v[88:91]
    v_mfma_f32_16x16x32_bf16 v[120:123], v[208:211], v[48:51], v[120:123]
    ds_read_b64_tr_b16 v[196:197], v236 offset:49152
    ds_read_b64_tr_b16 v[198:199], v236 offset:53248
    s_waitcnt lgkmcnt(8)
    v_mfma_f32_16x16x32_bf16 v[60:63], v[212:215], v[28:31], v[60:63]
    v_mfma_f32_16x16x32_bf16 v[92:95], v[212:215], v[36:39], v[92:95]
    v_mfma_f32_16x16x32_bf16 v[124:127], v[212:215], v[44:47], v[124:127]
    ds_read_b64_tr_b16 v[200:201], v236 offset:57344
    ds_read_b64_tr_b16 v[202:203], v236 offset:61440
    s_waitcnt lgkmcnt(8)
    v_mfma_f32_16x16x32_bf16 v[60:63], v[216:219], v[32:35], v[60:63]
    v_mfma_f32_16x16x32_bf16 v[92:95], v[216:219], v[40:43], v[92:95]
    v_mfma_f32_16x16x32_bf16 v[124:127], v[216:219], v[48:51], v[124:127]
    ds_read_b64_tr_b16 v[204:205], v237 offset:49152
    ds_read_b64_tr_b16 v[206:207], v237 offset:53248
    s_waitcnt lgkmcnt(8)
    v_mfma_f32_16x16x32_bf16 v[64:67], v[220:223], v[28:31], v[64:67]
    v_mfma_f32_16x16x32_bf16 v[96:99], v[220:223], v[36:39], v[96:99]
    v_mfma_f32_16x16x32_bf16 v[128:131], v[220:223], v[44:47], v[128:131]
    ds_read_b64_tr_b16 v[208:209], v237 offset:57344
    ds_read_b64_tr_b16 v[210:211], v237 offset:61440
    s_waitcnt lgkmcnt(8)
    v_mfma_f32_16x16x32_bf16 v[64:67], v[224:227], v[32:35], v[64:67]
    v_mfma_f32_16x16x32_bf16 v[96:99], v[224:227], v[40:43], v[96:99]
    v_mfma_f32_16x16x32_bf16 v[128:131], v[224:227], v[48:51], v[128:131]
    ds_read_b64_tr_b16 v[212:213], v238 offset:49152
    ds_read_b64_tr_b16 v[214:215], v238 offset:53248
    s_waitcnt lgkmcnt(8)
    v_mfma_f32_16x16x32_bf16 v[68:71], v[196:199], v[28:31], v[68:71]
    v_mfma_f32_16x16x32_bf16 v[100:103], v[196:199], v[36:39], v[100:103]
    v_mfma_f32_16x16x32_bf16 v[132:135], v[196:199], v[44:47], v[132:135]
    ds_read_b64_tr_b16 v[216:217], v238 offset:57344
    ds_read_b64_tr_b16 v[218:219], v238 offset:61440
    s_waitcnt lgkmcnt(8)
    v_mfma_f32_16x16x32_bf16 v[68:71], v[200:203], v[32:35], v[68:71]
    v_mfma_f32_16x16x32_bf16 v[100:103], v[200:203], v[40:43], v[100:103]
    v_mfma_f32_16x16x32_bf16 v[132:135], v[200:203], v[48:51], v[132:135]
    ds_read_b64_tr_b16 v[220:221], v239 offset:49152
    ds_read_b64_tr_b16 v[222:223], v239 offset:53248
    s_waitcnt lgkmcnt(8)
    v_mfma_f32_16x16x32_bf16 v[72:75], v[204:207], v[28:31], v[72:75]
    v_mfma_f32_16x16x32_bf16 v[104:107], v[204:207], v[36:39], v[104:107]
    v_mfma_f32_16x16x32_bf16 v[136:139], v[204:207], v[44:47], v[136:139]
    ds_read_b64_tr_b16 v[224:225], v239 offset:57344
    ds_read_b64_tr_b16 v[226:227], v239 offset:61440
    s_waitcnt lgkmcnt(8)
    v_mfma_f32_16x16x32_bf16 v[72:75], v[208:211], v[32:35], v[72:75]
    v_mfma_f32_16x16x32_bf16 v[104:107], v[208:211], v[40:43], v[104:107]
    v_mfma_f32_16x16x32_bf16 v[136:139], v[208:211], v[48:51], v[136:139]
    s_waitcnt lgkmcnt(6)
    v_mfma_f32_16x16x32_bf16 v[76:79], v[212:215], v[28:31], v[76:79]
    v_mfma_f32_16x16x32_bf16 v[108:111], v[212:215], v[36:39], v[108:111]
    v_mfma_f32_16x16x32_bf16 v[140:143], v[212:215], v[44:47], v[140:143]
    s_waitcnt lgkmcnt(4)
    v_mfma_f32_16x16x32_bf16 v[76:79], v[216:219], v[32:35], v[76:79]
    v_mfma_f32_16x16x32_bf16 v[108:111], v[216:219], v[40:43], v[108:111]
    v_mfma_f32_16x16x32_bf16 v[140:143], v[216:219], v[48:51], v[140:143]
    s_waitcnt lgkmcnt(2)
    v_mfma_f32_16x16x32_bf16 v[80:83], v[220:223], v[28:31], v[80:83]
    v_mfma_f32_16x16x32_bf16 v[112:115], v[220:223], v[36:39], v[112:115]
    v_mfma_f32_16x16x32_bf16 v[144:147], v[220:223], v[44:47], v[144:147]
    s_waitcnt lgkmcnt(0)
    v_mfma_f32_16x16x32_bf16 v[80:83], v[224:227], v[32:35], v[80:83]
    v_mfma_f32_16x16x32_bf16 v[112:115], v[224:227], v[40:43], v[112:115]
    v_mfma_f32_16x16x32_bf16 v[144:147], v[224:227], v[48:51], v[144:147]
    s_waitcnt vmcnt(8)
    s_barrier
    s_lshl_b32 s39, s28, 12
    v_add_u32 v255, s39, v3
    v_add_u32 v251, s39, v228
    v_add_u32 v252, s39, v229
    v_add_u32 v253, s39, v230
    v_add_u32 v254, s39, v231
    v_cvt_pk_bf16_f32 v196, v52, v53
    v_cvt_pk_bf16_f32 v197, v54, v55
    v_xor_b32 v249, 0, v255
    ds_write_b64 v249, v[196:197] offset:49152
    v_cvt_pk_bf16_f32 v198, v56, v57
    v_cvt_pk_bf16_f32 v199, v58, v59
    v_xor_b32 v249, 32, v255
    ds_write_b64 v249, v[198:199] offset:49152
    v_cvt_pk_bf16_f32 v200, v60, v61
    v_cvt_pk_bf16_f32 v201, v62, v63
    v_xor_b32 v249, 64, v255
    ds_write_b64 v249, v[200:201] offset:49152
    v_cvt_pk_bf16_f32 v202, v64, v65
    v_cvt_pk_bf16_f32 v203, v66, v67
    v_xor_b32 v249, 96, v255
    ds_write_b64 v249, v[202:203] offset:49152
    v_cvt_pk_bf16_f32 v204, v68, v69
    v_cvt_pk_bf16_f32 v205, v70, v71
    v_xor_b32 v249, 128, v255
    ds_write_b64 v249, v[204:205] offset:49152
    v_cvt_pk_bf16_f32 v206, v72, v73
    v_cvt_pk_bf16_f32 v207, v74, v75
    v_xor_b32 v249, 160, v255
    ds_write_b64 v249, v[206:207] offset:49152
    v_cvt_pk_bf16_f32 v208, v76, v77
    v_cvt_pk_bf16_f32 v209, v78, v79
    v_xor_b32 v249, 192, v255
    ds_write_b64 v249, v[208:209] offset:49152
    v_cvt_pk_bf16_f32 v210, v80, v81
    v_cvt_pk_bf16_f32 v211, v82, v83
    v_xor_b32 v249, 224, v255
    ds_write_b64 v249, v[210:211] offset:49152
    s_waitcnt lgkmcnt(0)
    ds_read_b128 v[4:7], v251 offset:49152
    ds_read_b128 v[8:11], v252 offset:49152
    ds_read_b128 v[12:15], v253 offset:49152
    ds_read_b128 v[16:19], v254 offset:49152
    s_waitcnt lgkmcnt(0)
    v_cvt_pk_bf16_f32 v196, v84, v85
    v_cvt_pk_bf16_f32 v197, v86, v87
    v_xor_b32 v249, 0, v255
    ds_write_b64 v249, v[196:197] offset:49152
    v_cvt_pk_bf16_f32 v198, v88, v89
    v_cvt_pk_bf16_f32 v199, v90, v91
    v_xor_b32 v249, 32, v255
    ds_write_b64 v249, v[198:199] offset:49152
    v_cvt_pk_bf16_f32 v200, v92, v93
    v_cvt_pk_bf16_f32 v201, v94, v95
    v_xor_b32 v249, 64, v255
    ds_write_b64 v249, v[200:201] offset:49152
    v_cvt_pk_bf16_f32 v202, v96, v97
    v_cvt_pk_bf16_f32 v203, v98, v99
    v_xor_b32 v249, 96, v255
    ds_write_b64 v249, v[202:203] offset:49152
    v_cvt_pk_bf16_f32 v204, v100, v101
    v_cvt_pk_bf16_f32 v205, v102, v103
    v_xor_b32 v249, 128, v255
    ds_write_b64 v249, v[204:205] offset:49152
    v_cvt_pk_bf16_f32 v206, v104, v105
    v_cvt_pk_bf16_f32 v207, v106, v107
    v_xor_b32 v249, 160, v255
    ds_write_b64 v249, v[206:207] offset:49152
    v_cvt_pk_bf16_f32 v208, v108, v109
    v_cvt_pk_bf16_f32 v209, v110, v111
    v_xor_b32 v249, 192, v255
    ds_write_b64 v249, v[208:209] offset:49152
    v_cvt_pk_bf16_f32 v210, v112, v113
    v_cvt_pk_bf16_f32 v211, v114, v115
    v_xor_b32 v249, 224, v255
    ds_write_b64 v249, v[210:211] offset:49152
    s_waitcnt lgkmcnt(0)
    ds_read_b128 v[20:23], v251 offset:49152
    ds_read_b128 v[24:27], v252 offset:49152
    ds_read_b128 v[28:31], v253 offset:49152
    ds_read_b128 v[32:35], v254 offset:49152
    s_waitcnt lgkmcnt(0)
    v_cvt_pk_bf16_f32 v196, v116, v117
    v_cvt_pk_bf16_f32 v197, v118, v119
    v_xor_b32 v249, 0, v255
    ds_write_b64 v249, v[196:197] offset:49152
    v_cvt_pk_bf16_f32 v198, v120, v121
    v_cvt_pk_bf16_f32 v199, v122, v123
    v_xor_b32 v249, 32, v255
    ds_write_b64 v249, v[198:199] offset:49152
    v_cvt_pk_bf16_f32 v200, v124, v125
    v_cvt_pk_bf16_f32 v201, v126, v127
    v_xor_b32 v249, 64, v255
    ds_write_b64 v249, v[200:201] offset:49152
    v_cvt_pk_bf16_f32 v202, v128, v129
    v_cvt_pk_bf16_f32 v203, v130, v131
    v_xor_b32 v249, 96, v255
    ds_write_b64 v249, v[202:203] offset:49152
    v_cvt_pk_bf16_f32 v204, v132, v133
    v_cvt_pk_bf16_f32 v205, v134, v135
    v_xor_b32 v249, 128, v255
    ds_write_b64 v249, v[204:205] offset:49152
    v_cvt_pk_bf16_f32 v206, v136, v137
    v_cvt_pk_bf16_f32 v207, v138, v139
    v_xor_b32 v249, 160, v255
    ds_write_b64 v249, v[206:207] offset:49152
    v_cvt_pk_bf16_f32 v208, v140, v141
    v_cvt_pk_bf16_f32 v209, v142, v143
    v_xor_b32 v249, 192, v255
    ds_write_b64 v249, v[208:209] offset:49152
    v_cvt_pk_bf16_f32 v210, v144, v145
    v_cvt_pk_bf16_f32 v211, v146, v147
    v_xor_b32 v249, 224, v255
    ds_write_b64 v249, v[210:211] offset:49152
    s_waitcnt lgkmcnt(0)
    ds_read_b128 v[36:39], v251 offset:49152
    ds_read_b128 v[40:43], v252 offset:49152
    ds_read_b128 v[44:47], v253 offset:49152
    ds_read_b128 v[48:51], v254 offset:49152
    s_waitcnt lgkmcnt(0)
    v_mov_b32 v52, 0
    v_mov_b32 v53, 0
    v_mov_b32 v54, 0
    v_mov_b32 v55, 0
    v_mov_b32 v56, 0
    v_mov_b32 v57, 0
    v_mov_b32 v58, 0
    v_mov_b32 v59, 0
    v_mov_b32 v60, 0
    v_mov_b32 v61, 0
    v_mov_b32 v62, 0
    v_mov_b32 v63, 0
    v_mov_b32 v64, 0
    v_mov_b32 v65, 0
    v_mov_b32 v66, 0
    v_mov_b32 v67, 0
    v_mov_b32 v68, 0
    v_mov_b32 v69, 0
    v_mov_b32 v70, 0
    v_mov_b32 v71, 0
    v_mov_b32 v72, 0
    v_mov_b32 v73, 0
    v_mov_b32 v74, 0
    v_mov_b32 v75, 0
    v_mov_b32 v76, 0
    v_mov_b32 v77, 0
    v_mov_b32 v78, 0
    v_mov_b32 v79, 0
    v_mov_b32 v80, 0
    v_mov_b32 v81, 0
    v_mov_b32 v82, 0
    v_mov_b32 v83, 0
    v_mov_b32 v84, 0
    v_mov_b32 v85, 0
    v_mov_b32 v86, 0
    v_mov_b32 v87, 0
    v_mov_b32 v88, 0
    v_mov_b32 v89, 0
    v_mov_b32 v90, 0
    v_mov_b32 v91, 0
    v_mov_b32 v92, 0
    v_mov_b32 v93, 0
    v_mov_b32 v94, 0
    v_mov_b32 v95, 0
    v_mov_b32 v96, 0
    v_mov_b32 v97, 0
    v_mov_b32 v98, 0
    v_mov_b32 v99, 0
    v_mov_b32 v100, 0
    v_mov_b32 v101, 0
    v_mov_b32 v102, 0
    v_mov_b32 v103, 0
    v_mov_b32 v104, 0
    v_mov_b32 v105, 0
    v_mov_b32 v106, 0
    v_mov_b32 v107, 0
    v_mov_b32 v108, 0
    v_mov_b32 v109, 0
    v_mov_b32 v110, 0
    v_mov_b32 v111, 0
    v_mov_b32 v112, 0
    v_mov_b32 v113, 0
    v_mov_b32 v114, 0
    v_mov_b32 v115, 0
    v_mov_b32 v116, 0
    v_mov_b32 v117, 0
    v_mov_b32 v118, 0
    v_mov_b32 v119, 0
    v_mov_b32 v120, 0
    v_mov_b32 v121, 0
    v_mov_b32 v122, 0
    v_mov_b32 v123, 0
    v_mov_b32 v124, 0
    v_mov_b32 v125, 0
    v_mov_b32 v126, 0
    v_mov_b32 v127, 0
    v_mov_b32 v128, 0
    v_mov_b32 v129, 0
    v_mov_b32 v130, 0
    v_mov_b32 v131, 0
    v_mov_b32 v132, 0
    v_mov_b32 v133, 0
    v_mov_b32 v134, 0
    v_mov_b32 v135, 0
    v_mov_b32 v136, 0
    v_mov_b32 v137, 0
    v_mov_b32 v138, 0
    v_mov_b32 v139, 0
    v_mov_b32 v140, 0
    v_mov_b32 v141, 0
    v_mov_b32 v142, 0
    v_mov_b32 v143, 0
    v_mov_b32 v144, 0
    v_mov_b32 v145, 0
    v_mov_b32 v146, 0
    v_mov_b32 v147, 0
    s_mov_b32 s34, 0
L_attn_loop:
    s_waitcnt vmcnt(8)
    s_barrier
    s_add_u32 m0, s38, 49152
    s_add_u32 s31, s33, 0
    buffer_load_dwordx4 v241, s[20:23], s31 offen nt lds
    s_add_u32 m0, s38, 53248
    s_add_u32 s31, s33, 4096
    buffer_load_dwordx4 v241, s[20:23], s31 offen nt lds
    s_add_u32 m0, s38, 57344
    s_add_u32 s31, s33, 8192
    buffer_load_dwordx4 v241, s[20:23], s31 offen nt lds
    s_add_u32 m0, s38, 61440
    s_add_u32 s31, s33, 12288
    buffer_load_dwordx4 v241, s[20:23], s31 offen nt lds
    s_add_u32 s33, s33, 16384
    ds_read_b128 v[196:199], v228 offset:0
    ds_read_b128 v[200:203], v229 offset:0
    ds_read_b128 v[204:207], v230 offset:0
    ds_read_b128 v[208:211], v231 offset:0
    ds_read_b128 v[212:215], v228 offset:4096
    ds_read_b128 v[216:219], v229 offset:4096
    ds_read_b128 v[220:223], v230 offset:4096
    ds_read_b128 v[224:227], v231 offset:4096
    s_waitcnt lgkmcnt(4)
    v_mfma_f32_16x16x32_bf16 v[148:151], v[196:199], v[4:7], 0
    v_mfma_f32_16x16x32_bf16 v[152:155], v[196:199], v[20:23], 0
    v_mfma_f32_16x16x32_bf16 v[156:159], v[196:199], v[36:39], 0
    v_mfma_f32_16x16x32_bf16 v[148:151], v[200:203], v[8:11], v[148:151]
    v_mfma_f32_16x16x32_bf16 v[152:155], v[200:203], v[24:27], v[152:155]
    v_mfma_f32_16x16x32_bf16 v[156:159], v[200:203], v[40:43], v[156:159]
    v_mfma_f32_16x16x32_bf16 v[148:151], v[204:207], v[12:15], v[148:151]
    v_mfma_f32_16x16x32_bf16 v[152:155], v[204:207], v[28:31], v[152:155]
    v_mfma_f32_16x16x32_bf16 v[156:159], v[204:207], v[44:47], v[156:159]
    v_mfma_f32_16x16x32_bf16 v[148:151], v[208:211], v[16:19], v[148:151]
    v_mfma_f32_16x16x32_bf16 v[152:155], v[208:211], v[32:35], v[152:155]
    v_mfma_f32_16x16x32_bf16 v[156:159], v[208:211], v[48:51], v[156:159]
    ds_read_b128 v[196:199], v228 offset:8192
    ds_read_b128 v[200:203], v229 offset:8192
    ds_read_b128 v[204:207], v230 offset:8192
    ds_read_b128 v[208:211], v231 offset:8192
    s_waitcnt lgkmcnt(4)
    v_mfma_f32_16x16x32_bf16 v[160:163], v[212:215], v[4:7], 0
    v_mfma_f32_16x16x32_bf16 v[164:167], v[212:215], v[20:23], 0
    v_mfma_f32_16x16x32_bf16 v[168:171], v[212:215], v[36:39], 0
    v_mfma_f32_16x16x32_bf16 v[160:163], v[216:219], v[8:11], v[160:163]
    v_mfma_f32_16x16x32_bf16 v[164:167], v[216:219], v[24:27], v[164:167]
    v_mfma_f32_16x16x32_bf16 v[168:171], v[216:219], v[40:43], v[168:171]
    v_mfma_f32_16x16x32_bf16 v[160:163], v[220:223], v[12:15], v[160:163]
    v_mfma_f32_16x16x32_bf16 v[164:167], v[220:223], v[28:31], v[164:167]
    v_mfma_f32_16x16x32_bf16 v[168:171], v[220:223], v[44:47], v[168:171]
    v_mfma_f32_16x16x32_bf16 v[160:163], v[224:227], v[16:19], v[160:163]
    v_mfma_f32_16x16x32_bf16 v[164:167], v[224:227], v[32:35], v[164:167]
    v_mfma_f32_16x16x32_bf16 v[168:171], v[224:227], v[48:51], v[168:171]
    ds_read_b128 v[212:215], v228 offset:12288
    ds_read_b128 v[216:219], v229 offset:12288
    ds_read_b128 v[220:223], v230 offset:12288
    ds_read_b128 v[224:227], v231 offset:12288
    s_waitcnt lgkmcnt(4)
    v_mfma_f32_16x16x32_bf16 v[172:175], v[196:199], v[4:7], 0
    v_mfma_f32_16x16x32_bf16 v[176:179], v[196:199], v[20:23], 0
    v_mfma_f32_16x16x32_bf16 v[180:183], v[196:199], v[36:39], 0
    v_mfma_f32_16x16x32_bf16 v[172:175], v[200:203], v[8:11], v[172:175]
    v_mfma_f32_16x16x32_bf16 v[176:179], v[200:203], v[24:27], v[176:179]
    v_mfma_f32_16x16x32_bf16 v[180:183], v[200:203], v[40:43], v[180:183]
    v_mfma_f32_16x16x32_bf16 v[172:175], v[204:207], v[12:15], v[172:175]
    v_mfma_f32_16x16x32_bf16 v[176:179], v[204:207], v[28:31], v[176:179]
    v_mfma_f32_16x16x32_bf16 v[180:183], v[204:207], v[44:47], v[180:183]
    v_mfma_f32_16x16x32_bf16 v[172:175], v[208:211], v[16:19], v[172:175]
    v_mfma_f32_16x16x32_bf16 v[176:179], v[208:211], v[32:35], v[176:179]
    v_mfma_f32_16x16x32_bf16 v[180:183], v[208:211], v[48:51], v[180:183]
    s_waitcnt lgkmcnt(0)
    v_mfma_f32_16x16x32_bf16 v[184:187], v[212:215], v[4:7], 0
    v_mfma_f32_16x16x32_bf16 v[188:191], v[212:215], v[20:23], 0
    v_mfma_f32_16x16x32_bf16 v[192:195], v[212:215], v[36:39], 0
    v_mfma_f32_16x16x32_bf16 v[184:187], v[216:219], v[8:11], v[184:187]
    v_mfma_f32_16x16x32_bf16 v[188:191], v[216:219], v[24:27], v[188:191]
    v_mfma_f32_16x16x32_bf16 v[192:195], v[216:219], v[40:43], v[192:195]
    v_mfma_f32_16x16x32_bf16 v[184:187], v[220:223], v[12:15], v[184:187]
    v_mfma_f32_16x16x32_bf16 v[188:191], v[220:223], v[28:31], v[188:191]
    v_mfma_f32_16x16x32_bf16 v[192:195], v[220:223], v[44:47], v[192:195]
    v_mfma_f32_16x16x32_bf16 v[184:187], v[224:227], v[16:19], v[184:187]
    v_mfma_f32_16x16x32_bf16 v[188:191], v[224:227], v[32:35], v[188:191]
    v_mfma_f32_16x16x32_bf16 v[192:195], v[224:227], v[48:51], v[192:195]
    s_waitcnt vmcnt(8)
    s_barrier
    s_add_u32 m0, s38, 0
    s_add_u32 s31, s32, 0
    buffer_load_dwordx4 v240, s[16:19], s31 offen nt lds
    s_add_u32 m0, s38, 4096
    s_add_u32 s31, s32, 4096
    buffer_load_dwordx4 v240, s[16:19], s31 offen nt lds
    s_add_u32 m0, s38, 8192
    s_add_u32 s31, s32, 8192
    buffer_load_dwordx4 v240, s[16:19], s31 offen nt lds
    s_add_u32 m0, s38, 12288
    s_add_u32 s31, s32, 12288
    buffer_load_dwordx4 v240, s[16:19], s31 offen nt lds
    s_add_u32 s32, s32, 16384
    s_nop 7
    v_max3_f32 v249, v148, v149, v150
    v_max3_f32 v250, v152, v153, v154
    v_max3_f32 v251, v156, v157, v158
    v_max3_f32 v249, v249, v151, v160
    v_max3_f32 v250, v250, v155, v164
    v_max3_f32 v251, v251, v159, v168
    v_max3_f32 v249, v249, v161, v162
    v_max3_f32 v250, v250, v165, v166
    v_max3_f32 v251, v251, v169, v170
    v_max3_f32 v249, v249, v163, v172
    v_max3_f32 v250, v250, v167, v176
    v_max3_f32 v251, v251, v171, v180
    v_max3_f32 v249, v249, v173, v174
    v_max3_f32 v250, v250, v177, v178
    v_max3_f32 v251, v251, v181, v182
    v_max3_f32 v249, v249, v175, v184
    v_max3_f32 v250, v250, v179, v188
    v_max3_f32 v251, v251, v183, v192
    v_max3_f32 v249, v249, v185, v186
    v_max3_f32 v250, v250, v189, v190
    v_max3_f32 v251, v251, v193, v194
    v_max_f32 v249, v249, v187
    v_max_f32 v250, v250, v191
    v_max_f32 v251, v251, v195
    v_mov_b32 v252, v249
    v_mov_b32 v253, v250
    v_mov_b32 v254, v251
    s_nop 0
    v_permlane32_swap_b32 v249, v252
    v_permlane32_swap_b32 v250, v253
    v_permlane32_swap_b32 v251, v254
    v_max_f32 v249, v249, v252
    v_max_f32 v250, v250, v253
    v_max_f32 v251, v251, v254
    v_mov_b32 v252, v249
    v_mov_b32 v253, v250
    v_mov_b32 v254, v251
    s_nop 0
    v_permlane16_swap_b32 v249, v252
    v_permlane16_swap_b32 v250, v253
    v_permlane16_swap_b32 v251, v254
    v_max_f32 v249, v249, v252
    v_max_f32 v250, v250, v253
    v_max_f32 v251, v251, v254
    v_mul_f32 v249, s29, v249
    v_mul_f32 v250, s29, v250
    v_mul_f32 v251, s29, v251
    v_sub_f32 v252, v249, v243
    v_sub_f32 v253, v250, v244
    v_sub_f32 v254, v251, v245
    v_max3_f32 v255, v252, v253, v254
    v_cmp_lt_f32 vcc, s30, v255
    s_cbranch_vccz L_norescale_a
    v_max_f32 v249, v249, v243
    v_max_f32 v250, v250, v244
    v_max_f32 v251, v251, v245
    v_sub_f32 v252, v243, v249
    v_sub_f32 v253, v244, v250
    v_sub_f32 v254, v245, v251
    v_exp_f32 v252, v252
    v_exp_f32 v253, v253
    v_exp_f32 v254, v254
    v_mov_b32 v243, v249
    v_mov_b32 v244, v250
    v_mov_b32 v245, v251
    v_mul_f32 v246, v246, v252
    v_mul_f32 v247, v247, v253
    v_mul_f32 v248, v248, v254
    v_mul_f32 v52, v52, v252
    v_mul_f32 v53, v53, v252
    v_mul_f32 v54, v54, v252
    v_mul_f32 v55, v55, v252
    v_mul_f32 v56, v56, v252
    v_mul_f32 v57, v57, v252
    v_mul_f32 v58, v58, v252
    v_mul_f32 v59, v59, v252
    v_mul_f32 v60, v60, v252
    v_mul_f32 v61, v61, v252
    v_mul_f32 v62, v62, v252
    v_mul_f32 v63, v63, v252
    v_mul_f32 v64, v64, v252
    v_mul_f32 v65, v65, v252
    v_mul_f32 v66, v66, v252
    v_mul_f32 v67, v67, v252
    v_mul_f32 v68, v68, v252
    v_mul_f32 v69, v69, v252
    v_mul_f32 v70, v70, v252
    v_mul_f32 v71, v71, v252
    v_mul_f32 v72, v72, v252
    v_mul_f32 v73, v73, v252
    v_mul_f32 v74, v74, v252
    v_mul_f32 v75, v75, v252
    v_mul_f32 v76, v76, v252
    v_mul_f32 v77, v77, v252
    v_mul_f32 v78, v78, v252
    v_mul_f32 v79, v79, v252
    v_mul_f32 v80, v80, v252
    v_mul_f32 v81, v81, v252
    v_mul_f32 v82, v82, v252
    v_mul_f32 v83, v83, v252
    v_mul_f32 v84, v84, v253
    v_mul_f32 v85, v85, v253
    v_mul_f32 v86, v86, v253
    v_mul_f32 v87, v87, v253
    v_mul_f32 v88, v88, v253
    v_mul_f32 v89, v89, v253
    v_mul_f32 v90, v90, v253
    v_mul_f32 v91, v91, v253
    v_mul_f32 v92, v92, v253
    v_mul_f32 v93, v93, v253
    v_mul_f32 v94, v94, v253
    v_mul_f32 v95, v95, v253
    v_mul_f32 v96, v96, v253
    v_mul_f32 v97, v97, v253
    v_mul_f32 v98, v98, v253
    v_mul_f32 v99, v99, v253
    v_mul_f32 v100, v100, v253
    v_mul_f32 v101, v101, v253
    v_mul_f32 v102, v102, v253
    v_mul_f32 v103, v103, v253
    v_mul_f32 v104, v104, v253
    v_mul_f32 v105, v105, v253
    v_mul_f32 v106, v106, v253
    v_mul_f32 v107, v107, v253
    v_mul_f32 v108, v108, v253
    v_mul_f32 v109, v109, v253
    v_mul_f32 v110, v110, v253
    v_mul_f32 v111, v111, v253
    v_mul_f32 v112, v112, v253
    v_mul_f32 v113, v113, v253
    v_mul_f32 v114, v114, v253
    v_mul_f32 v115, v115, v253
    v_mul_f32 v116, v116, v254
    v_mul_f32 v117, v117, v254
    v_mul_f32 v118, v118, v254
    v_mul_f32 v119, v119, v254
    v_mul_f32 v120, v120, v254
    v_mul_f32 v121, v121, v254
    v_mul_f32 v122, v122, v254
    v_mul_f32 v123, v123, v254
    v_mul_f32 v124, v124, v254
    v_mul_f32 v125, v125, v254
    v_mul_f32 v126, v126, v254
    v_mul_f32 v127, v127, v254
    v_mul_f32 v128, v128, v254
    v_mul_f32 v129, v129, v254
    v_mul_f32 v130, v130, v254
    v_mul_f32 v131, v131, v254
    v_mul_f32 v132, v132, v254
    v_mul_f32 v133, v133, v254
    v_mul_f32 v134, v134, v254
    v_mul_f32 v135, v135, v254
    v_mul_f32 v136, v136, v254
    v_mul_f32 v137, v137, v254
    v_mul_f32 v138, v138, v254
    v_mul_f32 v139, v139, v254
    v_mul_f32 v140, v140, v254
    v_mul_f32 v141, v141, v254
    v_mul_f32 v142, v142, v254
    v_mul_f32 v143, v143, v254
    v_mul_f32 v144, v144, v254
    v_mul_f32 v145, v145, v254
    v_mul_f32 v146, v146, v254
    v_mul_f32 v147, v147, v254
L_norescale_a:
    v_fma_f32 v148, v148, s29, -v243
    v_fma_f32 v149, v149, s29, -v243
    v_fma_f32 v150, v150, s29, -v243
    v_fma_f32 v151, v151, s29, -v243
    v_fma_f32 v152, v152, s29, -v244
    v_fma_f32 v153, v153, s29, -v244
    v_fma_f32 v154, v154, s29, -v244
    v_fma_f32 v155, v155, s29, -v244
    v_fma_f32 v156, v156, s29, -v245
    v_fma_f32 v157, v157, s29, -v245
    v_fma_f32 v158, v158, s29, -v245
    v_fma_f32 v159, v159, s29, -v245
    v_exp_f32 v148, v148
    v_exp_f32 v149, v149
    v_exp_f32 v150, v150
    v_exp_f32 v151, v151
    v_exp_f32 v152, v152
    v_exp_f32 v153, v153
    v_exp_f32 v154, v154
    v_exp_f32 v155, v155
    v_exp_f32 v156, v156
    v_exp_f32 v157, v157
    v_exp_f32 v158, v158
    v_exp_f32 v159, v159
    v_add_f32 v246, v246, v148
    v_add_f32 v247, v247, v152
    v_add_f32 v248, v248, v156
    v_add_f32 v246, v246, v149
    v_add_f32 v247, v247, v153
    v_add_f32 v248, v248, v157
    v_add_f32 v246, v246, v150
    v_add_f32 v247, v247, v154
    v_add_f32 v248, v248, v158
    v_add_f32 v246, v246, v151
    v_add_f32 v247, v247, v155
    v_add_f32 v248, v248, v159
    v_fma_f32 v160, v160, s29, -v243
    v_fma_f32 v161, v161, s29, -v243
    v_fma_f32 v162, v162, s29, -v243
    v_fma_f32 v163, v163, s29, -v243
    v_fma_f32 v164, v164, s29, -v244
    v_fma_f32 v165, v165, s29, -v244
    v_fma_f32 v166, v166, s29, -v244
    v_fma_f32 v167, v167, s29, -v244
    v_fma_f32 v168, v168, s29, -v245
    v_fma_f32 v169, v169, s29, -v245
    v_fma_f32 v170, v170, s29, -v245
    v_fma_f32 v171, v171, s29, -v245
    v_exp_f32 v160, v160
    v_exp_f32 v161, v161
    v_exp_f32 v162, v162
    v_exp_f32 v163, v163
    v_exp_f32 v164, v164
    v_exp_f32 v165, v165
    v_exp_f32 v166, v166
    v_exp_f32 v167, v167
    v_exp_f32 v168, v168
    v_exp_f32 v169, v169
    v_exp_f32 v170, v170
    v_exp_f32 v171, v171
    v_add_f32 v246, v246, v160
    v_add_f32 v247, v247, v164
    v_add_f32 v248, v248, v168
    v_add_f32 v246, v246, v161
    v_add_f32 v247, v247, v165
    v_add_f32 v248, v248, v169
    v_add_f32 v246, v246, v162
    v_add_f32 v247, v247, v166
    v_add_f32 v248, v248, v170
    v_add_f32 v246, v246, v163
    v_add_f32 v247, v247, v167
    v_add_f32 v248, v248, v171
    v_fma_f32 v172, v172, s29, -v243
    v_fma_f32 v173, v173, s29, -v243
    v_fma_f32 v174, v174, s29, -v243
    v_fma_f32 v175, v175, s29, -v243
    v_fma_f32 v176, v176, s29, -v244
    v_fma_f32 v177, v177, s29, -v244
    v_fma_f32 v178, v178, s29, -v244
    v_fma_f32 v179, v179, s29, -v244
    v_fma_f32 v180, v180, s29, -v245
    v_fma_f32 v181, v181, s29, -v245
    v_fma_f32 v182, v182, s29, -v245
    v_fma_f32 v183, v183, s29, -v245
    v_exp_f32 v172, v172
    v_exp_f32 v173, v173
    v_exp_f32 v174, v174
    v_exp_f32 v175, v175
    v_exp_f32 v176, v176
    v_exp_f32 v177, v177
    v_exp_f32 v178, v178
    v_exp_f32 v179, v179
    v_exp_f32 v180, v180
    v_exp_f32 v181, v181
    v_exp_f32 v182, v182
    v_exp_f32 v183, v183
    v_add_f32 v246, v246, v172
    v_add_f32 v247, v247, v176
    v_add_f32 v248, v248, v180
    v_add_f32 v246, v246, v173
    v_add_f32 v247, v247, v177
    v_add_f32 v248, v248, v181
    v_add_f32 v246, v246, v174
    v_add_f32 v247, v247, v178
    v_add_f32 v248, v248, v182
    v_add_f32 v246, v246, v175
    v_add_f32 v247, v247, v179
    v_add_f32 v248, v248, v183
    v_fma_f32 v184, v184, s29, -v243
    v_fma_f32 v185, v185, s29, -v243
    v_fma_f32 v186, v186, s29, -v243
    v_fma_f32 v187, v187, s29, -v243
    v_fma_f32 v188, v188, s29, -v244
    v_fma_f32 v189, v189, s29, -v244
    v_fma_f32 v190, v190, s29, -v244
    v_fma_f32 v191, v191, s29, -v244
    v_fma_f32 v192, v192, s29, -v245
    v_fma_f32 v193, v193, s29, -v245
    v_fma_f32 v194, v194, s29, -v245
    v_fma_f32 v195, v195, s29, -v245
    v_exp_f32 v184, v184
    v_exp_f32 v185, v185
    v_exp_f32 v186, v186
    v_exp_f32 v187, v187
    v_exp_f32 v188, v188
    v_exp_f32 v189, v189
    v_exp_f32 v190, v190
    v_exp_f32 v191, v191
    v_exp_f32 v192, v192
    v_exp_f32 v193, v193
    v_exp_f32 v194, v194
    v_exp_f32 v195, v195
    v_add_f32 v246, v246, v184
    v_add_f32 v247, v247, v188
    v_add_f32 v248, v248, v192
    v_add_f32 v246, v246, v185
    v_add_f32 v247, v247, v189
    v_add_f32 v248, v248, v193
    v_add_f32 v246, v246, v186
    v_add_f32 v247, v247, v190
    v_add_f32 v248, v248, v194
    v_add_f32 v246, v246, v187
    v_add_f32 v247, v247, v191
    v_add_f32 v248, v248, v195
    v_cvt_pk_bf16_f32 v148, v148, v149
    v_cvt_pk_bf16_f32 v149, v150, v151
    v_cvt_pk_bf16_f32 v150, v160, v161
    v_cvt_pk_bf16_f32 v151, v162, v163
    v_cvt_pk_bf16_f32 v152, v152, v153
    v_cvt_pk_bf16_f32 v153, v154, v155
    v_cvt_pk_bf16_f32 v154, v164, v165
    v_cvt_pk_bf16_f32 v155, v166, v167
    v_cvt_pk_bf16_f32 v156, v156, v157
    v_cvt_pk_bf16_f32 v157, v158, v159
    v_cvt_pk_bf16_f32 v158, v168, v169
    v_cvt_pk_bf16_f32 v159, v170, v171
    v_cvt_pk_bf16_f32 v172, v172, v173
    v_cvt_pk_bf16_f32 v173, v174, v175
    v_cvt_pk_bf16_f32 v174, v184, v185
    v_cvt_pk_bf16_f32 v175, v186, v187
    v_cvt_pk_bf16_f32 v176, v176, v177
    v_cvt_pk_bf16_f32 v177, v178, v179
    v_cvt_pk_bf16_f32 v178, v188, v189
    v_cvt_pk_bf16_f32 v179, v190, v191
    v_cvt_pk_bf16_f32 v180, v180, v181
    v_cvt_pk_bf16_f32 v181, v182, v183
    v_cvt_pk_bf16_f32 v182, v192, v193
    v_cvt_pk_bf16_f32 v183, v194, v195
    s_nop 1
    ds_read_b64_tr_b16 v[196:197], v232 offset:16384
    ds_read_b64_tr_b16 v[198:199], v232 offset:20480
    ds_read_b64_tr_b16 v[200:201], v232 offset:24576
    ds_read_b64_tr_b16 v[202:203], v232 offset:28672
    ds_read_b64_tr_b16 v[204:205], v233 offset:16384
    ds_read_b64_tr_b16 v[206:207], v233 offset:20480
    ds_read_b64_tr_b16 v[208:209], v233 offset:24576
    ds_read_b64_tr_b16 v[210:211], v233 offset:28672
    ds_read_b64_tr_b16 v[212:213], v234 offset:16384
    ds_read_b64_tr_b16 v[214:215], v234 offset:20480
    s_waitcnt lgkmcnt(8)
    v_mfma_f32_16x16x32_bf16 v[52:55], v[196:199], v[148:151], v[52:55]
    v_mfma_f32_16x16x32_bf16 v[84:87], v[196:199], v[152:155], v[84:87]
    v_mfma_f32_16x16x32_bf16 v[116:119], v[196:199], v[156:159], v[116:119]
    ds_read_b64_tr_b16 v[216:217], v234 offset:24576
    ds_read_b64_tr_b16 v[218:219], v234 offset:28672
    s_waitcnt lgkmcnt(8)
    v_mfma_f32_16x16x32_bf16 v[52:55], v[200:203], v[172:175], v[52:55]
    v_mfma_f32_16x16x32_bf16 v[84:87], v[200:203], v[176:179], v[84:87]
    v_mfma_f32_16x16x32_bf16 v[116:119], v[200:203], v[180:183], v[116:119]
    ds_read_b64_tr_b16 v[220:221], v235 offset:16384
    ds_read_b64_tr_b16 v[222:223], v235 offset:20480
    s_waitcnt lgkmcnt(8)
    v_mfma_f32_16x16x32_bf16 v[56:59], v[204:207], v[148:151], v[56:59]
    v_mfma_f32_16x16x32_bf16 v[88:91], v[204:207], v[152:155], v[88:91]
    v_mfma_f32_16x16x32_bf16 v[120:123], v[204:207], v[156:159], v[120:123]
    ds_read_b64_tr_b16 v[224:225], v235 offset:24576
    ds_read_b64_tr_b16 v[226:227], v235 offset:28672
    s_waitcnt lgkmcnt(8)
    v_mfma_f32_16x16x32_bf16 v[56:59], v[208:211], v[172:175], v[56:59]
    v_mfma_f32_16x16x32_bf16 v[88:91], v[208:211], v[176:179], v[88:91]
    v_mfma_f32_16x16x32_bf16 v[120:123], v[208:211], v[180:183], v[120:123]
    ds_read_b64_tr_b16 v[196:197], v236 offset:16384
    ds_read_b64_tr_b16 v[198:199], v236 offset:20480
    s_waitcnt lgkmcnt(8)
    v_mfma_f32_16x16x32_bf16 v[60:63], v[212:215], v[148:151], v[60:63]
    v_mfma_f32_16x16x32_bf16 v[92:95], v[212:215], v[152:155], v[92:95]
    v_mfma_f32_16x16x32_bf16 v[124:127], v[212:215], v[156:159], v[124:127]
    ds_read_b64_tr_b16 v[200:201], v236 offset:24576
    ds_read_b64_tr_b16 v[202:203], v236 offset:28672
    s_waitcnt lgkmcnt(8)
    v_mfma_f32_16x16x32_bf16 v[60:63], v[216:219], v[172:175], v[60:63]
    v_mfma_f32_16x16x32_bf16 v[92:95], v[216:219], v[176:179], v[92:95]
    v_mfma_f32_16x16x32_bf16 v[124:127], v[216:219], v[180:183], v[124:127]
    ds_read_b64_tr_b16 v[204:205], v237 offset:16384
    ds_read_b64_tr_b16 v[206:207], v237 offset:20480
    s_waitcnt lgkmcnt(8)
    v_mfma_f32_16x16x32_bf16 v[64:67], v[220:223], v[148:151], v[64:67]
    v_mfma_f32_16x16x32_bf16 v[96:99], v[220:223], v[152:155], v[96:99]
    v_mfma_f32_16x16x32_bf16 v[128:131], v[220:223], v[156:159], v[128:131]
    ds_read_b64_tr_b16 v[208:209], v237 offset:24576
    ds_read_b64_tr_b16 v[210:211], v237 offset:28672
    s_waitcnt lgkmcnt(8)
    v_mfma_f32_16x16x32_bf16 v[64:67], v[224:227], v[172:175], v[64:67]
    v_mfma_f32_16x16x32_bf16 v[96:99], v[224:227], v[176:179], v[96:99]
    v_mfma_f32_16x16x32_bf16 v[128:131], v[224:227], v[180:183], v[128:131]
    ds_read_b64_tr_b16 v[212:213], v238 offset:16384
    ds_read_b64_tr_b16 v[214:215], v238 offset:20480
    s_waitcnt lgkmcnt(8)
    v_mfma_f32_16x16x32_bf16 v[68:71], v[196:199], v[148:151], v[68:71]
    v_mfma_f32_16x16x32_bf16 v[100:103], v[196:199], v[152:155], v[100:103]
    v_mfma_f32_16x16x32_bf16 v[132:135], v[196:199], v[156:159], v[132:135]
    ds_read_b64_tr_b16 v[216:217], v238 offset:24576
    ds_read_b64_tr_b16 v[218:219], v238 offset:28672
    s_waitcnt lgkmcnt(8)
    v_mfma_f32_16x16x32_bf16 v[68:71], v[200:203], v[172:175], v[68:71]
    v_mfma_f32_16x16x32_bf16 v[100:103], v[200:203], v[176:179], v[100:103]
    v_mfma_f32_16x16x32_bf16 v[132:135], v[200:203], v[180:183], v[132:135]
    ds_read_b64_tr_b16 v[220:221], v239 offset:16384
    ds_read_b64_tr_b16 v[222:223], v239 offset:20480
    s_waitcnt lgkmcnt(8)
    v_mfma_f32_16x16x32_bf16 v[72:75], v[204:207], v[148:151], v[72:75]
    v_mfma_f32_16x16x32_bf16 v[104:107], v[204:207], v[152:155], v[104:107]
    v_mfma_f32_16x16x32_bf16 v[136:139], v[204:207], v[156:159], v[136:139]
    ds_read_b64_tr_b16 v[224:225], v239 offset:24576
    ds_read_b64_tr_b16 v[226:227], v239 offset:28672
    s_waitcnt lgkmcnt(8)
    v_mfma_f32_16x16x32_bf16 v[72:75], v[208:211], v[172:175], v[72:75]
    v_mfma_f32_16x16x32_bf16 v[104:107], v[208:211], v[176:179], v[104:107]
    v_mfma_f32_16x16x32_bf16 v[136:139], v[208:211], v[180:183], v[136:139]
    s_waitcnt lgkmcnt(6)
    v_mfma_f32_16x16x32_bf16 v[76:79], v[212:215], v[148:151], v[76:79]
    v_mfma_f32_16x16x32_bf16 v[108:111], v[212:215], v[152:155], v[108:111]
    v_mfma_f32_16x16x32_bf16 v[140:143], v[212:215], v[156:159], v[140:143]
    s_waitcnt lgkmcnt(4)
    v_mfma_f32_16x16x32_bf16 v[76:79], v[216:219], v[172:175], v[76:79]
    v_mfma_f32_16x16x32_bf16 v[108:111], v[216:219], v[176:179], v[108:111]
    v_mfma_f32_16x16x32_bf16 v[140:143], v[216:219], v[180:183], v[140:143]
    s_waitcnt lgkmcnt(2)
    v_mfma_f32_16x16x32_bf16 v[80:83], v[220:223], v[148:151], v[80:83]
    v_mfma_f32_16x16x32_bf16 v[112:115], v[220:223], v[152:155], v[112:115]
    v_mfma_f32_16x16x32_bf16 v[144:147], v[220:223], v[156:159], v[144:147]
    s_waitcnt lgkmcnt(0)
    v_mfma_f32_16x16x32_bf16 v[80:83], v[224:227], v[172:175], v[80:83]
    v_mfma_f32_16x16x32_bf16 v[112:115], v[224:227], v[176:179], v[112:115]
    v_mfma_f32_16x16x32_bf16 v[144:147], v[224:227], v[180:183], v[144:147]
    s_waitcnt vmcnt(8)
    s_barrier
    s_add_u32 m0, s38, 16384
    s_add_u32 s31, s33, 0
    buffer_load_dwordx4 v241, s[20:23], s31 offen nt lds
    s_add_u32 m0, s38, 20480
    s_add_u32 s31, s33, 4096
    buffer_load_dwordx4 v241, s[20:23], s31 offen nt lds
    s_add_u32 m0, s38, 24576
    s_add_u32 s31, s33, 8192
    buffer_load_dwordx4 v241, s[20:23], s31 offen nt lds
    s_add_u32 m0, s38, 28672
    s_add_u32 s31, s33, 12288
    buffer_load_dwordx4 v241, s[20:23], s31 offen nt lds
    s_add_u32 s33, s33, 16384
    ds_read_b128 v[196:199], v228 offset:32768
    ds_read_b128 v[200:203], v229 offset:32768
    ds_read_b128 v[204:207], v230 offset:32768
    ds_read_b128 v[208:211], v231 offset:32768
    ds_read_b128 v[212:215], v228 offset:36864
    ds_read_b128 v[216:219], v229 offset:36864
    ds_read_b128 v[220:223], v230 offset:36864
    ds_read_b128 v[224:227], v231 offset:36864
    s_waitcnt lgkmcnt(4)
    v_mfma_f32_16x16x32_bf16 v[148:151], v[196:199], v[4:7], 0
    v_mfma_f32_16x16x32_bf16 v[152:155], v[196:199], v[20:23], 0
    v_mfma_f32_16x16x32_bf16 v[156:159], v[196:199], v[36:39], 0
    v_mfma_f32_16x16x32_bf16 v[148:151], v[200:203], v[8:11], v[148:151]
    v_mfma_f32_16x16x32_bf16 v[152:155], v[200:203], v[24:27], v[152:155]
    v_mfma_f32_16x16x32_bf16 v[156:159], v[200:203], v[40:43], v[156:159]
    v_mfma_f32_16x16x32_bf16 v[148:151], v[204:207], v[12:15], v[148:151]
    v_mfma_f32_16x16x32_bf16 v[152:155], v[204:207], v[28:31], v[152:155]
    v_mfma_f32_16x16x32_bf16 v[156:159], v[204:207], v[44:47], v[156:159]
    v_mfma_f32_16x16x32_bf16 v[148:151], v[208:211], v[16:19], v[148:151]
    v_mfma_f32_16x16x32_bf16 v[152:155], v[208:211], v[32:35], v[152:155]
    v_mfma_f32_16x16x32_bf16 v[156:159], v[208:211], v[48:51], v[156:159]
    ds_read_b128 v[196:199], v228 offset:40960
    ds_read_b128 v[200:203], v229 offset:40960
    ds_read_b128 v[204:207], v230 offset:40960
    ds_read_b128 v[208:211], v231 offset:40960
    s_waitcnt lgkmcnt(4)
    v_mfma_f32_16x16x32_bf16 v[160:163], v[212:215], v[4:7], 0
    v_mfma_f32_16x16x32_bf16 v[164:167], v[212:215], v[20:23], 0
    v_mfma_f32_16x16x32_bf16 v[168:171], v[212:215], v[36:39], 0
    v_mfma_f32_16x16x32_bf16 v[160:163], v[216:219], v[8:11], v[160:163]
    v_mfma_f32_16x16x32_bf16 v[164:167], v[216:219], v[24:27], v[164:167]
    v_mfma_f32_16x16x32_bf16 v[168:171], v[216:219], v[40:43], v[168:171]
    v_mfma_f32_16x16x32_bf16 v[160:163], v[220:223], v[12:15], v[160:163]
    v_mfma_f32_16x16x32_bf16 v[164:167], v[220:223], v[28:31], v[164:167]
    v_mfma_f32_16x16x32_bf16 v[168:171], v[220:223], v[44:47], v[168:171]
    v_mfma_f32_16x16x32_bf16 v[160:163], v[224:227], v[16:19], v[160:163]
    v_mfma_f32_16x16x32_bf16 v[164:167], v[224:227], v[32:35], v[164:167]
    v_mfma_f32_16x16x32_bf16 v[168:171], v[224:227], v[48:51], v[168:171]
    ds_read_b128 v[212:215], v228 offset:45056
    ds_read_b128 v[216:219], v229 offset:45056
    ds_read_b128 v[220:223], v230 offset:45056
    ds_read_b128 v[224:227], v231 offset:45056
    s_waitcnt lgkmcnt(4)
    v_mfma_f32_16x16x32_bf16 v[172:175], v[196:199], v[4:7], 0
    v_mfma_f32_16x16x32_bf16 v[176:179], v[196:199], v[20:23], 0
    v_mfma_f32_16x16x32_bf16 v[180:183], v[196:199], v[36:39], 0
    v_mfma_f32_16x16x32_bf16 v[172:175], v[200:203], v[8:11], v[172:175]
    v_mfma_f32_16x16x32_bf16 v[176:179], v[200:203], v[24:27], v[176:179]
    v_mfma_f32_16x16x32_bf16 v[180:183], v[200:203], v[40:43], v[180:183]
    v_mfma_f32_16x16x32_bf16 v[172:175], v[204:207], v[12:15], v[172:175]
    v_mfma_f32_16x16x32_bf16 v[176:179], v[204:207], v[28:31], v[176:179]
    v_mfma_f32_16x16x32_bf16 v[180:183], v[204:207], v[44:47], v[180:183]
    v_mfma_f32_16x16x32_bf16 v[172:175], v[208:211], v[16:19], v[172:175]
    v_mfma_f32_16x16x32_bf16 v[176:179], v[208:211], v[32:35], v[176:179]
    v_mfma_f32_16x16x32_bf16 v[180:183], v[208:211], v[48:51], v[180:183]
    s_waitcnt lgkmcnt(0)
    v_mfma_f32_16x16x32_bf16 v[184:187], v[212:215], v[4:7], 0
    v_mfma_f32_16x16x32_bf16 v[188:191], v[212:215], v[20:23], 0
    v_mfma_f32_16x16x32_bf16 v[192:195], v[212:215], v[36:39], 0
    v_mfma_f32_16x16x32_bf16 v[184:187], v[216:219], v[8:11], v[184:187]
    v_mfma_f32_16x16x32_bf16 v[188:191], v[216:219], v[24:27], v[188:191]
    v_mfma_f32_16x16x32_bf16 v[192:195], v[216:219], v[40:43], v[192:195]
    v_mfma_f32_16x16x32_bf16 v[184:187], v[220:223], v[12:15], v[184:187]
    v_mfma_f32_16x16x32_bf16 v[188:191], v[220:223], v[28:31], v[188:191]
    v_mfma_f32_16x16x32_bf16 v[192:195], v[220:223], v[44:47], v[192:195]
    v_mfma_f32_16x16x32_bf16 v[184:187], v[224:227], v[16:19], v[184:187]
    v_mfma_f32_16x16x32_bf16 v[188:191], v[224:227], v[32:35], v[188:191]
    v_mfma_f32_16x16x32_bf16 v[192:195], v[224:227], v[48:51], v[192:195]
    s_waitcnt vmcnt(8)
    s_barrier
    s_add_u32 m0, s38, 32768
    s_add_u32 s31, s32, 0
    buffer_load_dwordx4 v240, s[16:19], s31 offen nt lds
    s_add_u32 m0, s38, 36864
    s_add_u32 s31, s32, 4096
    buffer_load_dwordx4 v240, s[16:19], s31 offen nt lds
    s_add_u32 m0, s38, 40960
    s_add_u32 s31, s32, 8192
    buffer_load_dwordx4 v240, s[16:19], s31 offen nt lds
    s_add_u32 m0, s38, 45056
    s_add_u32 s31, s32, 12288
    buffer_load_dwordx4 v240, s[16:19], s31 offen nt lds
    s_add_u32 s32, s32, 16384
    s_nop 7
    v_max3_f32 v249, v148, v149, v150
    v_max3_f32 v250, v152, v153, v154
    v_max3_f32 v251, v156, v157, v158
    v_max3_f32 v249, v249, v151, v160
    v_max3_f32 v250, v250, v155, v164
    v_max3_f32 v251, v251, v159, v168
    v_max3_f32 v249, v249, v161, v162
    v_max3_f32 v250, v250, v165, v166
    v_max3_f32 v251, v251, v169, v170
    v_max3_f32 v249, v249, v163, v172
    v_max3_f32 v250, v250, v167, v176
    v_max3_f32 v251, v251, v171, v180
    v_max3_f32 v249, v249, v173, v174
    v_max3_f32 v250, v250, v177, v178
    v_max3_f32 v251, v251, v181, v182
    v_max3_f32 v249, v249, v175, v184
    v_max3_f32 v250, v250, v179, v188
    v_max3_f32 v251, v251, v183, v192
    v_max3_f32 v249, v249, v185, v186
    v_max3_f32 v250, v250, v189, v190
    v_max3_f32 v251, v251, v193, v194
    v_max_f32 v249, v249, v187
    v_max_f32 v250, v250, v191
    v_max_f32 v251, v251, v195
    v_mov_b32 v252, v249
    v_mov_b32 v253, v250
    v_mov_b32 v254, v251
    s_nop 0
    v_permlane32_swap_b32 v249, v252
    v_permlane32_swap_b32 v250, v253
    v_permlane32_swap_b32 v251, v254
    v_max_f32 v249, v249, v252
    v_max_f32 v250, v250, v253
    v_max_f32 v251, v251, v254
    v_mov_b32 v252, v249
    v_mov_b32 v253, v250
    v_mov_b32 v254, v251
    s_nop 0
    v_permlane16_swap_b32 v249, v252
    v_permlane16_swap_b32 v250, v253
    v_permlane16_swap_b32 v251, v254
    v_max_f32 v249, v249, v252
    v_max_f32 v250, v250, v253
    v_max_f32 v251, v251, v254
    v_mul_f32 v249, s29, v249
    v_mul_f32 v250, s29, v250
    v_mul_f32 v251, s29, v251
    v_sub_f32 v252, v249, v243
    v_sub_f32 v253, v250, v244
    v_sub_f32 v254, v251, v245
    v_max3_f32 v255, v252, v253, v254
    v_cmp_lt_f32 vcc, s30, v255
    s_cbranch_vccz L_norescale_b
    v_max_f32 v249, v249, v243
    v_max_f32 v250, v250, v244
    v_max_f32 v251, v251, v245
    v_sub_f32 v252, v243, v249
    v_sub_f32 v253, v244, v250
    v_sub_f32 v254, v245, v251
    v_exp_f32 v252, v252
    v_exp_f32 v253, v253
    v_exp_f32 v254, v254
    v_mov_b32 v243, v249
    v_mov_b32 v244, v250
    v_mov_b32 v245, v251
    v_mul_f32 v246, v246, v252
    v_mul_f32 v247, v247, v253
    v_mul_f32 v248, v248, v254
    v_mul_f32 v52, v52, v252
    v_mul_f32 v53, v53, v252
    v_mul_f32 v54, v54, v252
    v_mul_f32 v55, v55, v252
    v_mul_f32 v56, v56, v252
    v_mul_f32 v57, v57, v252
    v_mul_f32 v58, v58, v252
    v_mul_f32 v59, v59, v252
    v_mul_f32 v60, v60, v252
    v_mul_f32 v61, v61, v252
    v_mul_f32 v62, v62, v252
    v_mul_f32 v63, v63, v252
    v_mul_f32 v64, v64, v252
    v_mul_f32 v65, v65, v252
    v_mul_f32 v66, v66, v252
    v_mul_f32 v67, v67, v252
    v_mul_f32 v68, v68, v252
    v_mul_f32 v69, v69, v252
    v_mul_f32 v70, v70, v252
    v_mul_f32 v71, v71, v252
    v_mul_f32 v72, v72, v252
    v_mul_f32 v73, v73, v252
    v_mul_f32 v74, v74, v252
    v_mul_f32 v75, v75, v252
    v_mul_f32 v76, v76, v252
    v_mul_f32 v77, v77, v252
    v_mul_f32 v78, v78, v252
    v_mul_f32 v79, v79, v252
    v_mul_f32 v80, v80, v252
    v_mul_f32 v81, v81, v252
    v_mul_f32 v82, v82, v252
    v_mul_f32 v83, v83, v252
    v_mul_f32 v84, v84, v253
    v_mul_f32 v85, v85, v253
    v_mul_f32 v86, v86, v253
    v_mul_f32 v87, v87, v253
    v_mul_f32 v88, v88, v253
    v_mul_f32 v89, v89, v253
    v_mul_f32 v90, v90, v253
    v_mul_f32 v91, v91, v253
    v_mul_f32 v92, v92, v253
    v_mul_f32 v93, v93, v253
    v_mul_f32 v94, v94, v253
    v_mul_f32 v95, v95, v253
    v_mul_f32 v96, v96, v253
    v_mul_f32 v97, v97, v253
    v_mul_f32 v98, v98, v253
    v_mul_f32 v99, v99, v253
    v_mul_f32 v100, v100, v253
    v_mul_f32 v101, v101, v253
    v_mul_f32 v102, v102, v253
    v_mul_f32 v103, v103, v253
    v_mul_f32 v104, v104, v253
    v_mul_f32 v105, v105, v253
    v_mul_f32 v106, v106, v253
    v_mul_f32 v107, v107, v253
    v_mul_f32 v108, v108, v253
    v_mul_f32 v109, v109, v253
    v_mul_f32 v110, v110, v253
    v_mul_f32 v111, v111, v253
    v_mul_f32 v112, v112, v253
    v_mul_f32 v113, v113, v253
    v_mul_f32 v114, v114, v253
    v_mul_f32 v115, v115, v253
    v_mul_f32 v116, v116, v254
    v_mul_f32 v117, v117, v254
    v_mul_f32 v118, v118, v254
    v_mul_f32 v119, v119, v254
    v_mul_f32 v120, v120, v254
    v_mul_f32 v121, v121, v254
    v_mul_f32 v122, v122, v254
    v_mul_f32 v123, v123, v254
    v_mul_f32 v124, v124, v254
    v_mul_f32 v125, v125, v254
    v_mul_f32 v126, v126, v254
    v_mul_f32 v127, v127, v254
    v_mul_f32 v128, v128, v254
    v_mul_f32 v129, v129, v254
    v_mul_f32 v130, v130, v254
    v_mul_f32 v131, v131, v254
    v_mul_f32 v132, v132, v254
    v_mul_f32 v133, v133, v254
    v_mul_f32 v134, v134, v254
    v_mul_f32 v135, v135, v254
    v_mul_f32 v136, v136, v254
    v_mul_f32 v137, v137, v254
    v_mul_f32 v138, v138, v254
    v_mul_f32 v139, v139, v254
    v_mul_f32 v140, v140, v254
    v_mul_f32 v141, v141, v254
    v_mul_f32 v142, v142, v254
    v_mul_f32 v143, v143, v254
    v_mul_f32 v144, v144, v254
    v_mul_f32 v145, v145, v254
    v_mul_f32 v146, v146, v254
    v_mul_f32 v147, v147, v254
L_norescale_b:
    v_fma_f32 v148, v148, s29, -v243
    v_fma_f32 v149, v149, s29, -v243
    v_fma_f32 v150, v150, s29, -v243
    v_fma_f32 v151, v151, s29, -v243
    v_fma_f32 v152, v152, s29, -v244
    v_fma_f32 v153, v153, s29, -v244
    v_fma_f32 v154, v154, s29, -v244
    v_fma_f32 v155, v155, s29, -v244
    v_fma_f32 v156, v156, s29, -v245
    v_fma_f32 v157, v157, s29, -v245
    v_fma_f32 v158, v158, s29, -v245
    v_fma_f32 v159, v159, s29, -v245
    v_exp_f32 v148, v148
    v_exp_f32 v149, v149
    v_exp_f32 v150, v150
    v_exp_f32 v151, v151
    v_exp_f32 v152, v152
    v_exp_f32 v153, v153
    v_exp_f32 v154, v154
    v_exp_f32 v155, v155
    v_exp_f32 v156, v156
    v_exp_f32 v157, v157
    v_exp_f32 v158, v158
    v_exp_f32 v159, v159
    v_add_f32 v246, v246, v148
    v_add_f32 v247, v247, v152
    v_add_f32 v248, v248, v156
    v_add_f32 v246, v246, v149
    v_add_f32 v247, v247, v153
    v_add_f32 v248, v248, v157
    v_add_f32 v246, v246, v150
    v_add_f32 v247, v247, v154
    v_add_f32 v248, v248, v158
    v_add_f32 v246, v246, v151
    v_add_f32 v247, v247, v155
    v_add_f32 v248, v248, v159
    v_fma_f32 v160, v160, s29, -v243
    v_fma_f32 v161, v161, s29, -v243
    v_fma_f32 v162, v162, s29, -v243
    v_fma_f32 v163, v163, s29, -v243
    v_fma_f32 v164, v164, s29, -v244
    v_fma_f32 v165, v165, s29, -v244
    v_fma_f32 v166, v166, s29, -v244
    v_fma_f32 v167, v167, s29, -v244
    v_fma_f32 v168, v168, s29, -v245
    v_fma_f32 v169, v169, s29, -v245
    v_fma_f32 v170, v170, s29, -v245
    v_fma_f32 v171, v171, s29, -v245
    v_exp_f32 v160, v160
    v_exp_f32 v161, v161
    v_exp_f32 v162, v162
    v_exp_f32 v163, v163
    v_exp_f32 v164, v164
    v_exp_f32 v165, v165
    v_exp_f32 v166, v166
    v_exp_f32 v167, v167
    v_exp_f32 v168, v168
    v_exp_f32 v169, v169
    v_exp_f32 v170, v170
    v_exp_f32 v171, v171
    v_add_f32 v246, v246, v160
    v_add_f32 v247, v247, v164
    v_add_f32 v248, v248, v168
    v_add_f32 v246, v246, v161
    v_add_f32 v247, v247, v165
    v_add_f32 v248, v248, v169
    v_add_f32 v246, v246, v162
    v_add_f32 v247, v247, v166
    v_add_f32 v248, v248, v170
    v_add_f32 v246, v246, v163
    v_add_f32 v247, v247, v167
    v_add_f32 v248, v248, v171
    v_fma_f32 v172, v172, s29, -v243
    v_fma_f32 v173, v173, s29, -v243
    v_fma_f32 v174, v174, s29, -v243
    v_fma_f32 v175, v175, s29, -v243
    v_fma_f32 v176, v176, s29, -v244
    v_fma_f32 v177, v177, s29, -v244
    v_fma_f32 v178, v178, s29, -v244
    v_fma_f32 v179, v179, s29, -v244
    v_fma_f32 v180, v180, s29, -v245
    v_fma_f32 v181, v181, s29, -v245
    v_fma_f32 v182, v182, s29, -v245
    v_fma_f32 v183, v183, s29, -v245
    v_exp_f32 v172, v172
    v_exp_f32 v173, v173
    v_exp_f32 v174, v174
    v_exp_f32 v175, v175
    v_exp_f32 v176, v176
    v_exp_f32 v177, v177
    v_exp_f32 v178, v178
    v_exp_f32 v179, v179
    v_exp_f32 v180, v180
    v_exp_f32 v181, v181
    v_exp_f32 v182, v182
    v_exp_f32 v183, v183
    v_add_f32 v246, v246, v172
    v_add_f32 v247, v247, v176
    v_add_f32 v248, v248, v180
    v_add_f32 v246, v246, v173
    v_add_f32 v247, v247, v177
    v_add_f32 v248, v248, v181
    v_add_f32 v246, v246, v174
    v_add_f32 v247, v247, v178
    v_add_f32 v248, v248, v182
    v_add_f32 v246, v246, v175
    v_add_f32 v247, v247, v179
    v_add_f32 v248, v248, v183
    v_fma_f32 v184, v184, s29, -v243
    v_fma_f32 v185, v185, s29, -v243
    v_fma_f32 v186, v186, s29, -v243
    v_fma_f32 v187, v187, s29, -v243
    v_fma_f32 v188, v188, s29, -v244
    v_fma_f32 v189, v189, s29, -v244
    v_fma_f32 v190, v190, s29, -v244
    v_fma_f32 v191, v191, s29, -v244
    v_fma_f32 v192, v192, s29, -v245
    v_fma_f32 v193, v193, s29, -v245
    v_fma_f32 v194, v194, s29, -v245
    v_fma_f32 v195, v195, s29, -v245
    v_exp_f32 v184, v184
    v_exp_f32 v185, v185
    v_exp_f32 v186, v186
    v_exp_f32 v187, v187
    v_exp_f32 v188, v188
    v_exp_f32 v189, v189
    v_exp_f32 v190, v190
    v_exp_f32 v191, v191
    v_exp_f32 v192, v192
    v_exp_f32 v193, v193
    v_exp_f32 v194, v194
    v_exp_f32 v195, v195
    v_add_f32 v246, v246, v184
    v_add_f32 v247, v247, v188
    v_add_f32 v248, v248, v192
    v_add_f32 v246, v246, v185
    v_add_f32 v247, v247, v189
    v_add_f32 v248, v248, v193
    v_add_f32 v246, v246, v186
    v_add_f32 v247, v247, v190
    v_add_f32 v248, v248, v194
    v_add_f32 v246, v246, v187
    v_add_f32 v247, v247, v191
    v_add_f32 v248, v248, v195
    v_cvt_pk_bf16_f32 v148, v148, v149
    v_cvt_pk_bf16_f32 v149, v150, v151
    v_cvt_pk_bf16_f32 v150, v160, v161
    v_cvt_pk_bf16_f32 v151, v162, v163
    v_cvt_pk_bf16_f32 v152, v152, v153
    v_cvt_pk_bf16_f32 v153, v154, v155
    v_cvt_pk_bf16_f32 v154, v164, v165
    v_cvt_pk_bf16_f32 v155, v166, v167
    v_cvt_pk_bf16_f32 v156, v156, v157
    v_cvt_pk_bf16_f32 v157, v158, v159
    v_cvt_pk_bf16_f32 v158, v168, v169
    v_cvt_pk_bf16_f32 v159, v170, v171
    v_cvt_pk_bf16_f32 v172, v172, v173
    v_cvt_pk_bf16_f32 v173, v174, v175
    v_cvt_pk_bf16_f32 v174, v184, v185
    v_cvt_pk_bf16_f32 v175, v186, v187
    v_cvt_pk_bf16_f32 v176, v176, v177
    v_cvt_pk_bf16_f32 v177, v178, v179
    v_cvt_pk_bf16_f32 v178, v188, v189
    v_cvt_pk_bf16_f32 v179, v190, v191
    v_cvt_pk_bf16_f32 v180, v180, v181
    v_cvt_pk_bf16_f32 v181, v182, v183
    v_cvt_pk_bf16_f32 v182, v192, v193
    v_cvt_pk_bf16_f32 v183, v194, v195
    s_nop 1
    ds_read_b64_tr_b16 v[196:197], v232 offset:49152
    ds_read_b64_tr_b16 v[198:199], v232 offset:53248
    ds_read_b64_tr_b16 v[200:201], v232 offset:57344
    ds_read_b64_tr_b16 v[202:203], v232 offset:61440
    ds_read_b64_tr_b16 v[204:205], v233 offset:49152
    ds_read_b64_tr_b16 v[206:207], v233 offset:53248
    ds_read_b64_tr_b16 v[208:209], v233 offset:57344
    ds_read_b64_tr_b16 v[210:211], v233 offset:61440
    ds_read_b64_tr_b16 v[212:213], v234 offset:49152
    ds_read_b64_tr_b16 v[214:215], v234 offset:53248
    s_waitcnt lgkmcnt(8)
    v_mfma_f32_16x16x32_bf16 v[52:55], v[196:199], v[148:151], v[52:55]
    v_mfma_f32_16x16x32_bf16 v[84:87], v[196:199], v[152:155], v[84:87]
    v_mfma_f32_16x16x32_bf16 v[116:119], v[196:199], v[156:159], v[116:119]
    ds_read_b64_tr_b16 v[216:217], v234 offset:57344
    ds_read_b64_tr_b16 v[218:219], v234 offset:61440
    s_waitcnt lgkmcnt(8)
    v_mfma_f32_16x16x32_bf16 v[52:55], v[200:203], v[172:175], v[52:55]
    v_mfma_f32_16x16x32_bf16 v[84:87], v[200:203], v[176:179], v[84:87]
    v_mfma_f32_16x16x32_bf16 v[116:119], v[200:203], v[180:183], v[116:119]
    ds_read_b64_tr_b16 v[220:221], v235 offset:49152
    ds_read_b64_tr_b16 v[222:223], v235 offset:53248
    s_waitcnt lgkmcnt(8)
    v_mfma_f32_16x16x32_bf16 v[56:59], v[204:207], v[148:151], v[56:59]
    v_mfma_f32_16x16x32_bf16 v[88:91], v[204:207], v[152:155], v[88:91]
    v_mfma_f32_16x16x32_bf16 v[120:123], v[204:207], v[156:159], v[120:123]
    ds_read_b64_tr_b16 v[224:225], v235 offset:57344
    ds_read_b64_tr_b16 v[226:227], v235 offset:61440
    s_waitcnt lgkmcnt(8)
    v_mfma_f32_16x16x32_bf16 v[56:59], v[208:211], v[172:175], v[56:59]
    v_mfma_f32_16x16x32_bf16 v[88:91], v[208:211], v[176:179], v[88:91]
    v_mfma_f32_16x16x32_bf16 v[120:123], v[208:211], v[180:183], v[120:123]
    ds_read_b64_tr_b16 v[196:197], v236 offset:49152
    ds_read_b64_tr_b16 v[198:199], v236 offset:53248
    s_waitcnt lgkmcnt(8)
    v_mfma_f32_16x16x32_bf16 v[60:63], v[212:215], v[148:151], v[60:63]
    v_mfma_f32_16x16x32_bf16 v[92:95], v[212:215], v[152:155], v[92:95]
    v_mfma_f32_16x16x32_bf16 v[124:127], v[212:215], v[156:159], v[124:127]
    ds_read_b64_tr_b16 v[200:201], v236 offset:57344
    ds_read_b64_tr_b16 v[202:203], v236 offset:61440
    s_waitcnt lgkmcnt(8)
    v_mfma_f32_16x16x32_bf16 v[60:63], v[216:219], v[172:175], v[60:63]
    v_mfma_f32_16x16x32_bf16 v[92:95], v[216:219], v[176:179], v[92:95]
    v_mfma_f32_16x16x32_bf16 v[124:127], v[216:219], v[180:183], v[124:127]
    ds_read_b64_tr_b16 v[204:205], v237 offset:49152
    ds_read_b64_tr_b16 v[206:207], v237 offset:53248
    s_waitcnt lgkmcnt(8)
    v_mfma_f32_16x16x32_bf16 v[64:67], v[220:223], v[148:151], v[64:67]
    v_mfma_f32_16x16x32_bf16 v[96:99], v[220:223], v[152:155], v[96:99]
    v_mfma_f32_16x16x32_bf16 v[128:131], v[220:223], v[156:159], v[128:131]
    ds_read_b64_tr_b16 v[208:209], v237 offset:57344
    ds_read_b64_tr_b16 v[210:211], v237 offset:61440
    s_waitcnt lgkmcnt(8)
    v_mfma_f32_16x16x32_bf16 v[64:67], v[224:227], v[172:175], v[64:67]
    v_mfma_f32_16x16x32_bf16 v[96:99], v[224:227], v[176:179], v[96:99]
    v_mfma_f32_16x16x32_bf16 v[128:131], v[224:227], v[180:183], v[128:131]
    ds_read_b64_tr_b16 v[212:213], v238 offset:49152
    ds_read_b64_tr_b16 v[214:215], v238 offset:53248
    s_waitcnt lgkmcnt(8)
    v_mfma_f32_16x16x32_bf16 v[68:71], v[196:199], v[148:151], v[68:71]
    v_mfma_f32_16x16x32_bf16 v[100:103], v[196:199], v[152:155], v[100:103]
    v_mfma_f32_16x16x32_bf16 v[132:135], v[196:199], v[156:159], v[132:135]
    ds_read_b64_tr_b16 v[216:217], v238 offset:57344
    ds_read_b64_tr_b16 v[218:219], v238 offset:61440
    s_waitcnt lgkmcnt(8)
    v_mfma_f32_16x16x32_bf16 v[68:71], v[200:203], v[172:175], v[68:71]
    v_mfma_f32_16x16x32_bf16 v[100:103], v[200:203], v[176:179], v[100:103]
    v_mfma_f32_16x16x32_bf16 v[132:135], v[200:203], v[180:183], v[132:135]
    ds_read_b64_tr_b16 v[220:221], v239 offset:49152
    ds_read_b64_tr_b16 v[222:223], v239 offset:53248
    s_waitcnt lgkmcnt(8)
    v_mfma_f32_16x16x32_bf16 v[72:75], v[204:207], v[148:151], v[72:75]
    v_mfma_f32_16x16x32_bf16 v[104:107], v[204:207], v[152:155], v[104:107]
    v_mfma_f32_16x16x32_bf16 v[136:139], v[204:207], v[156:159], v[136:139]
    ds_read_b64_tr_b16 v[224:225], v239 offset:57344
    ds_read_b64_tr_b16 v[226:227], v239 offset:61440
    s_waitcnt lgkmcnt(8)
    v_mfma_f32_16x16x32_bf16 v[72:75], v[208:211], v[172:175], v[72:75]
    v_mfma_f32_16x16x32_bf16 v[104:107], v[208:211], v[176:179], v[104:107]
    v_mfma_f32_16x16x32_bf16 v[136:139], v[208:211], v[180:183], v[136:139]
    s_waitcnt lgkmcnt(6)
    v_mfma_f32_16x16x32_bf16 v[76:79], v[212:215], v[148:151], v[76:79]
    v_mfma_f32_16x16x32_bf16 v[108:111], v[212:215], v[152:155], v[108:111]
    v_mfma_f32_16x16x32_bf16 v[140:143], v[212:215], v[156:159], v[140:143]
    s_waitcnt lgkmcnt(4)
    v_mfma_f32_16x16x32_bf16 v[76:79], v[216:219], v[172:175], v[76:79]
    v_mfma_f32_16x16x32_bf16 v[108:111], v[216:219], v[176:179], v[108:111]
    v_mfma_f32_16x16x32_bf16 v[140:143], v[216:219], v[180:183], v[140:143]
    s_waitcnt lgkmcnt(2)
    v_mfma_f32_16x16x32_bf16 v[80:83], v[220:223], v[148:151], v[80:83]
    v_mfma_f32_16x16x32_bf16 v[112:115], v[220:223], v[152:155], v[112:115]
    v_mfma_f32_16x16x32_bf16 v[144:147], v[220:223], v[156:159], v[144:147]
    s_waitcnt lgkmcnt(0)
    v_mfma_f32_16x16x32_bf16 v[80:83], v[224:227], v[172:175], v[80:83]
    v_mfma_f32_16x16x32_bf16 v[112:115], v[224:227], v[176:179], v[112:115]
    v_mfma_f32_16x16x32_bf16 v[144:147], v[224:227], v[180:183], v[144:147]
    s_add_u32 s34, s34, 1
    s_cmp_lt_u32 s34, 7
    s_cbranch_scc1 L_attn_loop
    s_waitcnt vmcnt(8)
    s_barrier
    s_add_u32 m0, s38, 49152
    s_add_u32 s31, s33, 0
    buffer_load_dwordx4 v241, s[20:23], s31 offen nt lds
    s_add_u32 m0, s38, 53248
    s_add_u32 s31, s33, 4096
    buffer_load_dwordx4 v241, s[20:23], s31 offen nt lds
    s_add_u32 m0, s38, 57344
    s_add_u32 s31, s33, 8192
    buffer_load_dwordx4 v241, s[20:23], s31 offen nt lds
    s_add_u32 m0, s38, 61440
    s_add_u32 s31, s33, 12288
    buffer_load_dwordx4 v241, s[20:23], s31 offen nt lds
    s_add_u32 s33, s33, 16384
    ds_read_b128 v[196:199], v228 offset:0
    ds_read_b128 v[200:203], v229 offset:0
    ds_read_b128 v[204:207], v230 offset:0
    ds_read_b128 v[208:211], v231 offset:0
    ds_read_b128 v[212:215], v228 offset:4096
    ds_read_b128 v[216:219], v229 offset:4096
    ds_read_b128 v[220:223], v230 offset:4096
    ds_read_b128 v[224:227], v231 offset:4096
    s_waitcnt lgkmcnt(4)
    v_mfma_f32_16x16x32_bf16 v[148:151], v[196:199], v[4:7], 0
    v_mfma_f32_16x16x32_bf16 v[152:155], v[196:199], v[20:23], 0
    v_mfma_f32_16x16x32_bf16 v[156:159], v[196:199], v[36:39], 0
    v_mfma_f32_16x16x32_bf16 v[148:151], v[200:203], v[8:11], v[148:151]
    v_mfma_f32_16x16x32_bf16 v[152:155], v[200:203], v[24:27], v[152:155]
    v_mfma_f32_16x16x32_bf16 v[156:159], v[200:203], v[40:43], v[156:159]
    v_mfma_f32_16x16x32_bf16 v[148:151], v[204:207], v[12:15], v[148:151]
    v_mfma_f32_16x16x32_bf16 v[152:155], v[204:207], v[28:31], v[152:155]
    v_mfma_f32_16x16x32_bf16 v[156:159], v[204:207], v[44:47], v[156:159]
    v_mfma_f32_16x16x32_bf16 v[148:151], v[208:211], v[16:19], v[148:151]
    v_mfma_f32_16x16x32_bf16 v[152:155], v[208:211], v[32:35], v[152:155]
    v_mfma_f32_16x16x32_bf16 v[156:159], v[208:211], v[48:51], v[156:159]
    ds_read_b128 v[196:199], v228 offset:8192
    ds_read_b128 v[200:203], v229 offset:8192
    ds_read_b128 v[204:207], v230 offset:8192
    ds_read_b128 v[208:211], v231 offset:8192
    s_waitcnt lgkmcnt(4)
    v_mfma_f32_16x16x32_bf16 v[160:163], v[212:215], v[4:7], 0
    v_mfma_f32_16x16x32_bf16 v[164:167], v[212:215], v[20:23], 0
    v_mfma_f32_16x16x32_bf16 v[168:171], v[212:215], v[36:39], 0
    v_mfma_f32_16x16x32_bf16 v[160:163], v[216:219], v[8:11], v[160:163]
    v_mfma_f32_16x16x32_bf16 v[164:167], v[216:219], v[24:27], v[164:167]
    v_mfma_f32_16x16x32_bf16 v[168:171], v[216:219], v[40:43], v[168:171]
    v_mfma_f32_16x16x32_bf16 v[160:163], v[220:223], v[12:15], v[160:163]
    v_mfma_f32_16x16x32_bf16 v[164:167], v[220:223], v[28:31], v[164:167]
    v_mfma_f32_16x16x32_bf16 v[168:171], v[220:223], v[44:47], v[168:171]
    v_mfma_f32_16x16x32_bf16 v[160:163], v[224:227], v[16:19], v[160:163]
    v_mfma_f32_16x16x32_bf16 v[164:167], v[224:227], v[32:35], v[164:167]
    v_mfma_f32_16x16x32_bf16 v[168:171], v[224:227], v[48:51], v[168:171]
    ds_read_b128 v[212:215], v228 offset:12288
    ds_read_b128 v[216:219], v229 offset:12288
    ds_read_b128 v[220:223], v230 offset:12288
    ds_read_b128 v[224:227], v231 offset:12288
    s_waitcnt lgkmcnt(4)
    v_mfma_f32_16x16x32_bf16 v[172:175], v[196:199], v[4:7], 0
    v_mfma_f32_16x16x32_bf16 v[176:179], v[196:199], v[20:23], 0
    v_mfma_f32_16x16x32_bf16 v[180:183], v[196:199], v[36:39], 0
    v_mfma_f32_16x16x32_bf16 v[172:175], v[200:203], v[8:11], v[172:175]
    v_mfma_f32_16x16x32_bf16 v[176:179], v[200:203], v[24:27], v[176:179]
    v_mfma_f32_16x16x32_bf16 v[180:183], v[200:203], v[40:43], v[180:183]
    v_mfma_f32_16x16x32_bf16 v[172:175], v[204:207], v[12:15], v[172:175]
    v_mfma_f32_16x16x32_bf16 v[176:179], v[204:207], v[28:31], v[176:179]
    v_mfma_f32_16x16x32_bf16 v[180:183], v[204:207], v[44:47], v[180:183]
    v_mfma_f32_16x16x32_bf16 v[172:175], v[208:211], v[16:19], v[172:175]
    v_mfma_f32_16x16x32_bf16 v[176:179], v[208:211], v[32:35], v[176:179]
    v_mfma_f32_16x16x32_bf16 v[180:183], v[208:211], v[48:51], v[180:183]
    s_waitcnt lgkmcnt(0)
    v_mfma_f32_16x16x32_bf16 v[184:187], v[212:215], v[4:7], 0
    v_mfma_f32_16x16x32_bf16 v[188:191], v[212:215], v[20:23], 0
    v_mfma_f32_16x16x32_bf16 v[192:195], v[212:215], v[36:39], 0
    v_mfma_f32_16x16x32_bf16 v[184:187], v[216:219], v[8:11], v[184:187]
    v_mfma_f32_16x16x32_bf16 v[188:191], v[216:219], v[24:27], v[188:191]
    v_mfma_f32_16x16x32_bf16 v[192:195], v[216:219], v[40:43], v[192:195]
    v_mfma_f32_16x16x32_bf16 v[184:187], v[220:223], v[12:15], v[184:187]
    v_mfma_f32_16x16x32_bf16 v[188:191], v[220:223], v[28:31], v[188:191]
    v_mfma_f32_16x16x32_bf16 v[192:195], v[220:223], v[44:47], v[192:195]
    v_mfma_f32_16x16x32_bf16 v[184:187], v[224:227], v[16:19], v[184:187]
    v_mfma_f32_16x16x32_bf16 v[188:191], v[224:227], v[32:35], v[188:191]
    v_mfma_f32_16x16x32_bf16 v[192:195], v[224:227], v[48:51], v[192:195]
    s_waitcnt vmcnt(8)
    s_barrier
    s_nop 7
    v_max3_f32 v249, v148, v149, v150
    v_max3_f32 v250, v152, v153, v154
    v_max3_f32 v251, v156, v157, v158
    v_max3_f32 v249, v249, v151, v160
    v_max3_f32 v250, v250, v155, v164
    v_max3_f32 v251, v251, v159, v168
    v_max3_f32 v249, v249, v161, v162
    v_max3_f32 v250, v250, v165, v166
    v_max3_f32 v251, v251, v169, v170
    v_max3_f32 v249, v249, v163, v172
    v_max3_f32 v250, v250, v167, v176
    v_max3_f32 v251, v251, v171, v180
    v_max3_f32 v249, v249, v173, v174
    v_max3_f32 v250, v250, v177, v178
    v_max3_f32 v251, v251, v181, v182
    v_max3_f32 v249, v249, v175, v184
    v_max3_f32 v250, v250, v179, v188
    v_max3_f32 v251, v251, v183, v192
    v_max3_f32 v249, v249, v185, v186
    v_max3_f32 v250, v250, v189, v190
    v_max3_f32 v251, v251, v193, v194
    v_max_f32 v249, v249, v187
    v_max_f32 v250, v250, v191
    v_max_f32 v251, v251, v195
    v_mov_b32 v252, v249
    v_mov_b32 v253, v250
    v_mov_b32 v254, v251
    s_nop 0
    v_permlane32_swap_b32 v249, v252
    v_permlane32_swap_b32 v250, v253
    v_permlane32_swap_b32 v251, v254
    v_max_f32 v249, v249, v252
    v_max_f32 v250, v250, v253
    v_max_f32 v251, v251, v254
    v_mov_b32 v252, v249
    v_mov_b32 v253, v250
    v_mov_b32 v254, v251
    s_nop 0
    v_permlane16_swap_b32 v249, v252
    v_permlane16_swap_b32 v250, v253
    v_permlane16_swap_b32 v251, v254
    v_max_f32 v249, v249, v252
    v_max_f32 v250, v250, v253
    v_max_f32 v251, v251, v254
    v_mul_f32 v249, s29, v249
    v_mul_f32 v250, s29, v250
    v_mul_f32 v251, s29, v251
    v_sub_f32 v252, v249, v243
    v_sub_f32 v253, v250, v244
    v_sub_f32 v254, v251, v245
    v_max3_f32 v255, v252, v253, v254
    v_cmp_lt_f32 vcc, s30, v255
    s_cbranch_vccz L_norescale_c
    v_max_f32 v249, v249, v243
    v_max_f32 v250, v250, v244
    v_max_f32 v251, v251, v245
    v_sub_f32 v252, v243, v249
    v_sub_f32 v253, v244, v250
    v_sub_f32 v254, v245, v251
    v_exp_f32 v252, v252
    v_exp_f32 v253, v253
    v_exp_f32 v254, v254
    v_mov_b32 v243, v249
    v_mov_b32 v244, v250
    v_mov_b32 v245, v251
    v_mul_f32 v246, v246, v252
    v_mul_f32 v247, v247, v253
    v_mul_f32 v248, v248, v254
    v_mul_f32 v52, v52, v252
    v_mul_f32 v53, v53, v252
    v_mul_f32 v54, v54, v252
    v_mul_f32 v55, v55, v252
    v_mul_f32 v56, v56, v252
    v_mul_f32 v57, v57, v252
    v_mul_f32 v58, v58, v252
    v_mul_f32 v59, v59, v252
    v_mul_f32 v60, v60, v252
    v_mul_f32 v61, v61, v252
    v_mul_f32 v62, v62, v252
    v_mul_f32 v63, v63, v252
    v_mul_f32 v64, v64, v252
    v_mul_f32 v65, v65, v252
    v_mul_f32 v66, v66, v252
    v_mul_f32 v67, v67, v252
    v_mul_f32 v68, v68, v252
    v_mul_f32 v69, v69, v252
    v_mul_f32 v70, v70, v252
    v_mul_f32 v71, v71, v252
    v_mul_f32 v72, v72, v252
    v_mul_f32 v73, v73, v252
    v_mul_f32 v74, v74, v252
    v_mul_f32 v75, v75, v252
    v_mul_f32 v76, v76, v252
    v_mul_f32 v77, v77, v252
    v_mul_f32 v78, v78, v252
    v_mul_f32 v79, v79, v252
    v_mul_f32 v80, v80, v252
    v_mul_f32 v81, v81, v252
    v_mul_f32 v82, v82, v252
    v_mul_f32 v83, v83, v252
    v_mul_f32 v84, v84, v253
    v_mul_f32 v85, v85, v253
    v_mul_f32 v86, v86, v253
    v_mul_f32 v87, v87, v253
    v_mul_f32 v88, v88, v253
    v_mul_f32 v89, v89, v253
    v_mul_f32 v90, v90, v253
    v_mul_f32 v91, v91, v253
    v_mul_f32 v92, v92, v253
    v_mul_f32 v93, v93, v253
    v_mul_f32 v94, v94, v253
    v_mul_f32 v95, v95, v253
    v_mul_f32 v96, v96, v253
    v_mul_f32 v97, v97, v253
    v_mul_f32 v98, v98, v253
    v_mul_f32 v99, v99, v253
    v_mul_f32 v100, v100, v253
    v_mul_f32 v101, v101, v253
    v_mul_f32 v102, v102, v253
    v_mul_f32 v103, v103, v253
    v_mul_f32 v104, v104, v253
    v_mul_f32 v105, v105, v253
    v_mul_f32 v106, v106, v253
    v_mul_f32 v107, v107, v253
    v_mul_f32 v108, v108, v253
    v_mul_f32 v109, v109, v253
    v_mul_f32 v110, v110, v253
    v_mul_f32 v111, v111, v253
    v_mul_f32 v112, v112, v253
    v_mul_f32 v113, v113, v253
    v_mul_f32 v114, v114, v253
    v_mul_f32 v115, v115, v253
    v_mul_f32 v116, v116, v254
    v_mul_f32 v117, v117, v254
    v_mul_f32 v118, v118, v254
    v_mul_f32 v119, v119, v254
    v_mul_f32 v120, v120, v254
    v_mul_f32 v121, v121, v254
    v_mul_f32 v122, v122, v254
    v_mul_f32 v123, v123, v254
    v_mul_f32 v124, v124, v254
    v_mul_f32 v125, v125, v254
    v_mul_f32 v126, v126, v254
    v_mul_f32 v127, v127, v254
    v_mul_f32 v128, v128, v254
    v_mul_f32 v129, v129, v254
    v_mul_f32 v130, v130, v254
    v_mul_f32 v131, v131, v254
    v_mul_f32 v132, v132, v254
    v_mul_f32 v133, v133, v254
    v_mul_f32 v134, v134, v254
    v_mul_f32 v135, v135, v254
    v_mul_f32 v136, v136, v254
    v_mul_f32 v137, v137, v254
    v_mul_f32 v138, v138, v254
    v_mul_f32 v139, v139, v254
    v_mul_f32 v140, v140, v254
    v_mul_f32 v141, v141, v254
    v_mul_f32 v142, v142, v254
    v_mul_f32 v143, v143, v254
    v_mul_f32 v144, v144, v254
    v_mul_f32 v145, v145, v254
    v_mul_f32 v146, v146, v254
    v_mul_f32 v147, v147, v254
L_norescale_c:
    v_fma_f32 v148, v148, s29, -v243
    v_fma_f32 v149, v149, s29, -v243
    v_fma_f32 v150, v150, s29, -v243
    v_fma_f32 v151, v151, s29, -v243
    v_fma_f32 v152, v152, s29, -v244
    v_fma_f32 v153, v153, s29, -v244
    v_fma_f32 v154, v154, s29, -v244
    v_fma_f32 v155, v155, s29, -v244
    v_fma_f32 v156, v156, s29, -v245
    v_fma_f32 v157, v157, s29, -v245
    v_fma_f32 v158, v158, s29, -v245
    v_fma_f32 v159, v159, s29, -v245
    v_exp_f32 v148, v148
    v_exp_f32 v149, v149
    v_exp_f32 v150, v150
    v_exp_f32 v151, v151
    v_exp_f32 v152, v152
    v_exp_f32 v153, v153
    v_exp_f32 v154, v154
    v_exp_f32 v155, v155
    v_exp_f32 v156, v156
    v_exp_f32 v157, v157
    v_exp_f32 v158, v158
    v_exp_f32 v159, v159
    v_add_f32 v246, v246, v148
    v_add_f32 v247, v247, v152
    v_add_f32 v248, v248, v156
    v_add_f32 v246, v246, v149
    v_add_f32 v247, v247, v153
    v_add_f32 v248, v248, v157
    v_add_f32 v246, v246, v150
    v_add_f32 v247, v247, v154
    v_add_f32 v248, v248, v158
    v_add_f32 v246, v246, v151
    v_add_f32 v247, v247, v155
    v_add_f32 v248, v248, v159
    v_fma_f32 v160, v160, s29, -v243
    v_fma_f32 v161, v161, s29, -v243
    v_fma_f32 v162, v162, s29, -v243
    v_fma_f32 v163, v163, s29, -v243
    v_fma_f32 v164, v164, s29, -v244
    v_fma_f32 v165, v165, s29, -v244
    v_fma_f32 v166, v166, s29, -v244
    v_fma_f32 v167, v167, s29, -v244
    v_fma_f32 v168, v168, s29, -v245
    v_fma_f32 v169, v169, s29, -v245
    v_fma_f32 v170, v170, s29, -v245
    v_fma_f32 v171, v171, s29, -v245
    v_exp_f32 v160, v160
    v_exp_f32 v161, v161
    v_exp_f32 v162, v162
    v_exp_f32 v163, v163
    v_exp_f32 v164, v164
    v_exp_f32 v165, v165
    v_exp_f32 v166, v166
    v_exp_f32 v167, v167
    v_exp_f32 v168, v168
    v_exp_f32 v169, v169
    v_exp_f32 v170, v170
    v_exp_f32 v171, v171
    v_add_f32 v246, v246, v160
    v_add_f32 v247, v247, v164
    v_add_f32 v248, v248, v168
    v_add_f32 v246, v246, v161
    v_add_f32 v247, v247, v165
    v_add_f32 v248, v248, v169
    v_add_f32 v246, v246, v162
    v_add_f32 v247, v247, v166
    v_add_f32 v248, v248, v170
    v_add_f32 v246, v246, v163
    v_add_f32 v247, v247, v167
    v_add_f32 v248, v248, v171
    v_fma_f32 v172, v172, s29, -v243
    v_fma_f32 v173, v173, s29, -v243
    v_fma_f32 v174, v174, s29, -v243
    v_fma_f32 v175, v175, s29, -v243
    v_fma_f32 v176, v176, s29, -v244
    v_fma_f32 v177, v177, s29, -v244
    v_fma_f32 v178, v178, s29, -v244
    v_fma_f32 v179, v179, s29, -v244
    v_fma_f32 v180, v180, s29, -v245
    v_fma_f32 v181, v181, s29, -v245
    v_fma_f32 v182, v182, s29, -v245
    v_fma_f32 v183, v183, s29, -v245
    v_exp_f32 v172, v172
    v_exp_f32 v173, v173
    v_exp_f32 v174, v174
    v_exp_f32 v175, v175
    v_exp_f32 v176, v176
    v_exp_f32 v177, v177
    v_exp_f32 v178, v178
    v_exp_f32 v179, v179
    v_exp_f32 v180, v180
    v_exp_f32 v181, v181
    v_exp_f32 v182, v182
    v_exp_f32 v183, v183
    v_add_f32 v246, v246, v172
    v_add_f32 v247, v247, v176
    v_add_f32 v248, v248, v180
    v_add_f32 v246, v246, v173
    v_add_f32 v247, v247, v177
    v_add_f32 v248, v248, v181
    v_add_f32 v246, v246, v174
    v_add_f32 v247, v247, v178
    v_add_f32 v248, v248, v182
    v_add_f32 v246, v246, v175
    v_add_f32 v247, v247, v179
    v_add_f32 v248, v248, v183
    v_fma_f32 v184, v184, s29, -v243
    v_fma_f32 v185, v185, s29, -v243
    v_fma_f32 v186, v186, s29, -v243
    v_fma_f32 v187, v187, s29, -v243
    v_fma_f32 v188, v188, s29, -v244
    v_fma_f32 v189, v189, s29, -v244
    v_fma_f32 v190, v190, s29, -v244
    v_fma_f32 v191, v191, s29, -v244
    v_fma_f32 v192, v192, s29, -v245
    v_fma_f32 v193, v193, s29, -v245
    v_fma_f32 v194, v194, s29, -v245
    v_fma_f32 v195, v195, s29, -v245
    v_exp_f32 v184, v184
    v_exp_f32 v185, v185
    v_exp_f32 v186, v186
    v_exp_f32 v187, v187
    v_exp_f32 v188, v188
    v_exp_f32 v189, v189
    v_exp_f32 v190, v190
    v_exp_f32 v191, v191
    v_exp_f32 v192, v192
    v_exp_f32 v193, v193
    v_exp_f32 v194, v194
    v_exp_f32 v195, v195
    v_add_f32 v246, v246, v184
    v_add_f32 v247, v247, v188
    v_add_f32 v248, v248, v192
    v_add_f32 v246, v246, v185
    v_add_f32 v247, v247, v189
    v_add_f32 v248, v248, v193
    v_add_f32 v246, v246, v186
    v_add_f32 v247, v247, v190
    v_add_f32 v248, v248, v194
    v_add_f32 v246, v246, v187
    v_add_f32 v247, v247, v191
    v_add_f32 v248, v248, v195
    v_cvt_pk_bf16_f32 v148, v148, v149
    v_cvt_pk_bf16_f32 v149, v150, v151
    v_cvt_pk_bf16_f32 v150, v160, v161
    v_cvt_pk_bf16_f32 v151, v162, v163
    v_cvt_pk_bf16_f32 v152, v152, v153
    v_cvt_pk_bf16_f32 v153, v154, v155
    v_cvt_pk_bf16_f32 v154, v164, v165
    v_cvt_pk_bf16_f32 v155, v166, v167
    v_cvt_pk_bf16_f32 v156, v156, v157
    v_cvt_pk_bf16_f32 v157, v158, v159
    v_cvt_pk_bf16_f32 v158, v168, v169
    v_cvt_pk_bf16_f32 v159, v170, v171
    v_cvt_pk_bf16_f32 v172, v172, v173
    v_cvt_pk_bf16_f32 v173, v174, v175
    v_cvt_pk_bf16_f32 v174, v184, v185
    v_cvt_pk_bf16_f32 v175, v186, v187
    v_cvt_pk_bf16_f32 v176, v176, v177
    v_cvt_pk_bf16_f32 v177, v178, v179
    v_cvt_pk_bf16_f32 v178, v188, v189
    v_cvt_pk_bf16_f32 v179, v190, v191
    v_cvt_pk_bf16_f32 v180, v180, v181
    v_cvt_pk_bf16_f32 v181, v182, v183
    v_cvt_pk_bf16_f32 v182, v192, v193
    v_cvt_pk_bf16_f32 v183, v194, v195
    s_nop 1
    ds_read_b64_tr_b16 v[196:197], v232 offset:16384
    ds_read_b64_tr_b16 v[198:199], v232 offset:20480
    ds_read_b64_tr_b16 v[200:201], v232 offset:24576
    ds_read_b64_tr_b16 v[202:203], v232 offset:28672
    ds_read_b64_tr_b16 v[204:205], v233 offset:16384
    ds_read_b64_tr_b16 v[206:207], v233 offset:20480
    ds_read_b64_tr_b16 v[208:209], v233 offset:24576
    ds_read_b64_tr_b16 v[210:211], v233 offset:28672
    ds_read_b64_tr_b16 v[212:213], v234 offset:16384
    ds_read_b64_tr_b16 v[214:215], v234 offset:20480
    s_waitcnt lgkmcnt(8)
    v_mfma_f32_16x16x32_bf16 v[52:55], v[196:199], v[148:151], v[52:55]
    v_mfma_f32_16x16x32_bf16 v[84:87], v[196:199], v[152:155], v[84:87]
    v_mfma_f32_16x16x32_bf16 v[116:119], v[196:199], v[156:159], v[116:119]
    ds_read_b64_tr_b16 v[216:217], v234 offset:24576
    ds_read_b64_tr_b16 v[218:219], v234 offset:28672
    s_waitcnt lgkmcnt(8)
    v_mfma_f32_16x16x32_bf16 v[52:55], v[200:203], v[172:175], v[52:55]
    v_mfma_f32_16x16x32_bf16 v[84:87], v[200:203], v[176:179], v[84:87]
    v_mfma_f32_16x16x32_bf16 v[116:119], v[200:203], v[180:183], v[116:119]
    ds_read_b64_tr_b16 v[220:221], v235 offset:16384
    ds_read_b64_tr_b16 v[222:223], v235 offset:20480
    s_waitcnt lgkmcnt(8)
    v_mfma_f32_16x16x32_bf16 v[56:59], v[204:207], v[148:151], v[56:59]
    v_mfma_f32_16x16x32_bf16 v[88:91], v[204:207], v[152:155], v[88:91]
    v_mfma_f32_16x16x32_bf16 v[120:123], v[204:207], v[156:159], v[120:123]
    ds_read_b64_tr_b16 v[224:225], v235 offset:24576
    ds_read_b64_tr_b16 v[226:227], v235 offset:28672
    s_waitcnt lgkmcnt(8)
    v_mfma_f32_16x16x32_bf16 v[56:59], v[208:211], v[172:175], v[56:59]
    v_mfma_f32_16x16x32_bf16 v[88:91], v[208:211], v[176:179], v[88:91]
    v_mfma_f32_16x16x32_bf16 v[120:123], v[208:211], v[180:183], v[120:123]
    ds_read_b64_tr_b16 v[196:197], v236 offset:16384
    ds_read_b64_tr_b16 v[198:199], v236 offset:20480
    s_waitcnt lgkmcnt(8)
    v_mfma_f32_16x16x32_bf16 v[60:63], v[212:215], v[148:151], v[60:63]
    v_mfma_f32_16x16x32_bf16 v[92:95], v[212:215], v[152:155], v[92:95]
    v_mfma_f32_16x16x32_bf16 v[124:127], v[212:215], v[156:159], v[124:127]
    ds_read_b64_tr_b16 v[200:201], v236 offset:24576
    ds_read_b64_tr_b16 v[202:203], v236 offset:28672
    s_waitcnt lgkmcnt(8)
    v_mfma_f32_16x16x32_bf16 v[60:63], v[216:219], v[172:175], v[60:63]
    v_mfma_f32_16x16x32_bf16 v[92:95], v[216:219], v[176:179], v[92:95]
    v_mfma_f32_16x16x32_bf16 v[124:127], v[216:219], v[180:183], v[124:127]
    ds_read_b64_tr_b16 v[204:205], v237 offset:16384
    ds_read_b64_tr_b16 v[206:207], v237 offset:20480
    s_waitcnt lgkmcnt(8)
    v_mfma_f32_16x16x32_bf16 v[64:67], v[220:223], v[148:151], v[64:67]
    v_mfma_f32_16x16x32_bf16 v[96:99], v[220:223], v[152:155], v[96:99]
    v_mfma_f32_16x16x32_bf16 v[128:131], v[220:223], v[156:159], v[128:131]
    ds_read_b64_tr_b16 v[208:209], v237 offset:24576
    ds_read_b64_tr_b16 v[210:211], v237 offset:28672
    s_waitcnt lgkmcnt(8)
    v_mfma_f32_16x16x32_bf16 v[64:67], v[224:227], v[172:175], v[64:67]
    v_mfma_f32_16x16x32_bf16 v[96:99], v[224:227], v[176:179], v[96:99]
    v_mfma_f32_16x16x32_bf16 v[128:131], v[224:227], v[180:183], v[128:131]
    ds_read_b64_tr_b16 v[212:213], v238 offset:16384
    ds_read_b64_tr_b16 v[214:215], v238 offset:20480
    s_waitcnt lgkmcnt(8)
    v_mfma_f32_16x16x32_bf16 v[68:71], v[196:199], v[148:151], v[68:71]
    v_mfma_f32_16x16x32_bf16 v[100:103], v[196:199], v[152:155], v[100:103]
    v_mfma_f32_16x16x32_bf16 v[132:135], v[196:199], v[156:159], v[132:135]
    ds_read_b64_tr_b16 v[216:217], v238 offset:24576
    ds_read_b64_tr_b16 v[218:219], v238 offset:28672
    s_waitcnt lgkmcnt(8)
    v_mfma_f32_16x16x32_bf16 v[68:71], v[200:203], v[172:175], v[68:71]
    v_mfma_f32_16x16x32_bf16 v[100:103], v[200:203], v[176:179], v[100:103]
    v_mfma_f32_16x16x32_bf16 v[132:135], v[200:203], v[180:183], v[132:135]
    ds_read_b64_tr_b16 v[220:221], v239 offset:16384
    ds_read_b64_tr_b16 v[222:223], v239 offset:20480
    s_waitcnt lgkmcnt(8)
    v_mfma_f32_16x16x32_bf16 v[72:75], v[204:207], v[148:151], v[72:75]
    v_mfma_f32_16x16x32_bf16 v[104:107], v[204:207], v[152:155], v[104:107]
    v_mfma_f32_16x16x32_bf16 v[136:139], v[204:207], v[156:159], v[136:139]
    ds_read_b64_tr_b16 v[224:225], v239 offset:24576
    ds_read_b64_tr_b16 v[226:227], v239 offset:28672
    s_waitcnt lgkmcnt(8)
    v_mfma_f32_16x16x32_bf16 v[72:75], v[208:211], v[172:175], v[72:75]
    v_mfma_f32_16x16x32_bf16 v[104:107], v[208:211], v[176:179], v[104:107]
    v_mfma_f32_16x16x32_bf16 v[136:139], v[208:211], v[180:183], v[136:139]
    s_waitcnt lgkmcnt(6)
    v_mfma_f32_16x16x32_bf16 v[76:79], v[212:215], v[148:151], v[76:79]
    v_mfma_f32_16x16x32_bf16 v[108:111], v[212:215], v[152:155], v[108:111]
    v_mfma_f32_16x16x32_bf16 v[140:143], v[212:215], v[156:159], v[140:143]
    s_waitcnt lgkmcnt(4)
    v_mfma_f32_16x16x32_bf16 v[76:79], v[216:219], v[172:175], v[76:79]
    v_mfma_f32_16x16x32_bf16 v[108:111], v[216:219], v[176:179], v[108:111]
    v_mfma_f32_16x16x32_bf16 v[140:143], v[216:219], v[180:183], v[140:143]
    s_waitcnt lgkmcnt(2)
    v_mfma_f32_16x16x32_bf16 v[80:83], v[220:223], v[148:151], v[80:83]
    v_mfma_f32_16x16x32_bf16 v[112:115], v[220:223], v[152:155], v[112:115]
    v_mfma_f32_16x16x32_bf16 v[144:147], v[220:223], v[156:159], v[144:147]
    s_waitcnt lgkmcnt(0)
    v_mfma_f32_16x16x32_bf16 v[80:83], v[224:227], v[172:175], v[80:83]
    v_mfma_f32_16x16x32_bf16 v[112:115], v[224:227], v[176:179], v[112:115]
    v_mfma_f32_16x16x32_bf16 v[144:147], v[224:227], v[180:183], v[144:147]
    s_waitcnt vmcnt(4)
    s_barrier
    ds_read_b128 v[196:199], v228 offset:32768
    ds_read_b128 v[200:203], v229 offset:32768
    ds_read_b128 v[204:207], v230 offset:32768
    ds_read_b128 v[208:211], v231 offset:32768
    ds_read_b128 v[212:215], v228 offset:36864
    ds_read_b128 v[216:219], v229 offset:36864
    ds_read_b128 v[220:223], v230 offset:36864
    ds_read_b128 v[224:227], v231 offset:36864
    s_waitcnt lgkmcnt(4)
    v_mfma_f32_16x16x32_bf16 v[148:151], v[196:199], v[4:7], 0
    v_mfma_f32_16x16x32_bf16 v[152:155], v[196:199], v[20:23], 0
    v_mfma_f32_16x16x32_bf16 v[156:159], v[196:199], v[36:39], 0
    v_mfma_f32_16x16x32_bf16 v[148:151], v[200:203], v[8:11], v[148:151]
    v_mfma_f32_16x16x32_bf16 v[152:155], v[200:203], v[24:27], v[152:155]
    v_mfma_f32_16x16x32_bf16 v[156:159], v[200:203], v[40:43], v[156:159]
    v_mfma_f32_16x16x32_bf16 v[148:151], v[204:207], v[12:15], v[148:151]
    v_mfma_f32_16x16x32_bf16 v[152:155], v[204:207], v[28:31], v[152:155]
    v_mfma_f32_16x16x32_bf16 v[156:159], v[204:207], v[44:47], v[156:159]
    v_mfma_f32_16x16x32_bf16 v[148:151], v[208:211], v[16:19], v[148:151]
    v_mfma_f32_16x16x32_bf16 v[152:155], v[208:211], v[32:35], v[152:155]
    v_mfma_f32_16x16x32_bf16 v[156:159], v[208:211], v[48:51], v[156:159]
    ds_read_b128 v[196:199], v228 offset:40960
    ds_read_b128 v[200:203], v229 offset:40960
    ds_read_b128 v[204:207], v230 offset:40960
    ds_read_b128 v[208:211], v231 offset:40960
    s_waitcnt lgkmcnt(4)
    v_mfma_f32_16x16x32_bf16 v[160:163], v[212:215], v[4:7], 0
    v_mfma_f32_16x16x32_bf16 v[164:167], v[212:215], v[20:23], 0
    v_mfma_f32_16x16x32_bf16 v[168:171], v[212:215], v[36:39], 0
    v_mfma_f32_16x16x32_bf16 v[160:163], v[216:219], v[8:11], v[160:163]
    v_mfma_f32_16x16x32_bf16 v[164:167], v[216:219], v[24:27], v[164:167]
    v_mfma_f32_16x16x32_bf16 v[168:171], v[216:219], v[40:43], v[168:171]
    v_mfma_f32_16x16x32_bf16 v[160:163], v[220:223], v[12:15], v[160:163]
    v_mfma_f32_16x16x32_bf16 v[164:167], v[220:223], v[28:31], v[164:167]
    v_mfma_f32_16x16x32_bf16 v[168:171], v[220:223], v[44:47], v[168:171]
    v_mfma_f32_16x16x32_bf16 v[160:163], v[224:227], v[16:19], v[160:163]
    v_mfma_f32_16x16x32_bf16 v[164:167], v[224:227], v[32:35], v[164:167]
    v_mfma_f32_16x16x32_bf16 v[168:171], v[224:227], v[48:51], v[168:171]
    ds_read_b128 v[212:215], v228 offset:45056
    ds_read_b128 v[216:219], v229 offset:45056
    ds_read_b128 v[220:223], v230 offset:45056
    ds_read_b128 v[224:227], v231 offset:45056
    s_waitcnt lgkmcnt(4)
    v_mfma_f32_16x16x32_bf16 v[172:175], v[196:199], v[4:7], 0
    v_mfma_f32_16x16x32_bf16 v[176:179], v[196:199], v[20:23], 0
    v_mfma_f32_16x16x32_bf16 v[180:183], v[196:199], v[36:39], 0
    v_mfma_f32_16x16x32_bf16 v[172:175], v[200:203], v[8:11], v[172:175]
    v_mfma_f32_16x16x32_bf16 v[176:179], v[200:203], v[24:27], v[176:179]
    v_mfma_f32_16x16x32_bf16 v[180:183], v[200:203], v[40:43], v[180:183]
    v_mfma_f32_16x16x32_bf16 v[172:175], v[204:207], v[12:15], v[172:175]
    v_mfma_f32_16x16x32_bf16 v[176:179], v[204:207], v[28:31], v[176:179]
    v_mfma_f32_16x16x32_bf16 v[180:183], v[204:207], v[44:47], v[180:183]
    v_mfma_f32_16x16x32_bf16 v[172:175], v[208:211], v[16:19], v[172:175]
    v_mfma_f32_16x16x32_bf16 v[176:179], v[208:211], v[32:35], v[176:179]
    v_mfma_f32_16x16x32_bf16 v[180:183], v[208:211], v[48:51], v[180:183]
    s_waitcnt lgkmcnt(0)
    v_mfma_f32_16x16x32_bf16 v[184:187], v[212:215], v[4:7], 0
    v_mfma_f32_16x16x32_bf16 v[188:191], v[212:215], v[20:23], 0
    v_mfma_f32_16x16x32_bf16 v[192:195], v[212:215], v[36:39], 0
    v_mfma_f32_16x16x32_bf16 v[184:187], v[216:219], v[8:11], v[184:187]
    v_mfma_f32_16x16x32_bf16 v[188:191], v[216:219], v[24:27], v[188:191]
    v_mfma_f32_16x16x32_bf16 v[192:195], v[216:219], v[40:43], v[192:195]
    v_mfma_f32_16x16x32_bf16 v[184:187], v[220:223], v[12:15], v[184:187]
    v_mfma_f32_16x16x32_bf16 v[188:191], v[220:223], v[28:31], v[188:191]
    v_mfma_f32_16x16x32_bf16 v[192:195], v[220:223], v[44:47], v[192:195]
    v_mfma_f32_16x16x32_bf16 v[184:187], v[224:227], v[16:19], v[184:187]
    v_mfma_f32_16x16x32_bf16 v[188:191], v[224:227], v[32:35], v[188:191]
    v_mfma_f32_16x16x32_bf16 v[192:195], v[224:227], v[48:51], v[192:195]
    s_waitcnt vmcnt(0)
    s_barrier
    s_nop 7
    v_max3_f32 v249, v148, v149, v150
    v_max3_f32 v250, v152, v153, v154
    v_max3_f32 v251, v156, v157, v158
    v_max3_f32 v249, v249, v151, v160
    v_max3_f32 v250, v250, v155, v164
    v_max3_f32 v251, v251, v159, v168
    v_max3_f32 v249, v249, v161, v162
    v_max3_f32 v250, v250, v165, v166
    v_max3_f32 v251, v251, v169, v170
    v_max3_f32 v249, v249, v163, v172
    v_max3_f32 v250, v250, v167, v176
    v_max3_f32 v251, v251, v171, v180
    v_max3_f32 v249, v249, v173, v174
    v_max3_f32 v250, v250, v177, v178
    v_max3_f32 v251, v251, v181, v182
    v_max3_f32 v249, v249, v175, v184
    v_max3_f32 v250, v250, v179, v188
    v_max3_f32 v251, v251, v183, v192
    v_max3_f32 v249, v249, v185, v186
    v_max3_f32 v250, v250, v189, v190
    v_max3_f32 v251, v251, v193, v194
    v_max_f32 v249, v249, v187
    v_max_f32 v250, v250, v191
    v_max_f32 v251, v251, v195
    v_mov_b32 v252, v249
    v_mov_b32 v253, v250
    v_mov_b32 v254, v251
    s_nop 0
    v_permlane32_swap_b32 v249, v252
    v_permlane32_swap_b32 v250, v253
    v_permlane32_swap_b32 v251, v254
    v_max_f32 v249, v249, v252
    v_max_f32 v250, v250, v253
    v_max_f32 v251, v251, v254
    v_mov_b32 v252, v249
    v_mov_b32 v253, v250
    v_mov_b32 v254, v251
    s_nop 0
    v_permlane16_swap_b32 v249, v252
    v_permlane16_swap_b32 v250, v253
    v_permlane16_swap_b32 v251, v254
    v_max_f32 v249, v249, v252
    v_max_f32 v250, v250, v253
    v_max_f32 v251, v251, v254
    v_mul_f32 v249, s29, v249
    v_mul_f32 v250, s29, v250
    v_mul_f32 v251, s29, v251
    v_sub_f32 v252, v249, v243
    v_sub_f32 v253, v250, v244
    v_sub_f32 v254, v251, v245
    v_max3_f32 v255, v252, v253, v254
    v_cmp_lt_f32 vcc, s30, v255
    s_cbranch_vccz L_norescale_d
    v_max_f32 v249, v249, v243
    v_max_f32 v250, v250, v244
    v_max_f32 v251, v251, v245
    v_sub_f32 v252, v243, v249
    v_sub_f32 v253, v244, v250
    v_sub_f32 v254, v245, v251
    v_exp_f32 v252, v252
    v_exp_f32 v253, v253
    v_exp_f32 v254, v254
    v_mov_b32 v243, v249
    v_mov_b32 v244, v250
    v_mov_b32 v245, v251
    v_mul_f32 v246, v246, v252
    v_mul_f32 v247, v247, v253
    v_mul_f32 v248, v248, v254
    v_mul_f32 v52, v52, v252
    v_mul_f32 v53, v53, v252
    v_mul_f32 v54, v54, v252
    v_mul_f32 v55, v55, v252
    v_mul_f32 v56, v56, v252
    v_mul_f32 v57, v57, v252
    v_mul_f32 v58, v58, v252
    v_mul_f32 v59, v59, v252
    v_mul_f32 v60, v60, v252
    v_mul_f32 v61, v61, v252
    v_mul_f32 v62, v62, v252
    v_mul_f32 v63, v63, v252
    v_mul_f32 v64, v64, v252
    v_mul_f32 v65, v65, v252
    v_mul_f32 v66, v66, v252
    v_mul_f32 v67, v67, v252
    v_mul_f32 v68, v68, v252
    v_mul_f32 v69, v69, v252
    v_mul_f32 v70, v70, v252
    v_mul_f32 v71, v71, v252
    v_mul_f32 v72, v72, v252
    v_mul_f32 v73, v73, v252
    v_mul_f32 v74, v74, v252
    v_mul_f32 v75, v75, v252
    v_mul_f32 v76, v76, v252
    v_mul_f32 v77, v77, v252
    v_mul_f32 v78, v78, v252
    v_mul_f32 v79, v79, v252
    v_mul_f32 v80, v80, v252
    v_mul_f32 v81, v81, v252
    v_mul_f32 v82, v82, v252
    v_mul_f32 v83, v83, v252
    v_mul_f32 v84, v84, v253
    v_mul_f32 v85, v85, v253
    v_mul_f32 v86, v86, v253
    v_mul_f32 v87, v87, v253
    v_mul_f32 v88, v88, v253
    v_mul_f32 v89, v89, v253
    v_mul_f32 v90, v90, v253
    v_mul_f32 v91, v91, v253
    v_mul_f32 v92, v92, v253
    v_mul_f32 v93, v93, v253
    v_mul_f32 v94, v94, v253
    v_mul_f32 v95, v95, v253
    v_mul_f32 v96, v96, v253
    v_mul_f32 v97, v97, v253
    v_mul_f32 v98, v98, v253
    v_mul_f32 v99, v99, v253
    v_mul_f32 v100, v100, v253
    v_mul_f32 v101, v101, v253
    v_mul_f32 v102, v102, v253
    v_mul_f32 v103, v103, v253
    v_mul_f32 v104, v104, v253
    v_mul_f32 v105, v105, v253
    v_mul_f32 v106, v106, v253
    v_mul_f32 v107, v107, v253
    v_mul_f32 v108, v108, v253
    v_mul_f32 v109, v109, v253
    v_mul_f32 v110, v110, v253
    v_mul_f32 v111, v111, v253
    v_mul_f32 v112, v112, v253
    v_mul_f32 v113, v113, v253
    v_mul_f32 v114, v114, v253
    v_mul_f32 v115, v115, v253
    v_mul_f32 v116, v116, v254
    v_mul_f32 v117, v117, v254
    v_mul_f32 v118, v118, v254
    v_mul_f32 v119, v119, v254
    v_mul_f32 v120, v120, v254
    v_mul_f32 v121, v121, v254
    v_mul_f32 v122, v122, v254
    v_mul_f32 v123, v123, v254
    v_mul_f32 v124, v124, v254
    v_mul_f32 v125, v125, v254
    v_mul_f32 v126, v126, v254
    v_mul_f32 v127, v127, v254
    v_mul_f32 v128, v128, v254
    v_mul_f32 v129, v129, v254
    v_mul_f32 v130, v130, v254
    v_mul_f32 v131, v131, v254
    v_mul_f32 v132, v132, v254
    v_mul_f32 v133, v133, v254
    v_mul_f32 v134, v134, v254
    v_mul_f32 v135, v135, v254
    v_mul_f32 v136, v136, v254
    v_mul_f32 v137, v137, v254
    v_mul_f32 v138, v138, v254
    v_mul_f32 v139, v139, v254
    v_mul_f32 v140, v140, v254
    v_mul_f32 v141, v141, v254
    v_mul_f32 v142, v142, v254
    v_mul_f32 v143, v143, v254
    v_mul_f32 v144, v144, v254
    v_mul_f32 v145, v145, v254
    v_mul_f32 v146, v146, v254
    v_mul_f32 v147, v147, v254
L_norescale_d:
    v_fma_f32 v148, v148, s29, -v243
    v_fma_f32 v149, v149, s29, -v243
    v_fma_f32 v150, v150, s29, -v243
    v_fma_f32 v151, v151, s29, -v243
    v_fma_f32 v152, v152, s29, -v244
    v_fma_f32 v153, v153, s29, -v244
    v_fma_f32 v154, v154, s29, -v244
    v_fma_f32 v155, v155, s29, -v244
    v_fma_f32 v156, v156, s29, -v245
    v_fma_f32 v157, v157, s29, -v245
    v_fma_f32 v158, v158, s29, -v245
    v_fma_f32 v159, v159, s29, -v245
    v_exp_f32 v148, v148
    v_exp_f32 v149, v149
    v_exp_f32 v150, v150
    v_exp_f32 v151, v151
    v_exp_f32 v152, v152
    v_exp_f32 v153, v153
    v_exp_f32 v154, v154
    v_exp_f32 v155, v155
    v_exp_f32 v156, v156
    v_exp_f32 v157, v157
    v_exp_f32 v158, v158
    v_exp_f32 v159, v159
    v_add_f32 v246, v246, v148
    v_add_f32 v247, v247, v152
    v_add_f32 v248, v248, v156
    v_add_f32 v246, v246, v149
    v_add_f32 v247, v247, v153
    v_add_f32 v248, v248, v157
    v_add_f32 v246, v246, v150
    v_add_f32 v247, v247, v154
    v_add_f32 v248, v248, v158
    v_add_f32 v246, v246, v151
    v_add_f32 v247, v247, v155
    v_add_f32 v248, v248, v159
    v_fma_f32 v160, v160, s29, -v243
    v_fma_f32 v161, v161, s29, -v243
    v_fma_f32 v162, v162, s29, -v243
    v_fma_f32 v163, v163, s29, -v243
    v_fma_f32 v164, v164, s29, -v244
    v_fma_f32 v165, v165, s29, -v244
    v_fma_f32 v166, v166, s29, -v244
    v_fma_f32 v167, v167, s29, -v244
    v_fma_f32 v168, v168, s29, -v245
    v_fma_f32 v169, v169, s29, -v245
    v_fma_f32 v170, v170, s29, -v245
    v_fma_f32 v171, v171, s29, -v245
    v_exp_f32 v160, v160
    v_exp_f32 v161, v161
    v_exp_f32 v162, v162
    v_exp_f32 v163, v163
    v_exp_f32 v164, v164
    v_exp_f32 v165, v165
    v_exp_f32 v166, v166
    v_exp_f32 v167, v167
    v_exp_f32 v168, v168
    v_exp_f32 v169, v169
    v_exp_f32 v170, v170
    v_exp_f32 v171, v171
    v_add_f32 v246, v246, v160
    v_add_f32 v247, v247, v164
    v_add_f32 v248, v248, v168
    v_add_f32 v246, v246, v161
    v_add_f32 v247, v247, v165
    v_add_f32 v248, v248, v169
    v_add_f32 v246, v246, v162
    v_add_f32 v247, v247, v166
    v_add_f32 v248, v248, v170
    v_add_f32 v246, v246, v163
    v_add_f32 v247, v247, v167
    v_add_f32 v248, v248, v171
    v_fma_f32 v172, v172, s29, -v243
    v_fma_f32 v173, v173, s29, -v243
    v_fma_f32 v174, v174, s29, -v243
    v_fma_f32 v175, v175, s29, -v243
    v_fma_f32 v176, v176, s29, -v244
    v_fma_f32 v177, v177, s29, -v244
    v_fma_f32 v178, v178, s29, -v244
    v_fma_f32 v179, v179, s29, -v244
    v_fma_f32 v180, v180, s29, -v245
    v_fma_f32 v181, v181, s29, -v245
    v_fma_f32 v182, v182, s29, -v245
    v_fma_f32 v183, v183, s29, -v245
    v_exp_f32 v172, v172
    v_exp_f32 v173, v173
    v_exp_f32 v174, v174
    v_exp_f32 v175, v175
    v_exp_f32 v176, v176
    v_exp_f32 v177, v177
    v_exp_f32 v178, v178
    v_exp_f32 v179, v179
    v_exp_f32 v180, v180
    v_exp_f32 v181, v181
    v_exp_f32 v182, v182
    v_exp_f32 v183, v183
    v_add_f32 v246, v246, v172
    v_add_f32 v247, v247, v176
    v_add_f32 v248, v248, v180
    v_add_f32 v246, v246, v173
    v_add_f32 v247, v247, v177
    v_add_f32 v248, v248, v181
    v_add_f32 v246, v246, v174
    v_add_f32 v247, v247, v178
    v_add_f32 v248, v248, v182
    v_add_f32 v246, v246, v175
    v_add_f32 v247, v247, v179
    v_add_f32 v248, v248, v183
    v_fma_f32 v184, v184, s29, -v243
    v_fma_f32 v185, v185, s29, -v243
    v_fma_f32 v186, v186, s29, -v243
    v_fma_f32 v187, v187, s29, -v243
    v_fma_f32 v188, v188, s29, -v244
    v_fma_f32 v189, v189, s29, -v244
    v_fma_f32 v190, v190, s29, -v244
    v_fma_f32 v191, v191, s29, -v244
    v_fma_f32 v192, v192, s29, -v245
    v_fma_f32 v193, v193, s29, -v245
    v_fma_f32 v194, v194, s29, -v245
    v_fma_f32 v195, v195, s29, -v245
    v_exp_f32 v184, v184
    v_exp_f32 v185, v185
    v_exp_f32 v186, v186
    v_exp_f32 v187, v187
    v_exp_f32 v188, v188
    v_exp_f32 v189, v189
    v_exp_f32 v190, v190
    v_exp_f32 v191, v191
    v_exp_f32 v192, v192
    v_exp_f32 v193, v193
    v_exp_f32 v194, v194
    v_exp_f32 v195, v195
    v_add_f32 v246, v246, v184
    v_add_f32 v247, v247, v188
    v_add_f32 v248, v248, v192
    v_add_f32 v246, v246, v185
    v_add_f32 v247, v247, v189
    v_add_f32 v248, v248, v193
    v_add_f32 v246, v246, v186
    v_add_f32 v247, v247, v190
    v_add_f32 v248, v248, v194
    v_add_f32 v246, v246, v187
    v_add_f32 v247, v247, v191
    v_add_f32 v248, v248, v195
    v_cvt_pk_bf16_f32 v148, v148, v149
    v_cvt_pk_bf16_f32 v149, v150, v151
    v_cvt_pk_bf16_f32 v150, v160, v161
    v_cvt_pk_bf16_f32 v151, v162, v163
    v_cvt_pk_bf16_f32 v152, v152, v153
    v_cvt_pk_bf16_f32 v153, v154, v155
    v_cvt_pk_bf16_f32 v154, v164, v165
    v_cvt_pk_bf16_f32 v155, v166, v167
    v_cvt_pk_bf16_f32 v156, v156, v157
    v_cvt_pk_bf16_f32 v157, v158, v159
    v_cvt_pk_bf16_f32 v158, v168, v169
    v_cvt_pk_bf16_f32 v159, v170, v171
    v_cvt_pk_bf16_f32 v172, v172, v173
    v_cvt_pk_bf16_f32 v173, v174, v175
    v_cvt_pk_bf16_f32 v174, v184, v185
    v_cvt_pk_bf16_f32 v175, v186, v187
    v_cvt_pk_bf16_f32 v176, v176, v177
    v_cvt_pk_bf16_f32 v177, v178, v179
    v_cvt_pk_bf16_f32 v178, v188, v189
    v_cvt_pk_bf16_f32 v179, v190, v191
    v_cvt_pk_bf16_f32 v180, v180, v181
    v_cvt_pk_bf16_f32 v181, v182, v183
    v_cvt_pk_bf16_f32 v182, v192, v193
    v_cvt_pk_bf16_f32 v183, v194, v195
    s_nop 1
    ds_read_b64_tr_b16 v[196:197], v232 offset:49152
    ds_read_b64_tr_b16 v[198:199], v232 offset:53248
    ds_read_b64_tr_b16 v[200:201], v232 offset:57344
    ds_read_b64_tr_b16 v[202:203], v232 offset:61440
    ds_read_b64_tr_b16 v[204:205], v233 offset:49152
    ds_read_b64_tr_b16 v[206:207], v233 offset:53248
    ds_read_b64_tr_b16 v[208:209], v233 offset:57344
    ds_read_b64_tr_b16 v[210:211], v233 offset:61440
    ds_read_b64_tr_b16 v[212:213], v234 offset:49152
    ds_read_b64_tr_b16 v[214:215], v234 offset:53248
    s_waitcnt lgkmcnt(8)
    v_mfma_f32_16x16x32_bf16 v[52:55], v[196:199], v[148:151], v[52:55]
    v_mfma_f32_16x16x32_bf16 v[84:87], v[196:199], v[152:155], v[84:87]
    v_mfma_f32_16x16x32_bf16 v[116:119], v[196:199], v[156:159], v[116:119]
    ds_read_b64_tr_b16 v[216:217], v234 offset:57344
    ds_read_b64_tr_b16 v[218:219], v234 offset:61440
    s_waitcnt lgkmcnt(8)
    v_mfma_f32_16x16x32_bf16 v[52:55], v[200:203], v[172:175], v[52:55]
    v_mfma_f32_16x16x32_bf16 v[84:87], v[200:203], v[176:179], v[84:87]
    v_mfma_f32_16x16x32_bf16 v[116:119], v[200:203], v[180:183], v[116:119]
    ds_read_b64_tr_b16 v[220:221], v235 offset:49152
    ds_read_b64_tr_b16 v[222:223], v235 offset:53248
    s_waitcnt lgkmcnt(8)
    v_mfma_f32_16x16x32_bf16 v[56:59], v[204:207], v[148:151], v[56:59]
    v_mfma_f32_16x16x32_bf16 v[88:91], v[204:207], v[152:155], v[88:91]
    v_mfma_f32_16x16x32_bf16 v[120:123], v[204:207], v[156:159], v[120:123]
    ds_read_b64_tr_b16 v[224:225], v235 offset:57344
    ds_read_b64_tr_b16 v[226:227], v235 offset:61440
    s_waitcnt lgkmcnt(8)
    v_mfma_f32_16x16x32_bf16 v[56:59], v[208:211], v[172:175], v[56:59]
    v_mfma_f32_16x16x32_bf16 v[88:91], v[208:211], v[176:179], v[88:91]
    v_mfma_f32_16x16x32_bf16 v[120:123], v[208:211], v[180:183], v[120:123]
    ds_read_b64_tr_b16 v[196:197], v236 offset:49152
    ds_read_b64_tr_b16 v[198:199], v236 offset:53248
    s_waitcnt lgkmcnt(8)
    v_mfma_f32_16x16x32_bf16 v[60:63], v[212:215], v[148:151], v[60:63]
    v_mfma_f32_16x16x32_bf16 v[92:95], v[212:215], v[152:155], v[92:95]
    v_mfma_f32_16x16x32_bf16 v[124:127], v[212:215], v[156:159], v[124:127]
    ds_read_b64_tr_b16 v[200:201], v236 offset:57344
    ds_read_b64_tr_b16 v[202:203], v236 offset:61440
    s_waitcnt lgkmcnt(8)
    v_mfma_f32_16x16x32_bf16 v[60:63], v[216:219], v[172:175], v[60:63]
    v_mfma_f32_16x16x32_bf16 v[92:95], v[216:219], v[176:179], v[92:95]
    v_mfma_f32_16x16x32_bf16 v[124:127], v[216:219], v[180:183], v[124:127]
    ds_read_b64_tr_b16 v[204:205], v237 offset:49152
    ds_read_b64_tr_b16 v[206:207], v237 offset:53248
    s_waitcnt lgkmcnt(8)
    v_mfma_f32_16x16x32_bf16 v[64:67], v[220:223], v[148:151], v[64:67]
    v_mfma_f32_16x16x32_bf16 v[96:99], v[220:223], v[152:155], v[96:99]
    v_mfma_f32_16x16x32_bf16 v[128:131], v[220:223], v[156:159], v[128:131]
    ds_read_b64_tr_b16 v[208:209], v237 offset:57344
    ds_read_b64_tr_b16 v[210:211], v237 offset:61440
    s_waitcnt lgkmcnt(8)
    v_mfma_f32_16x16x32_bf16 v[64:67], v[224:227], v[172:175], v[64:67]
    v_mfma_f32_16x16x32_bf16 v[96:99], v[224:227], v[176:179], v[96:99]
    v_mfma_f32_16x16x32_bf16 v[128:131], v[224:227], v[180:183], v[128:131]
    ds_read_b64_tr_b16 v[212:213], v238 offset:49152
    ds_read_b64_tr_b16 v[214:215], v238 offset:53248
    s_waitcnt lgkmcnt(8)
    v_mfma_f32_16x16x32_bf16 v[68:71], v[196:199], v[148:151], v[68:71]
    v_mfma_f32_16x16x32_bf16 v[100:103], v[196:199], v[152:155], v[100:103]
    v_mfma_f32_16x16x32_bf16 v[132:135], v[196:199], v[156:159], v[132:135]
    ds_read_b64_tr_b16 v[216:217], v238 offset:57344
    ds_read_b64_tr_b16 v[218:219], v238 offset:61440
    s_waitcnt lgkmcnt(8)
    v_mfma_f32_16x16x32_bf16 v[68:71], v[200:203], v[172:175], v[68:71]
    v_mfma_f32_16x16x32_bf16 v[100:103], v[200:203], v[176:179], v[100:103]
    v_mfma_f32_16x16x32_bf16 v[132:135], v[200:203], v[180:183], v[132:135]
    ds_read_b64_tr_b16 v[220:221], v239 offset:49152
    ds_read_b64_tr_b16 v[222:223], v239 offset:53248
    s_waitcnt lgkmcnt(8)
    v_mfma_f32_16x16x32_bf16 v[72:75], v[204:207], v[148:151], v[72:75]
    v_mfma_f32_16x16x32_bf16 v[104:107], v[204:207], v[152:155], v[104:107]
    v_mfma_f32_16x16x32_bf16 v[136:139], v[204:207], v[156:159], v[136:139]
    ds_read_b64_tr_b16 v[224:225], v239 offset:57344
    ds_read_b64_tr_b16 v[226:227], v239 offset:61440
    s_waitcnt lgkmcnt(8)
    v_mfma_f32_16x16x32_bf16 v[72:75], v[208:211], v[172:175], v[72:75]
    v_mfma_f32_16x16x32_bf16 v[104:107], v[208:211], v[176:179], v[104:107]
    v_mfma_f32_16x16x32_bf16 v[136:139], v[208:211], v[180:183], v[136:139]
    s_waitcnt lgkmcnt(6)
    v_mfma_f32_16x16x32_bf16 v[76:79], v[212:215], v[148:151], v[76:79]
    v_mfma_f32_16x16x32_bf16 v[108:111], v[212:215], v[152:155], v[108:111]
    v_mfma_f32_16x16x32_bf16 v[140:143], v[212:215], v[156:159], v[140:143]
    s_waitcnt lgkmcnt(4)
    v_mfma_f32_16x16x32_bf16 v[76:79], v[216:219], v[172:175], v[76:79]
    v_mfma_f32_16x16x32_bf16 v[108:111], v[216:219], v[176:179], v[108:111]
    v_mfma_f32_16x16x32_bf16 v[140:143], v[216:219], v[180:183], v[140:143]
    s_waitcnt lgkmcnt(2)
    v_mfma_f32_16x16x32_bf16 v[80:83], v[220:223], v[148:151], v[80:83]
    v_mfma_f32_16x16x32_bf16 v[112:115], v[220:223], v[152:155], v[112:115]
    v_mfma_f32_16x16x32_bf16 v[144:147], v[220:223], v[156:159], v[144:147]
    s_waitcnt lgkmcnt(0)
    v_mfma_f32_16x16x32_bf16 v[80:83], v[224:227], v[172:175], v[80:83]
    v_mfma_f32_16x16x32_bf16 v[112:115], v[224:227], v[176:179], v[112:115]
    v_mfma_f32_16x16x32_bf16 v[144:147], v[224:227], v[180:183], v[144:147]
    v_mov_b32 v249, v246
    v_mov_b32 v250, v247
    v_mov_b32 v251, v248
    s_nop 0
    v_permlane32_swap_b32 v246, v249
    v_permlane32_swap_b32 v247, v250
    v_permlane32_swap_b32 v248, v251
    v_add_f32 v246, v246, v249
    v_add_f32 v247, v247, v250
    v_add_f32 v248, v248, v251
    v_mov_b32 v249, v246
    v_mov_b32 v250, v247
    v_mov_b32 v251, v248
    s_nop 0
    v_permlane16_swap_b32 v246, v249
    v_permlane16_swap_b32 v247, v250
    v_permlane16_swap_b32 v248, v251
    v_add_f32 v246, v246, v249
    v_add_f32 v247, v247, v250
    v_add_f32 v248, v248, v251
    v_rcp_f32 v246, v246
    v_rcp_f32 v247, v247
    v_rcp_f32 v248, v248
    s_nop 0
    s_mov_b32 s39, 0
    v_mul_f32 v52, v52, v246
    v_mul_f32 v53, v53, v246
    v_mul_f32 v54, v54, v246
    v_mul_f32 v55, v55, v246
    v_cvt_pk_bf16_f32 v52, v52, v53
    v_cvt_pk_bf16_f32 v53, v54, v55
    buffer_store_dwordx2 v[52:53], v2, s[24:27], s39 offen offset:0
    v_mul_f32 v56, v56, v246
    v_mul_f32 v57, v57, v246
    v_mul_f32 v58, v58, v246
    v_mul_f32 v59, v59, v246
    v_cvt_pk_bf16_f32 v56, v56, v57
    v_cvt_pk_bf16_f32 v57, v58, v59
    buffer_store_dwordx2 v[56:57], v2, s[24:27], s39 offen offset:32
    v_mul_f32 v60, v60, v246
    v_mul_f32 v61, v61, v246
    v_mul_f32 v62, v62, v246
    v_mul_f32 v63, v63, v246
    v_cvt_pk_bf16_f32 v60, v60, v61
    v_cvt_pk_bf16_f32 v61, v62, v63
    buffer_store_dwordx2 v[60:61], v2, s[24:27], s39 offen offset:64
    v_mul_f32 v64, v64, v246
    v_mul_f32 v65, v65, v246
    v_mul_f32 v66, v66, v246
    v_mul_f32 v67, v67, v246
    v_cvt_pk_bf16_f32 v64, v64, v65
    v_cvt_pk_bf16_f32 v65, v66, v67
    buffer_store_dwordx2 v[64:65], v2, s[24:27], s39 offen offset:96
    v_mul_f32 v68, v68, v246
    v_mul_f32 v69, v69, v246
    v_mul_f32 v70, v70, v246
    v_mul_f32 v71, v71, v246
    v_cvt_pk_bf16_f32 v68, v68, v69
    v_cvt_pk_bf16_f32 v69, v70, v71
    buffer_store_dwordx2 v[68:69], v2, s[24:27], s39 offen offset:128
    v_mul_f32 v72, v72, v246
    v_mul_f32 v73, v73, v246
    v_mul_f32 v74, v74, v246
    v_mul_f32 v75, v75, v246
    v_cvt_pk_bf16_f32 v72, v72, v73
    v_cvt_pk_bf16_f32 v73, v74, v75
    buffer_store_dwordx2 v[72:73], v2, s[24:27], s39 offen offset:160
    v_mul_f32 v76, v76, v246
    v_mul_f32 v77, v77, v246
    v_mul_f32 v78, v78, v246
    v_mul_f32 v79, v79, v246
    v_cvt_pk_bf16_f32 v76, v76, v77
    v_cvt_pk_bf16_f32 v77, v78, v79
    buffer_store_dwordx2 v[76:77], v2, s[24:27], s39 offen offset:192
    v_mul_f32 v80, v80, v246
    v_mul_f32 v81, v81, v246
    v_mul_f32 v82, v82, v246
    v_mul_f32 v83, v83, v246
    v_cvt_pk_bf16_f32 v80, v80, v81
    v_cvt_pk_bf16_f32 v81, v82, v83
    buffer_store_dwordx2 v[80:81], v2, s[24:27], s39 offen offset:224
    s_mov_b32 s39, 131072
    v_mul_f32 v84, v84, v247
    v_mul_f32 v85, v85, v247
    v_mul_f32 v86, v86, v247
    v_mul_f32 v87, v87, v247
    v_cvt_pk_bf16_f32 v84, v84, v85
    v_cvt_pk_bf16_f32 v85, v86, v87
    buffer_store_dwordx2 v[84:85], v2, s[24:27], s39 offen offset:0
    v_mul_f32 v88, v88, v247
    v_mul_f32 v89, v89, v247
    v_mul_f32 v90, v90, v247
    v_mul_f32 v91, v91, v247
    v_cvt_pk_bf16_f32 v88, v88, v89
    v_cvt_pk_bf16_f32 v89, v90, v91
    buffer_store_dwordx2 v[88:89], v2, s[24:27], s39 offen offset:32
    v_mul_f32 v92, v92, v247
    v_mul_f32 v93, v93, v247
    v_mul_f32 v94, v94, v247
    v_mul_f32 v95, v95, v247
    v_cvt_pk_bf16_f32 v92, v92, v93
    v_cvt_pk_bf16_f32 v93, v94, v95
    buffer_store_dwordx2 v[92:93], v2, s[24:27], s39 offen offset:64
    v_mul_f32 v96, v96, v247
    v_mul_f32 v97, v97, v247
    v_mul_f32 v98, v98, v247
    v_mul_f32 v99, v99, v247
    v_cvt_pk_bf16_f32 v96, v96, v97
    v_cvt_pk_bf16_f32 v97, v98, v99
    buffer_store_dwordx2 v[96:97], v2, s[24:27], s39 offen offset:96
    v_mul_f32 v100, v100, v247
    v_mul_f32 v101, v101, v247
    v_mul_f32 v102, v102, v247
    v_mul_f32 v103, v103, v247
    v_cvt_pk_bf16_f32 v100, v100, v101
    v_cvt_pk_bf16_f32 v101, v102, v103
    buffer_store_dwordx2 v[100:101], v2, s[24:27], s39 offen offset:128
    v_mul_f32 v104, v104, v247
    v_mul_f32 v105, v105, v247
    v_mul_f32 v106, v106, v247
    v_mul_f32 v107, v107, v247
    v_cvt_pk_bf16_f32 v104, v104, v105
    v_cvt_pk_bf16_f32 v105, v106, v107
    buffer_store_dwordx2 v[104:105], v2, s[24:27], s39 offen offset:160
    v_mul_f32 v108, v108, v247
    v_mul_f32 v109, v109, v247
    v_mul_f32 v110, v110, v247
    v_mul_f32 v111, v111, v247
    v_cvt_pk_bf16_f32 v108, v108, v109
    v_cvt_pk_bf16_f32 v109, v110, v111
    buffer_store_dwordx2 v[108:109], v2, s[24:27], s39 offen offset:192
    v_mul_f32 v112, v112, v247
    v_mul_f32 v113, v113, v247
    v_mul_f32 v114, v114, v247
    v_mul_f32 v115, v115, v247
    v_cvt_pk_bf16_f32 v112, v112, v113
    v_cvt_pk_bf16_f32 v113, v114, v115
    buffer_store_dwordx2 v[112:113], v2, s[24:27], s39 offen offset:224
    s_mov_b32 s39, 262144
    v_mul_f32 v116, v116, v248
    v_mul_f32 v117, v117, v248
    v_mul_f32 v118, v118, v248
    v_mul_f32 v119, v119, v248
    v_cvt_pk_bf16_f32 v116, v116, v117
    v_cvt_pk_bf16_f32 v117, v118, v119
    buffer_store_dwordx2 v[116:117], v2, s[24:27], s39 offen offset:0
    v_mul_f32 v120, v120, v248
    v_mul_f32 v121, v121, v248
    v_mul_f32 v122, v122, v248
    v_mul_f32 v123, v123, v248
    v_cvt_pk_bf16_f32 v120, v120, v121
    v_cvt_pk_bf16_f32 v121, v122, v123
    buffer_store_dwordx2 v[120:121], v2, s[24:27], s39 offen offset:32
    v_mul_f32 v124, v124, v248
    v_mul_f32 v125, v125, v248
    v_mul_f32 v126, v126, v248
    v_mul_f32 v127, v127, v248
    v_cvt_pk_bf16_f32 v124, v124, v125
    v_cvt_pk_bf16_f32 v125, v126, v127
    buffer_store_dwordx2 v[124:125], v2, s[24:27], s39 offen offset:64
    v_mul_f32 v128, v128, v248
    v_mul_f32 v129, v129, v248
    v_mul_f32 v130, v130, v248
    v_mul_f32 v131, v131, v248
    v_cvt_pk_bf16_f32 v128, v128, v129
    v_cvt_pk_bf16_f32 v129, v130, v131
    buffer_store_dwordx2 v[128:129], v2, s[24:27], s39 offen offset:96
    v_mul_f32 v132, v132, v248
    v_mul_f32 v133, v133, v248
    v_mul_f32 v134, v134, v248
    v_mul_f32 v135, v135, v248
    v_cvt_pk_bf16_f32 v132, v132, v133
    v_cvt_pk_bf16_f32 v133, v134, v135
    buffer_store_dwordx2 v[132:133], v2, s[24:27], s39 offen offset:128
    v_mul_f32 v136, v136, v248
    v_mul_f32 v137, v137, v248
    v_mul_f32 v138, v138, v248
    v_mul_f32 v139, v139, v248
    v_cvt_pk_bf16_f32 v136, v136, v137
    v_cvt_pk_bf16_f32 v137, v138, v139
    buffer_store_dwordx2 v[136:137], v2, s[24:27], s39 offen offset:160
    v_mul_f32 v140, v140, v248
    v_mul_f32 v141, v141, v248
    v_mul_f32 v142, v142, v248
    v_mul_f32 v143, v143, v248
    v_cvt_pk_bf16_f32 v140, v140, v141
    v_cvt_pk_bf16_f32 v141, v142, v143
    buffer_store_dwordx2 v[140:141], v2, s[24:27], s39 offen offset:192
    v_mul_f32 v144, v144, v248
    v_mul_f32 v145, v145, v248
    v_mul_f32 v146, v146, v248
    v_mul_f32 v147, v147, v248
    v_cvt_pk_bf16_f32 v144, v144, v145
    v_cvt_pk_bf16_f32 v145, v146, v147
    buffer_store_dwordx2 v[144:145], v2, s[24:27], s39 offen offset:224
L_attn_done:
    s_endpgm
.globl oproj_kernel
.p2align 8
.type oproj_kernel,@function
oproj_kernel:
    s_cmp_ge_u32 s2, 256
    s_cbranch_scc1 L_op_done
    s_and_b32 s3, s2, 3
    s_lshr_b32 s4, s2, 2
    s_and_b32 s4, s4, 3
    s_lshr_b32 s5, s2, 4
    s_and_b32 s5, s5, 7
    s_lshr_b32 s6, s2, 7
    s_mul_i32 s7, s6, 40
    s_add_u32 s42, s0, s7
    s_addc_u32 s43, s1, 0
    s_load_dwordx2 s[50:51], s[42:43], 32
    s_load_dwordx2 s[52:53], s[0:1], 96
    v_lshrrev_b32 v3, 6, v0
    v_and_b32 v0, 63, v0
    s_nop 0
    v_readfirstlane_b32 s28, v3
    v_and_b32 v249, 15, v0
    v_lshrrev_b32 v250, 4, v0
    s_waitcnt lgkmcnt(0)
    s_mul_i32 s7, s6, 12582912
    s_mul_i32 s41, s5, 1572864
    s_add_u32 s7, s7, s41
    s_lshl_b32 s41, s3, 11
    s_add_u32 s7, s7, s41
    s_add_u32 s8, s52, s7
    s_addc_u32 s9, s53, 0
    s_and_b32 s9, s9, 0xffff
    s_sub_u32 s10, 1572864, s41
    s_mov_b32 s11, 0x00020000
    s_lshl_b32 s7, s3, 20
    s_lshl_b32 s41, s4, 8
    s_add_u32 s7, s7, s41
    s_add_u32 s12, s50, s7
    s_addc_u32 s13, s51, 0
    s_and_b32 s13, s13, 0xffff
    s_sub_u32 s14, 1048576, s41
    s_mov_b32 s15, 0x00020000
    s_mul_i32 s7, s3, 6291456
    s_add_u32 s7, s7, 25165824
    s_mul_i32 s41, s5, 786432
    s_add_u32 s7, s7, s41
    s_lshl_b32 s41, s6, 11
    s_lshl_b32 s44, s4, 9
    s_add_u32 s41, s41, s44
    s_add_u32 s7, s7, s41
    s_add_u32 s24, s52, s7
    s_addc_u32 s25, s53, 0
    s_and_b32 s25, s25, 0xffff
    s_sub_u32 s26, 786432, s41
    s_mov_b32 s27, 0x00020000
    s_lshl_b32 s38, s28, 10
    v_lshrrev_b32 v251, 2, v249
    v_lshlrev_b32 v252, 2, v250
    v_add_u32 v252, v252, v251
    v_lshlrev_b32 v252, 8, v252
    v_and_b32 v253, 1, v249
    v_lshlrev_b32 v253, 3, v253
    v_add_u32 v252, v252, v253
    v_and_b32 v253, 1, v250
    v_lshlrev_b32 v253, 3, v253
    v_lshlrev_b32 v251, 1, v251
    v_add_u32 v253, v253, v251
    v_bfe_u32 v251, v249, 1, 1
    v_xor_b32 v253, v253, v251
    v_lshlrev_b32 v253, 4, v253
    v_add_u32 v232, v252, v253
    v_xor_b32 v233, 32, v232
    v_xor_b32 v234, 64, v232
    v_xor_b32 v235, 96, v232
    v_xor_b32 v236, 128, v232
    v_xor_b32 v237, 160, v232
    v_xor_b32 v238, 192, v232
    v_xor_b32 v239, 224, v232
    s_lshl_b32 s7, s28, 2
    v_add_u32 v251, s7, v250
    v_and_b32 v252, 7, v251
    v_lshlrev_b32 v252, 1, v252
    v_xor_b32 v252, v252, v249
    v_lshlrev_b32 v252, 4, v252
    s_lshl_b32 s7, s28, 3
    v_add_u32 v253, s7, v250
    v_lshlrev_b32 v253, 10, v253
    v_add_u32 v242, v253, v252
    s_mul_i32 s7, s28, 48
    v_add_u32 v251, s7, v249
    v_lshlrev_b32 v252, 13, v251
    v_lshlrev_b32 v253, 4, v250
    v_add_u32 v1, v252, v253
    v_lshlrev_b32 v252, 12, v251
    v_lshlrev_b32 v253, 4, v250
    v_add_u32 v2, v252, v253
    v_add_u32 v243, 0x10000, v232
    v_add_u32 v244, 0x10000, v233
    v_add_u32 v245, 0x10000, v234
    v_add_u32 v246, 0x10000, v235
    v_add_u32 v247, 0x10000, v236
    v_add_u32 v248, 0x10000, v237
    v_add_u32 v249, 0x10000, v238
    v_add_u32 v250, 0x10000, v239
    v_mov_b32 v52, 0
    v_mov_b32 v53, 0
    v_mov_b32 v54, 0
    v_mov_b32 v55, 0
    v_mov_b32 v56, 0
    v_mov_b32 v57, 0
    v_mov_b32 v58, 0
    v_mov_b32 v59, 0
    v_mov_b32 v60, 0
    v_mov_b32 v61, 0
    v_mov_b32 v62, 0
    v_mov_b32 v63, 0
    v_mov_b32 v64, 0
    v_mov_b32 v65, 0
    v_mov_b32 v66, 0
    v_mov_b32 v67, 0
    v_mov_b32 v68, 0
    v_mov_b32 v69, 0
    v_mov_b32 v70, 0
    v_mov_b32 v71, 0
    v_mov_b32 v72, 0
    v_mov_b32 v73, 0
    v_mov_b32 v74, 0
    v_mov_b32 v75, 0
    v_mov_b32 v76, 0
    v_mov_b32 v77, 0
    v_mov_b32 v78, 0
    v_mov_b32 v79, 0
    v_mov_b32 v80, 0
    v_mov_b32 v81, 0
    v_mov_b32 v82, 0
    v_mov_b32 v83, 0
    v_mov_b32 v84, 0
    v_mov_b32 v85, 0
    v_mov_b32 v86, 0
    v_mov_b32 v87, 0
    v_mov_b32 v88, 0
    v_mov_b32 v89, 0
    v_mov_b32 v90, 0
    v_mov_b32 v91, 0
    v_mov_b32 v92, 0
    v_mov_b32 v93, 0
    v_mov_b32 v94, 0
    v_mov_b32 v95, 0
    v_mov_b32 v96, 0
    v_mov_b32 v97, 0
    v_mov_b32 v98, 0
    v_mov_b32 v99, 0
    v_mov_b32 v100, 0
    v_mov_b32 v101, 0
    v_mov_b32 v102, 0
    v_mov_b32 v103, 0
    v_mov_b32 v104, 0
    v_mov_b32 v105, 0
    v_mov_b32 v106, 0
    v_mov_b32 v107, 0
    v_mov_b32 v108, 0
    v_mov_b32 v109, 0
    v_mov_b32 v110, 0
    v_mov_b32 v111, 0
    v_mov_b32 v112, 0
    v_mov_b32 v113, 0
    v_mov_b32 v114, 0
    v_mov_b32 v115, 0
    v_mov_b32 v116, 0
    v_mov_b32 v117, 0
    v_mov_b32 v118, 0
    v_mov_b32 v119, 0
    v_mov_b32 v120, 0
    v_mov_b32 v121, 0
    v_mov_b32 v122, 0
    v_mov_b32 v123, 0
    v_mov_b32 v124, 0
    v_mov_b32 v125, 0
    v_mov_b32 v126, 0
    v_mov_b32 v127, 0
    v_mov_b32 v128, 0
    v_mov_b32 v129, 0
    v_mov_b32 v130, 0
    v_mov_b32 v131, 0
    v_mov_b32 v132, 0
    v_mov_b32 v133, 0
    v_mov_b32 v134, 0
    v_mov_b32 v135, 0
    v_mov_b32 v136, 0
    v_mov_b32 v137, 0
    v_mov_b32 v138, 0
    v_mov_b32 v139, 0
    v_mov_b32 v140, 0
    v_mov_b32 v141, 0
    v_mov_b32 v142, 0
    v_mov_b32 v143, 0
    v_mov_b32 v144, 0
    v_mov_b32 v145, 0
    v_mov_b32 v146, 0
    v_mov_b32 v147, 0
    s_mov_b32 s40, 0
    s_mov_b32 s35, 0
    s_mov_b32 s36, 131072
    s_mov_b32 s37, 262144
    s_add_u32 m0, s38, 0
    s_add_u32 s31, s40, 0
    buffer_load_dwordx4 v242, s[12:15], s31 offen lds
    s_add_u32 m0, s38, 4096
    s_add_u32 s31, s40, 4096
    buffer_load_dwordx4 v242, s[12:15], s31 offen lds
    s_add_u32 m0, s38, 8192
    s_add_u32 s31, s40, 32768
    buffer_load_dwordx4 v242, s[12:15], s31 offen lds
    s_add_u32 m0, s38, 12288
    s_add_u32 s31, s40, 36864
    buffer_load_dwordx4 v242, s[12:15], s31 offen lds
    s_add_u32 s40, s40, 65536
    s_add_u32 m0, s38, 16384
    s_add_u32 s31, s40, 0
    buffer_load_dwordx4 v242, s[12:15], s31 offen lds
    s_add_u32 m0, s38, 20480
    s_add_u32 s31, s40, 4096
    buffer_load_dwordx4 v242, s[12:15], s31 offen lds
    s_add_u32 m0, s38, 24576
    s_add_u32 s31, s40, 32768
    buffer_load_dwordx4 v242, s[12:15], s31 offen lds
    s_add_u32 m0, s38, 28672
    s_add_u32 s31, s40, 36864
    buffer_load_dwordx4 v242, s[12:15], s31 offen lds
    s_add_u32 s40, s40, 65536
    s_add_u32 m0, s38, 32768
    s_add_u32 s31, s40, 0
    buffer_load_dwordx4 v242, s[12:15], s31 offen lds
    s_add_u32 m0, s38, 36864
    s_add_u32 s31, s40, 4096
    buffer_load_dwordx4 v242, s[12:15], s31 offen lds
    s_add_u32 m0, s38, 40960
    s_add_u32 s31, s40, 32768
    buffer_load_dwordx4 v242, s[12:15], s31 offen lds
    s_add_u32 m0, s38, 45056
    s_add_u32 s31, s40, 36864
    buffer_load_dwordx4 v242, s[12:15], s31 offen lds
    s_add_u32 s40, s40, 65536
    s_add_u32 m0, s38, 49152
    s_add_u32 s31, s40, 0
    buffer_load_dwordx4 v242, s[12:15], s31 offen lds
    s_add_u32 m0, s38, 53248
    s_add_u32 s31, s40, 4096
    buffer_load_dwordx4 v242, s[12:15], s31 offen lds
    s_add_u32 m0, s38, 57344
    s_add_u32 s31, s40, 32768
    buffer_load_dwordx4 v242, s[12:15], s31 offen lds
    s_add_u32 m0, s38, 61440
    s_add_u32 s31, s40, 36864
    buffer_load_dwordx4 v242, s[12:15], s31 offen lds
    s_add_u32 s40, s40, 65536
    buffer_load_dwordx4 v[148:151], v1, s[8:11], s35 offen offset:0
    buffer_load_dwordx4 v[152:155], v1, s[8:11], s35 offen offset:64
    buffer_load_dwordx4 v[156:159], v1, s[8:11], s36 offen offset:0
    buffer_load_dwordx4 v[160:163], v1, s[8:11], s36 offen offset:64
    buffer_load_dwordx4 v[164:167], v1, s[8:11], s37 offen offset:0
    buffer_load_dwordx4 v[168:171], v1, s[8:11], s37 offen offset:64
    s_add_u32 s35, s35, 128
    s_add_u32 s36, s36, 128
    s_add_u32 s37, s37, 128
    s_add_u32 m0, s38, 65536
    s_add_u32 s31, s40, 0
    buffer_load_dwordx4 v242, s[12:15], s31 offen lds
    s_add_u32 m0, s38, 69632
    s_add_u32 s31, s40, 4096
    buffer_load_dwordx4 v242, s[12:15], s31 offen lds
    s_add_u32 m0, s38, 73728
    s_add_u32 s31, s40, 32768
    buffer_load_dwordx4 v242, s[12:15], s31 offen lds
    s_add_u32 m0, s38, 77824
    s_add_u32 s31, s40, 36864
    buffer_load_dwordx4 v242, s[12:15], s31 offen lds
    s_add_u32 s40, s40, 65536
    buffer_load_dwordx4 v[172:175], v1, s[8:11], s35 offen offset:0
    buffer_load_dwordx4 v[176:179], v1, s[8:11], s35 offen offset:64
    buffer_load_dwordx4 v[180:183], v1, s[8:11], s36 offen offset:0
    buffer_load_dwordx4 v[184:187], v1, s[8:11], s36 offen offset:64
    buffer_load_dwordx4 v[188:191], v1, s[8:11], s37 offen offset:0
    buffer_load_dwordx4 v[192:195], v1, s[8:11], s37 offen offset:64
    s_add_u32 s35, s35, 128
    s_add_u32 s36, s36, 128
    s_add_u32 s37, s37, 128
    s_add_u32 m0, s38, 81920
    s_add_u32 s31, s40, 0
    buffer_load_dwordx4 v242, s[12:15], s31 offen lds
    s_add_u32 m0, s38, 86016
    s_add_u32 s31, s40, 4096
    buffer_load_dwordx4 v242, s[12:15], s31 offen lds
    s_add_u32 m0, s38, 90112
    s_add_u32 s31, s40, 32768
    buffer_load_dwordx4 v242, s[12:15], s31 offen lds
    s_add_u32 m0, s38, 94208
    s_add_u32 s31, s40, 36864
    buffer_load_dwordx4 v242, s[12:15], s31 offen lds
    s_add_u32 s40, s40, 65536
    buffer_load_dwordx4 v[4:7], v1, s[8:11], s35 offen offset:0
    buffer_load_dwordx4 v[8:11], v1, s[8:11], s35 offen offset:64
    buffer_load_dwordx4 v[12:15], v1, s[8:11], s36 offen offset:0
    buffer_load_dwordx4 v[16:19], v1, s[8:11], s36 offen offset:64
    buffer_load_dwordx4 v[20:23], v1, s[8:11], s37 offen offset:0
    buffer_load_dwordx4 v[24:27], v1, s[8:11], s37 offen offset:64
    s_add_u32 s35, s35, 128
    s_add_u32 s36, s36, 128
    s_add_u32 s37, s37, 128
    s_waitcnt vmcnt(20)
    s_barrier
    s_add_u32 m0, s38, 98304
    s_add_u32 s31, s40, 0
    buffer_load_dwordx4 v242, s[12:15], s31 offen lds
    s_add_u32 m0, s38, 102400
    s_add_u32 s31, s40, 4096
    buffer_load_dwordx4 v242, s[12:15], s31 offen lds
    s_add_u32 m0, s38, 106496
    s_add_u32 s31, s40, 32768
    buffer_load_dwordx4 v242, s[12:15], s31 offen lds
    s_add_u32 m0, s38, 110592
    s_add_u32 s31, s40, 36864
    buffer_load_dwordx4 v242, s[12:15], s31 offen lds
    s_add_u32 s40, s40, 65536
    buffer_load_dwordx4 v[28:31], v1, s[8:11], s35 offen offset:0
    buffer_load_dwordx4 v[32:35], v1, s[8:11], s35 offen offset:64
    buffer_load_dwordx4 v[36:39], v1, s[8:11], s36 offen offset:0
    buffer_load_dwordx4 v[40:43], v1, s[8:11], s36 offen offset:64
    buffer_load_dwordx4 v[44:47], v1, s[8:11], s37 offen offset:0
    buffer_load_dwordx4 v[48:51], v1, s[8:11], s37 offen offset:64
    s_add_u32 s35, s35, 128
    s_add_u32 s36, s36, 128
    s_add_u32 s37, s37, 128
    ds_read_b64_tr_b16 v[196:197], v232 offset:0
    ds_read_b64_tr_b16 v[198:199], v232 offset:4096
    ds_read_b64_tr_b16 v[200:201], v232 offset:8192
    ds_read_b64_tr_b16 v[202:203], v232 offset:12288
    ds_read_b64_tr_b16 v[204:205], v233 offset:0
    ds_read_b64_tr_b16 v[206:207], v233 offset:4096
    ds_read_b64_tr_b16 v[208:209], v233 offset:8192
    ds_read_b64_tr_b16 v[210:211], v233 offset:12288
    ds_read_b64_tr_b16 v[212:213], v234 offset:0
    ds_read_b64_tr_b16 v[214:215], v234 offset:4096
    s_waitcnt lgkmcnt(8)
    v_mfma_f32_16x16x32_bf16 v[52:55], v[196:199], v[148:151], v[52:55]
    v_mfma_f32_16x16x32_bf16 v[84:87], v[196:199], v[156:159], v[84:87]
    v_mfma_f32_16x16x32_bf16 v[116:119], v[196:199], v[164:167], v[116:119]
    ds_read_b64_tr_b16 v[216:217], v234 offset:8192
    ds_read_b64_tr_b16 v[218:219], v234 offset:12288
    s_waitcnt lgkmcnt(8)
    v_mfma_f32_16x16x32_bf16 v[52:55], v[200:203], v[152:155], v[52:55]
    v_mfma_f32_16x16x32_bf16 v[84:87], v[200:203], v[160:163], v[84:87]
    v_mfma_f32_16x16x32_bf16 v[116:119], v[200:203], v[168:171], v[116:119]
    ds_read_b64_tr_b16 v[220:221], v235 offset:0
    ds_read_b64_tr_b16 v[222:223], v235 offset:4096
    s_waitcnt lgkmcnt(8)
    v_mfma_f32_16x16x32_bf16 v[56:59], v[204:207], v[148:151], v[56:59]
    v_mfma_f32_16x16x32_bf16 v[88:91], v[204:207], v[156:159], v[88:91]
    v_mfma_f32_16x16x32_bf16 v[120:123], v[204:207], v[164:167], v[120:123]
    ds_read_b64_tr_b16 v[224:225], v235 offset:8192
    ds_read_b64_tr_b16 v[226:227], v235 offset:12288
    s_waitcnt lgkmcnt(8)
    v_mfma_f32_16x16x32_bf16 v[56:59], v[208:211], v[152:155], v[56:59]
    v_mfma_f32_16x16x32_bf16 v[88:91], v[208:211], v[160:163], v[88:91]
    v_mfma_f32_16x16x32_bf16 v[120:123], v[208:211], v[168:171], v[120:123]
    ds_read_b64_tr_b16 v[196:197], v236 offset:0
    ds_read_b64_tr_b16 v[198:199], v236 offset:4096
    s_waitcnt lgkmcnt(8)
    v_mfma_f32_16x16x32_bf16 v[60:63], v[212:215], v[148:151], v[60:63]
    v_mfma_f32_16x16x32_bf16 v[92:95], v[212:215], v[156:159], v[92:95]
    v_mfma_f32_16x16x32_bf16 v[124:127], v[212:215], v[164:167], v[124:127]
    ds_read_b64_tr_b16 v[200:201], v236 offset:8192
    ds_read_b64_tr_b16 v[202:203], v236 offset:12288
    s_waitcnt lgkmcnt(8)
    v_mfma_f32_16x16x32_bf16 v[60:63], v[216:219], v[152:155], v[60:63]
    v_mfma_f32_16x16x32_bf16 v[92:95], v[216:219], v[160:163], v[92:95]
    v_mfma_f32_16x16x32_bf16 v[124:127], v[216:219], v[168:171], v[124:127]
    ds_read_b64_tr_b16 v[204:205], v237 offset:0
    ds_read_b64_tr_b16 v[206:207], v237 offset:4096
    s_waitcnt lgkmcnt(8)
    v_mfma_f32_16x16x32_bf16 v[64:67], v[220:223], v[148:151], v[64:67]
    v_mfma_f32_16x16x32_bf16 v[96:99], v[220:223], v[156:159], v[96:99]
    v_mfma_f32_16x16x32_bf16 v[128:131], v[220:223], v[164:167], v[128:131]
    ds_read_b64_tr_b16 v[208:209], v237 offset:8192
    ds_read_b64_tr_b16 v[210:211], v237 offset:12288
    s_waitcnt lgkmcnt(8)
    v_mfma_f32_16x16x32_bf16 v[64:67], v[224:227], v[152:155], v[64:67]
    v_mfma_f32_16x16x32_bf16 v[96:99], v[224:227], v[160:163], v[96:99]
    v_mfma_f32_16x16x32_bf16 v[128:131], v[224:227], v[168:171], v[128:131]
    ds_read_b64_tr_b16 v[212:213], v238 offset:0
    ds_read_b64_tr_b16 v[214:215], v238 offset:4096
    s_waitcnt lgkmcnt(8)
    v_mfma_f32_16x16x32_bf16 v[68:71], v[196:199], v[148:151], v[68:71]
    v_mfma_f32_16x16x32_bf16 v[100:103], v[196:199], v[156:159], v[100:103]
    v_mfma_f32_16x16x32_bf16 v[132:135], v[196:199], v[164:167], v[132:135]
    ds_read_b64_tr_b16 v[216:217], v238 offset:8192
    ds_read_b64_tr_b16 v[218:219], v238 offset:12288
    s_waitcnt lgkmcnt(8)
    v_mfma_f32_16x16x32_bf16 v[68:71], v[200:203], v[152:155], v[68:71]
    v_mfma_f32_16x16x32_bf16 v[100:103], v[200:203], v[160:163], v[100:103]
    v_mfma_f32_16x16x32_bf16 v[132:135], v[200:203], v[168:171], v[132:135]
    ds_read_b64_tr_b16 v[220:221], v239 offset:0
    ds_read_b64_tr_b16 v[222:223], v239 offset:4096
    s_waitcnt lgkmcnt(8)
    v_mfma_f32_16x16x32_bf16 v[72:75], v[204:207], v[148:151], v[72:75]
    v_mfma_f32_16x16x32_bf16 v[104:107], v[204:207], v[156:159], v[104:107]
    v_mfma_f32_16x16x32_bf16 v[136:139], v[204:207], v[164:167], v[136:139]
    ds_read_b64_tr_b16 v[224:225], v239 offset:8192
    ds_read_b64_tr_b16 v[226:227], v239 offset:12288
    s_waitcnt lgkmcnt(8)
    v_mfma_f32_16x16x32_bf16 v[72:75], v[208:211], v[152:155], v[72:75]
    v_mfma_f32_16x16x32_bf16 v[104:107], v[208:211], v[160:163], v[104:107]
    v_mfma_f32_16x16x32_bf16 v[136:139], v[208:211], v[168:171], v[136:139]
    s_waitcnt lgkmcnt(6)
    v_mfma_f32_16x16x32_bf16 v[76:79], v[212:215], v[148:151], v[76:79]
    v_mfma_f32_16x16x32_bf16 v[108:111], v[212:215], v[156:159], v[108:111]
    v_mfma_f32_16x16x32_bf16 v[140:143], v[212:215], v[164:167], v[140:143]
    s_waitcnt lgkmcnt(4)
    v_mfma_f32_16x16x32_bf16 v[76:79], v[216:219], v[152:155], v[76:79]
    v_mfma_f32_16x16x32_bf16 v[108:111], v[216:219], v[160:163], v[108:111]
    v_mfma_f32_16x16x32_bf16 v[140:143], v[216:219], v[168:171], v[140:143]
    s_waitcnt lgkmcnt(2)
    v_mfma_f32_16x16x32_bf16 v[80:83], v[220:223], v[148:151], v[80:83]
    v_mfma_f32_16x16x32_bf16 v[112:115], v[220:223], v[156:159], v[112:115]
    v_mfma_f32_16x16x32_bf16 v[144:147], v[220:223], v[164:167], v[144:147]
    s_waitcnt lgkmcnt(0)
    v_mfma_f32_16x16x32_bf16 v[80:83], v[224:227], v[152:155], v[80:83]
    v_mfma_f32_16x16x32_bf16 v[112:115], v[224:227], v[160:163], v[112:115]
    v_mfma_f32_16x16x32_bf16 v[144:147], v[224:227], v[168:171], v[144:147]
    s_waitcnt vmcnt(20)
    s_barrier
    s_add_u32 m0, s38, 114688
    s_add_u32 s31, s40, 0
    buffer_load_dwordx4 v242, s[12:15], s31 offen lds
    s_add_u32 m0, s38, 118784
    s_add_u32 s31, s40, 4096
    buffer_load_dwordx4 v242, s[12:15], s31 offen lds
    s_add_u32 m0, s38, 122880
    s_add_u32 s31, s40, 32768
    buffer_load_dwordx4 v242, s[12:15], s31 offen lds
    s_add_u32 m0, s38, 126976
    s_add_u32 s31, s40, 36864
    buffer_load_dwordx4 v242, s[12:15], s31 offen lds
    s_add_u32 s40, s40, 65536
    buffer_load_dwordx4 v[148:151], v1, s[8:11], s35 offen offset:0
    buffer_load_dwordx4 v[152:155], v1, s[8:11], s35 offen offset:64
    buffer_load_dwordx4 v[156:159], v1, s[8:11], s36 offen offset:0
    buffer_load_dwordx4 v[160:163], v1, s[8:11], s36 offen offset:64
    buffer_load_dwordx4 v[164:167], v1, s[8:11], s37 offen offset:0
    buffer_load_dwordx4 v[168:171], v1, s[8:11], s37 offen offset:64
    s_add_u32 s35, s35, 128
    s_add_u32 s36, s36, 128
    s_add_u32 s37, s37, 128
    ds_read_b64_tr_b16 v[196:197], v232 offset:16384
    ds_read_b64_tr_b16 v[198:199], v232 offset:20480
    ds_read_b64_tr_b16 v[200:201], v232 offset:24576
    ds_read_b64_tr_b16 v[202:203], v232 offset:28672
    ds_read_b64_tr_b16 v[204:205], v233 offset:16384
    ds_read_b64_tr_b16 v[206:207], v233 offset:20480
    ds_read_b64_tr_b16 v[208:209], v233 offset:24576
    ds_read_b64_tr_b16 v[210:211], v233 offset:28672
    ds_read_b64_tr_b16 v[212:213], v234 offset:16384
    ds_read_b64_tr_b16 v[214:215], v234 offset:20480
    s_waitcnt lgkmcnt(8)
    v_mfma_f32_16x16x32_bf16 v[52:55], v[196:199], v[172:175], v[52:55]
    v_mfma_f32_16x16x32_bf16 v[84:87], v[196:199], v[180:183], v[84:87]
    v_mfma_f32_16x16x32_bf16 v[116:119], v[196:199], v[188:191], v[116:119]
    ds_read_b64_tr_b16 v[216:217], v234 offset:24576
    ds_read_b64_tr_b16 v[218:219], v234 offset:28672
    s_waitcnt lgkmcnt(8)
    v_mfma_f32_16x16x32_bf16 v[52:55], v[200:203], v[176:179], v[52:55]
    v_mfma_f32_16x16x32_bf16 v[84:87], v[200:203], v[184:187], v[84:87]
    v_mfma_f32_16x16x32_bf16 v[116:119], v[200:203], v[192:195], v[116:119]
    ds_read_b64_tr_b16 v[220:221], v235 offset:16384
    ds_read_b64_tr_b16 v[222:223], v235 offset:20480
    s_waitcnt lgkmcnt(8)
    v_mfma_f32_16x16x32_bf16 v[56:59], v[204:207], v[172:175], v[56:59]
    v_mfma_f32_16x16x32_bf16 v[88:91], v[204:207], v[180:183], v[88:91]
    v_mfma_f32_16x16x32_bf16 v[120:123], v[204:207], v[188:191], v[120:123]
    ds_read_b64_tr_b16 v[224:225], v235 offset:24576
    ds_read_b64_tr_b16 v[226:227], v235 offset:28672
    s_waitcnt lgkmcnt(8)
    v_mfma_f32_16x16x32_bf16 v[56:59], v[208:211], v[176:179], v[56:59]
    v_mfma_f32_16x16x32_bf16 v[88:91], v[208:211], v[184:187], v[88:91]
    v_mfma_f32_16x16x32_bf16 v[120:123], v[208:211], v[192:195], v[120:123]
    ds_read_b64_tr_b16 v[196:197], v236 offset:16384
    ds_read_b64_tr_b16 v[198:199], v236 offset:20480
    s_waitcnt lgkmcnt(8)
    v_mfma_f32_16x16x32_bf16 v[60:63], v[212:215], v[172:175], v[60:63]
    v_mfma_f32_16x16x32_bf16 v[92:95], v[212:215], v[180:183], v[92:95]
    v_mfma_f32_16x16x32_bf16 v[124:127], v[212:215], v[188:191], v[124:127]
    ds_read_b64_tr_b16 v[200:201], v236 offset:24576
    ds_read_b64_tr_b16 v[202:203], v236 offset:28672
    s_waitcnt lgkmcnt(8)
    v_mfma_f32_16x16x32_bf16 v[60:63], v[216:219], v[176:179], v[60:63]
    v_mfma_f32_16x16x32_bf16 v[92:95], v[216:219], v[184:187], v[92:95]
    v_mfma_f32_16x16x32_bf16 v[124:127], v[216:219], v[192:195], v[124:127]
    ds_read_b64_tr_b16 v[204:205], v237 offset:16384
    ds_read_b64_tr_b16 v[206:207], v237 offset:20480
    s_waitcnt lgkmcnt(8)
    v_mfma_f32_16x16x32_bf16 v[64:67], v[220:223], v[172:175], v[64:67]
    v_mfma_f32_16x16x32_bf16 v[96:99], v[220:223], v[180:183], v[96:99]
    v_mfma_f32_16x16x32_bf16 v[128:131], v[220:223], v[188:191], v[128:131]
    ds_read_b64_tr_b16 v[208:209], v237 offset:24576
    ds_read_b64_tr_b16 v[210:211], v237 offset:28672
    s_waitcnt lgkmcnt(8)
    v_mfma_f32_16x16x32_bf16 v[64:67], v[224:227], v[176:179], v[64:67]
    v_mfma_f32_16x16x32_bf16 v[96:99], v[224:227], v[184:187], v[96:99]
    v_mfma_f32_16x16x32_bf16 v[128:131], v[224:227], v[192:195], v[128:131]
    ds_read_b64_tr_b16 v[212:213], v238 offset:16384
    ds_read_b64_tr_b16 v[214:215], v238 offset:20480
    s_waitcnt lgkmcnt(8)
    v_mfma_f32_16x16x32_bf16 v[68:71], v[196:199], v[172:175], v[68:71]
    v_mfma_f32_16x16x32_bf16 v[100:103], v[196:199], v[180:183], v[100:103]
    v_mfma_f32_16x16x32_bf16 v[132:135], v[196:199], v[188:191], v[132:135]
    ds_read_b64_tr_b16 v[216:217], v238 offset:24576
    ds_read_b64_tr_b16 v[218:219], v238 offset:28672
    s_waitcnt lgkmcnt(8)
    v_mfma_f32_16x16x32_bf16 v[68:71], v[200:203], v[176:179], v[68:71]
    v_mfma_f32_16x16x32_bf16 v[100:103], v[200:203], v[184:187], v[100:103]
    v_mfma_f32_16x16x32_bf16 v[132:135], v[200:203], v[192:195], v[132:135]
    ds_read_b64_tr_b16 v[220:221], v239 offset:16384
    ds_read_b64_tr_b16 v[222:223], v239 offset:20480
    s_waitcnt lgkmcnt(8)
    v_mfma_f32_16x16x32_bf16 v[72:75], v[204:207], v[172:175], v[72:75]
    v_mfma_f32_16x16x32_bf16 v[104:107], v[204:207], v[180:183], v[104:107]
    v_mfma_f32_16x16x32_bf16 v[136:139], v[204:207], v[188:191], v[136:139]
    ds_read_b64_tr_b16 v[224:225], v239 offset:24576
    ds_read_b64_tr_b16 v[226:227], v239 offset:28672
    s_waitcnt lgkmcnt(8)
    v_mfma_f32_16x16x32_bf16 v[72:75], v[208:211], v[176:179], v[72:75]
    v_mfma_f32_16x16x32_bf16 v[104:107], v[208:211], v[184:187], v[104:107]
    v_mfma_f32_16x16x32_bf16 v[136:139], v[208:211], v[192:195], v[136:139]
    s_waitcnt lgkmcnt(6)
    v_mfma_f32_16x16x32_bf16 v[76:79], v[212:215], v[172:175], v[76:79]
    v_mfma_f32_16x16x32_bf16 v[108:111], v[212:215], v[180:183], v[108:111]
    v_mfma_f32_16x16x32_bf16 v[140:143], v[212:215], v[188:191], v[140:143]
    s_waitcnt lgkmcnt(4)
    v_mfma_f32_16x16x32_bf16 v[76:79], v[216:219], v[176:179], v[76:79]
    v_mfma_f32_16x16x32_bf16 v[108:111], v[216:219], v[184:187], v[108:111]
    v_mfma_f32_16x16x32_bf16 v[140:143], v[216:219], v[192:195], v[140:143]
    s_waitcnt lgkmcnt(2)
    v_mfma_f32_16x16x32_bf16 v[80:83], v[220:223], v[172:175], v[80:83]
    v_mfma_f32_16x16x32_bf16 v[112:115], v[220:223], v[180:183], v[112:115]
    v_mfma_f32_16x16x32_bf16 v[144:147], v[220:223], v[188:191], v[144:147]
    s_waitcnt lgkmcnt(0)
    v_mfma_f32_16x16x32_bf16 v[80:83], v[224:227], v[176:179], v[80:83]
    v_mfma_f32_16x16x32_bf16 v[112:115], v[224:227], v[184:187], v[112:115]
    v_mfma_f32_16x16x32_bf16 v[144:147], v[224:227], v[192:195], v[144:147]
    s_waitcnt vmcnt(20)
    s_barrier
    s_add_u32 m0, s38, 0
    s_add_u32 s31, s40, 0
    buffer_load_dwordx4 v242, s[12:15], s31 offen lds
    s_add_u32 m0, s38, 4096
    s_add_u32 s31, s40, 4096
    buffer_load_dwordx4 v242, s[12:15], s31 offen lds
    s_add_u32 m0, s38, 8192
    s_add_u32 s31, s40, 32768
    buffer_load_dwordx4 v242, s[12:15], s31 offen lds
    s_add_u32 m0, s38, 12288
    s_add_u32 s31, s40, 36864
    buffer_load_dwordx4 v242, s[12:15], s31 offen lds
    s_add_u32 s40, s40, 65536
    buffer_load_dwordx4 v[172:175], v1, s[8:11], s35 offen offset:0
    buffer_load_dwordx4 v[176:179], v1, s[8:11], s35 offen offset:64
    buffer_load_dwordx4 v[180:183], v1, s[8:11], s36 offen offset:0
    buffer_load_dwordx4 v[184:187], v1, s[8:11], s36 offen offset:64
    buffer_load_dwordx4 v[188:191], v1, s[8:11], s37 offen offset:0
    buffer_load_dwordx4 v[192:195], v1, s[8:11], s37 offen offset:64
    s_add_u32 s35, s35, 128
    s_add_u32 s36, s36, 128
    s_add_u32 s37, s37, 128
    ds_read_b64_tr_b16 v[196:197], v232 offset:32768
    ds_read_b64_tr_b16 v[198:199], v232 offset:36864
    ds_read_b64_tr_b16 v[200:201], v232 offset:40960
    ds_read_b64_tr_b16 v[202:203], v232 offset:45056
    ds_read_b64_tr_b16 v[204:205], v233 offset:32768
    ds_read_b64_tr_b16 v[206:207], v233 offset:36864
    ds_read_b64_tr_b16 v[208:209], v233 offset:40960
    ds_read_b64_tr_b16 v[210:211], v233 offset:45056
    ds_read_b64_tr_b16 v[212:213], v234 offset:32768
    ds_read_b64_tr_b16 v[214:215], v234 offset:36864
    s_waitcnt lgkmcnt(8)
    v_mfma_f32_16x16x32_bf16 v[52:55], v[196:199], v[4:7], v[52:55]
    v_mfma_f32_16x16x32_bf16 v[84:87], v[196:199], v[12:15], v[84:87]
    v_mfma_f32_16x16x32_bf16 v[116:119], v[196:199], v[20:23], v[116:119]
    ds_read_b64_tr_b16 v[216:217], v234 offset:40960
    ds_read_b64_tr_b16 v[218:219], v234 offset:45056
    s_waitcnt lgkmcnt(8)
    v_mfma_f32_16x16x32_bf16 v[52:55], v[200:203], v[8:11], v[52:55]
    v_mfma_f32_16x16x32_bf16 v[84:87], v[200:203], v[16:19], v[84:87]
    v_mfma_f32_16x16x32_bf16 v[116:119], v[200:203], v[24:27], v[116:119]
    ds_read_b64_tr_b16 v[220:221], v235 offset:32768
    ds_read_b64_tr_b16 v[222:223], v235 offset:36864
    s_waitcnt lgkmcnt(8)
    v_mfma_f32_16x16x32_bf16 v[56:59], v[204:207], v[4:7], v[56:59]
    v_mfma_f32_16x16x32_bf16 v[88:91], v[204:207], v[12:15], v[88:91]
    v_mfma_f32_16x16x32_bf16 v[120:123], v[204:207], v[20:23], v[120:123]
    ds_read_b64_tr_b16 v[224:225], v235 offset:40960
    ds_read_b64_tr_b16 v[226:227], v235 offset:45056
    s_waitcnt lgkmcnt(8)
    v_mfma_f32_16x16x32_bf16 v[56:59], v[208:211], v[8:11], v[56:59]
    v_mfma_f32_16x16x32_bf16 v[88:91], v[208:211], v[16:19], v[88:91]
    v_mfma_f32_16x16x32_bf16 v[120:123], v[208:211], v[24:27], v[120:123]
    ds_read_b64_tr_b16 v[196:197], v236 offset:32768
    ds_read_b64_tr_b16 v[198:199], v236 offset:36864
    s_waitcnt lgkmcnt(8)
    v_mfma_f32_16x16x32_bf16 v[60:63], v[212:215], v[4:7], v[60:63]
    v_mfma_f32_16x16x32_bf16 v[92:95], v[212:215], v[12:15], v[92:95]
    v_mfma_f32_16x16x32_bf16 v[124:127], v[212:215], v[20:23], v[124:127]
    ds_read_b64_tr_b16 v[200:201], v236 offset:40960
    ds_read_b64_tr_b16 v[202:203], v236 offset:45056
    s_waitcnt lgkmcnt(8)
    v_mfma_f32_16x16x32_bf16 v[60:63], v[216:219], v[8:11], v[60:63]
    v_mfma_f32_16x16x32_bf16 v[92:95], v[216:219], v[16:19], v[92:95]
    v_mfma_f32_16x16x32_bf16 v[124:127], v[216:219], v[24:27], v[124:127]
    ds_read_b64_tr_b16 v[204:205], v237 offset:32768
    ds_read_b64_tr_b16 v[206:207], v237 offset:36864
    s_waitcnt lgkmcnt(8)
    v_mfma_f32_16x16x32_bf16 v[64:67], v[220:223], v[4:7], v[64:67]
    v_mfma_f32_16x16x32_bf16 v[96:99], v[220:223], v[12:15], v[96:99]
    v_mfma_f32_16x16x32_bf16 v[128:131], v[220:223], v[20:23], v[128:131]
    ds_read_b64_tr_b16 v[208:209], v237 offset:40960
    ds_read_b64_tr_b16 v[210:211], v237 offset:45056
    s_waitcnt lgkmcnt(8)
    v_mfma_f32_16x16x32_bf16 v[64:67], v[224:227], v[8:11], v[64:67]
    v_mfma_f32_16x16x32_bf16 v[96:99], v[224:227], v[16:19], v[96:99]
    v_mfma_f32_16x16x32_bf16 v[128:131], v[224:227], v[24:27], v[128:131]
    ds_read_b64_tr_b16 v[212:213], v238 offset:32768
    ds_read_b64_tr_b16 v[214:215], v238 offset:36864
    s_waitcnt lgkmcnt(8)
    v_mfma_f32_16x16x32_bf16 v[68:71], v[196:199], v[4:7], v[68:71]
    v_mfma_f32_16x16x32_bf16 v[100:103], v[196:199], v[12:15], v[100:103]
    v_mfma_f32_16x16x32_bf16 v[132:135], v[196:199], v[20:23], v[132:135]
    ds_read_b64_tr_b16 v[216:217], v238 offset:40960
    ds_read_b64_tr_b16 v[218:219], v238 offset:45056
    s_waitcnt lgkmcnt(8)
    v_mfma_f32_16x16x32_bf16 v[68:71], v[200:203], v[8:11], v[68:71]
    v_mfma_f32_16x16x32_bf16 v[100:103], v[200:203], v[16:19], v[100:103]
    v_mfma_f32_16x16x32_bf16 v[132:135], v[200:203], v[24:27], v[132:135]
    ds_read_b64_tr_b16 v[220:221], v239 offset:32768
    ds_read_b64_tr_b16 v[222:223], v239 offset:36864
    s_waitcnt lgkmcnt(8)
    v_mfma_f32_16x16x32_bf16 v[72:75], v[204:207], v[4:7], v[72:75]
    v_mfma_f32_16x16x32_bf16 v[104:107], v[204:207], v[12:15], v[104:107]
    v_mfma_f32_16x16x32_bf16 v[136:139], v[204:207], v[20:23], v[136:139]
    ds_read_b64_tr_b16 v[224:225], v239 offset:40960
    ds_read_b64_tr_b16 v[226:227], v239 offset:45056
    s_waitcnt lgkmcnt(8)
    v_mfma_f32_16x16x32_bf16 v[72:75], v[208:211], v[8:11], v[72:75]
    v_mfma_f32_16x16x32_bf16 v[104:107], v[208:211], v[16:19], v[104:107]
    v_mfma_f32_16x16x32_bf16 v[136:139], v[208:211], v[24:27], v[136:139]
    s_waitcnt lgkmcnt(6)
    v_mfma_f32_16x16x32_bf16 v[76:79], v[212:215], v[4:7], v[76:79]
    v_mfma_f32_16x16x32_bf16 v[108:111], v[212:215], v[12:15], v[108:111]
    v_mfma_f32_16x16x32_bf16 v[140:143], v[212:215], v[20:23], v[140:143]
    s_waitcnt lgkmcnt(4)
    v_mfma_f32_16x16x32_bf16 v[76:79], v[216:219], v[8:11], v[76:79]
    v_mfma_f32_16x16x32_bf16 v[108:111], v[216:219], v[16:19], v[108:111]
    v_mfma_f32_16x16x32_bf16 v[140:143], v[216:219], v[24:27], v[140:143]
    s_waitcnt lgkmcnt(2)
    v_mfma_f32_16x16x32_bf16 v[80:83], v[220:223], v[4:7], v[80:83]
    v_mfma_f32_16x16x32_bf16 v[112:115], v[220:223], v[12:15], v[112:115]
    v_mfma_f32_16x16x32_bf16 v[144:147], v[220:223], v[20:23], v[144:147]
    s_waitcnt lgkmcnt(0)
    v_mfma_f32_16x16x32_bf16 v[80:83], v[224:227], v[8:11], v[80:83]
    v_mfma_f32_16x16x32_bf16 v[112:115], v[224:227], v[16:19], v[112:115]
    v_mfma_f32_16x16x32_bf16 v[144:147], v[224:227], v[24:27], v[144:147]
    s_waitcnt vmcnt(20)
    s_barrier
    s_add_u32 m0, s38, 16384
    s_add_u32 s31, s40, 0
    buffer_load_dwordx4 v242, s[12:15], s31 offen lds
    s_add_u32 m0, s38, 20480
    s_add_u32 s31, s40, 4096
    buffer_load_dwordx4 v242, s[12:15], s31 offen lds
    s_add_u32 m0, s38, 24576
    s_add_u32 s31, s40, 32768
    buffer_load_dwordx4 v242, s[12:15], s31 offen lds
    s_add_u32 m0, s38, 28672
    s_add_u32 s31, s40, 36864
    buffer_load_dwordx4 v242, s[12:15], s31 offen lds
    s_add_u32 s40, s40, 65536
    buffer_load_dwordx4 v[4:7], v1, s[8:11], s35 offen offset:0
    buffer_load_dwordx4 v[8:11], v1, s[8:11], s35 offen offset:64
    buffer_load_dwordx4 v[12:15], v1, s[8:11], s36 offen offset:0
    buffer_load_dwordx4 v[16:19], v1, s[8:11], s36 offen offset:64
    buffer_load_dwordx4 v[20:23], v1, s[8:11], s37 offen offset:0
    buffer_load_dwordx4 v[24:27], v1, s[8:11], s37 offen offset:64
    s_add_u32 s35, s35, 128
    s_add_u32 s36, s36, 128
    s_add_u32 s37, s37, 128
    ds_read_b64_tr_b16 v[196:197], v232 offset:49152
    ds_read_b64_tr_b16 v[198:199], v232 offset:53248
    ds_read_b64_tr_b16 v[200:201], v232 offset:57344
    ds_read_b64_tr_b16 v[202:203], v232 offset:61440
    ds_read_b64_tr_b16 v[204:205], v233 offset:49152
    ds_read_b64_tr_b16 v[206:207], v233 offset:53248
    ds_read_b64_tr_b16 v[208:209], v233 offset:57344
    ds_read_b64_tr_b16 v[210:211], v233 offset:61440
    ds_read_b64_tr_b16 v[212:213], v234 offset:49152
    ds_read_b64_tr_b16 v[214:215], v234 offset:53248
    s_waitcnt lgkmcnt(8)
    v_mfma_f32_16x16x32_bf16 v[52:55], v[196:199], v[28:31], v[52:55]
    v_mfma_f32_16x16x32_bf16 v[84:87], v[196:199], v[36:39], v[84:87]
    v_mfma_f32_16x16x32_bf16 v[116:119], v[196:199], v[44:47], v[116:119]
    ds_read_b64_tr_b16 v[216:217], v234 offset:57344
    ds_read_b64_tr_b16 v[218:219], v234 offset:61440
    s_waitcnt lgkmcnt(8)
    v_mfma_f32_16x16x32_bf16 v[52:55], v[200:203], v[32:35], v[52:55]
    v_mfma_f32_16x16x32_bf16 v[84:87], v[200:203], v[40:43], v[84:87]
    v_mfma_f32_16x16x32_bf16 v[116:119], v[200:203], v[48:51], v[116:119]
    ds_read_b64_tr_b16 v[220:221], v235 offset:49152
    ds_read_b64_tr_b16 v[222:223], v235 offset:53248
    s_waitcnt lgkmcnt(8)
    v_mfma_f32_16x16x32_bf16 v[56:59], v[204:207], v[28:31], v[56:59]
    v_mfma_f32_16x16x32_bf16 v[88:91], v[204:207], v[36:39], v[88:91]
    v_mfma_f32_16x16x32_bf16 v[120:123], v[204:207], v[44:47], v[120:123]
    ds_read_b64_tr_b16 v[224:225], v235 offset:57344
    ds_read_b64_tr_b16 v[226:227], v235 offset:61440
    s_waitcnt lgkmcnt(8)
    v_mfma_f32_16x16x32_bf16 v[56:59], v[208:211], v[32:35], v[56:59]
    v_mfma_f32_16x16x32_bf16 v[88:91], v[208:211], v[40:43], v[88:91]
    v_mfma_f32_16x16x32_bf16 v[120:123], v[208:211], v[48:51], v[120:123]
    ds_read_b64_tr_b16 v[196:197], v236 offset:49152
    ds_read_b64_tr_b16 v[198:199], v236 offset:53248
    s_waitcnt lgkmcnt(8)
    v_mfma_f32_16x16x32_bf16 v[60:63], v[212:215], v[28:31], v[60:63]
    v_mfma_f32_16x16x32_bf16 v[92:95], v[212:215], v[36:39], v[92:95]
    v_mfma_f32_16x16x32_bf16 v[124:127], v[212:215], v[44:47], v[124:127]
    ds_read_b64_tr_b16 v[200:201], v236 offset:57344
    ds_read_b64_tr_b16 v[202:203], v236 offset:61440
    s_waitcnt lgkmcnt(8)
    v_mfma_f32_16x16x32_bf16 v[60:63], v[216:219], v[32:35], v[60:63]
    v_mfma_f32_16x16x32_bf16 v[92:95], v[216:219], v[40:43], v[92:95]
    v_mfma_f32_16x16x32_bf16 v[124:127], v[216:219], v[48:51], v[124:127]
    ds_read_b64_tr_b16 v[204:205], v237 offset:49152
    ds_read_b64_tr_b16 v[206:207], v237 offset:53248
    s_waitcnt lgkmcnt(8)
    v_mfma_f32_16x16x32_bf16 v[64:67], v[220:223], v[28:31], v[64:67]
    v_mfma_f32_16x16x32_bf16 v[96:99], v[220:223], v[36:39], v[96:99]
    v_mfma_f32_16x16x32_bf16 v[128:131], v[220:223], v[44:47], v[128:131]
    ds_read_b64_tr_b16 v[208:209], v237 offset:57344
    ds_read_b64_tr_b16 v[210:211], v237 offset:61440
    s_waitcnt lgkmcnt(8)
    v_mfma_f32_16x16x32_bf16 v[64:67], v[224:227], v[32:35], v[64:67]
    v_mfma_f32_16x16x32_bf16 v[96:99], v[224:227], v[40:43], v[96:99]
    v_mfma_f32_16x16x32_bf16 v[128:131], v[224:227], v[48:51], v[128:131]
    ds_read_b64_tr_b16 v[212:213], v238 offset:49152
    ds_read_b64_tr_b16 v[214:215], v238 offset:53248
    s_waitcnt lgkmcnt(8)
    v_mfma_f32_16x16x32_bf16 v[68:71], v[196:199], v[28:31], v[68:71]
    v_mfma_f32_16x16x32_bf16 v[100:103], v[196:199], v[36:39], v[100:103]
    v_mfma_f32_16x16x32_bf16 v[132:135], v[196:199], v[44:47], v[132:135]
    ds_read_b64_tr_b16 v[216:217], v238 offset:57344
    ds_read_b64_tr_b16 v[218:219], v238 offset:61440
    s_waitcnt lgkmcnt(8)
    v_mfma_f32_16x16x32_bf16 v[68:71], v[200:203], v[32:35], v[68:71]
    v_mfma_f32_16x16x32_bf16 v[100:103], v[200:203], v[40:43], v[100:103]
    v_mfma_f32_16x16x32_bf16 v[132:135], v[200:203], v[48:51], v[132:135]
    ds_read_b64_tr_b16 v[220:221], v239 offset:49152
    ds_read_b64_tr_b16 v[222:223], v239 offset:53248
    s_waitcnt lgkmcnt(8)
    v_mfma_f32_16x16x32_bf16 v[72:75], v[204:207], v[28:31], v[72:75]
    v_mfma_f32_16x16x32_bf16 v[104:107], v[204:207], v[36:39], v[104:107]
    v_mfma_f32_16x16x32_bf16 v[136:139], v[204:207], v[44:47], v[136:139]
    ds_read_b64_tr_b16 v[224:225], v239 offset:57344
    ds_read_b64_tr_b16 v[226:227], v239 offset:61440
    s_waitcnt lgkmcnt(8)
    v_mfma_f32_16x16x32_bf16 v[72:75], v[208:211], v[32:35], v[72:75]
    v_mfma_f32_16x16x32_bf16 v[104:107], v[208:211], v[40:43], v[104:107]
    v_mfma_f32_16x16x32_bf16 v[136:139], v[208:211], v[48:51], v[136:139]
    s_waitcnt lgkmcnt(6)
    v_mfma_f32_16x16x32_bf16 v[76:79], v[212:215], v[28:31], v[76:79]
    v_mfma_f32_16x16x32_bf16 v[108:111], v[212:215], v[36:39], v[108:111]
    v_mfma_f32_16x16x32_bf16 v[140:143], v[212:215], v[44:47], v[140:143]
    s_waitcnt lgkmcnt(4)
    v_mfma_f32_16x16x32_bf16 v[76:79], v[216:219], v[32:35], v[76:79]
    v_mfma_f32_16x16x32_bf16 v[108:111], v[216:219], v[40:43], v[108:111]
    v_mfma_f32_16x16x32_bf16 v[140:143], v[216:219], v[48:51], v[140:143]
    s_waitcnt lgkmcnt(2)
    v_mfma_f32_16x16x32_bf16 v[80:83], v[220:223], v[28:31], v[80:83]
    v_mfma_f32_16x16x32_bf16 v[112:115], v[220:223], v[36:39], v[112:115]
    v_mfma_f32_16x16x32_bf16 v[144:147], v[220:223], v[44:47], v[144:147]
    s_waitcnt lgkmcnt(0)
    v_mfma_f32_16x16x32_bf16 v[80:83], v[224:227], v[32:35], v[80:83]
    v_mfma_f32_16x16x32_bf16 v[112:115], v[224:227], v[40:43], v[112:115]
    v_mfma_f32_16x16x32_bf16 v[144:147], v[224:227], v[48:51], v[144:147]
    s_waitcnt vmcnt(20)
    s_barrier
    s_add_u32 m0, s38, 32768
    s_add_u32 s31, s40, 0
    buffer_load_dwordx4 v242, s[12:15], s31 offen lds
    s_add_u32 m0, s38, 36864
    s_add_u32 s31, s40, 4096
    buffer_load_dwordx4 v242, s[12:15], s31 offen lds
    s_add_u32 m0, s38, 40960
    s_add_u32 s31, s40, 32768
    buffer_load_dwordx4 v242, s[12:15], s31 offen lds
    s_add_u32 m0, s38, 45056
    s_add_u32 s31, s40, 36864
    buffer_load_dwordx4 v242, s[12:15], s31 offen lds
    s_add_u32 s40, s40, 65536
    buffer_load_dwordx4 v[28:31], v1, s[8:11], s35 offen offset:0
    buffer_load_dwordx4 v[32:35], v1, s[8:11], s35 offen offset:64
    buffer_load_dwordx4 v[36:39], v1, s[8:11], s36 offen offset:0
    buffer_load_dwordx4 v[40:43], v1, s[8:11], s36 offen offset:64
    buffer_load_dwordx4 v[44:47], v1, s[8:11], s37 offen offset:0
    buffer_load_dwordx4 v[48:51], v1, s[8:11], s37 offen offset:64
    s_add_u32 s35, s35, 128
    s_add_u32 s36, s36, 128
    s_add_u32 s37, s37, 128
    ds_read_b64_tr_b16 v[196:197], v243 offset:0
    ds_read_b64_tr_b16 v[198:199], v243 offset:4096
    ds_read_b64_tr_b16 v[200:201], v243 offset:8192
    ds_read_b64_tr_b16 v[202:203], v243 offset:12288
    ds_read_b64_tr_b16 v[204:205], v244 offset:0
    ds_read_b64_tr_b16 v[206:207], v244 offset:4096
    ds_read_b64_tr_b16 v[208:209], v244 offset:8192
    ds_read_b64_tr_b16 v[210:211], v244 offset:12288
    ds_read_b64_tr_b16 v[212:213], v245 offset:0
    ds_read_b64_tr_b16 v[214:215], v245 offset:4096
    s_waitcnt lgkmcnt(8)
    v_mfma_f32_16x16x32_bf16 v[52:55], v[196:199], v[148:151], v[52:55]
    v_mfma_f32_16x16x32_bf16 v[84:87], v[196:199], v[156:159], v[84:87]
    v_mfma_f32_16x16x32_bf16 v[116:119], v[196:199], v[164:167], v[116:119]
    ds_read_b64_tr_b16 v[216:217], v245 offset:8192
    ds_read_b64_tr_b16 v[218:219], v245 offset:12288
    s_waitcnt lgkmcnt(8)
    v_mfma_f32_16x16x32_bf16 v[52:55], v[200:203], v[152:155], v[52:55]
    v_mfma_f32_16x16x32_bf16 v[84:87], v[200:203], v[160:163], v[84:87]
    v_mfma_f32_16x16x32_bf16 v[116:119], v[200:203], v[168:171], v[116:119]
    ds_read_b64_tr_b16 v[220:221], v246 offset:0
    ds_read_b64_tr_b16 v[222:223], v246 offset:4096
    s_waitcnt lgkmcnt(8)
    v_mfma_f32_16x16x32_bf16 v[56:59], v[204:207], v[148:151], v[56:59]
    v_mfma_f32_16x16x32_bf16 v[88:91], v[204:207], v[156:159], v[88:91]
    v_mfma_f32_16x16x32_bf16 v[120:123], v[204:207], v[164:167], v[120:123]
    ds_read_b64_tr_b16 v[224:225], v246 offset:8192
    ds_read_b64_tr_b16 v[226:227], v246 offset:12288
    s_waitcnt lgkmcnt(8)
    v_mfma_f32_16x16x32_bf16 v[56:59], v[208:211], v[152:155], v[56:59]
    v_mfma_f32_16x16x32_bf16 v[88:91], v[208:211], v[160:163], v[88:91]
    v_mfma_f32_16x16x32_bf16 v[120:123], v[208:211], v[168:171], v[120:123]
    ds_read_b64_tr_b16 v[196:197], v247 offset:0
    ds_read_b64_tr_b16 v[198:199], v247 offset:4096
    s_waitcnt lgkmcnt(8)
    v_mfma_f32_16x16x32_bf16 v[60:63], v[212:215], v[148:151], v[60:63]
    v_mfma_f32_16x16x32_bf16 v[92:95], v[212:215], v[156:159], v[92:95]
    v_mfma_f32_16x16x32_bf16 v[124:127], v[212:215], v[164:167], v[124:127]
    ds_read_b64_tr_b16 v[200:201], v247 offset:8192
    ds_read_b64_tr_b16 v[202:203], v247 offset:12288
    s_waitcnt lgkmcnt(8)
    v_mfma_f32_16x16x32_bf16 v[60:63], v[216:219], v[152:155], v[60:63]
    v_mfma_f32_16x16x32_bf16 v[92:95], v[216:219], v[160:163], v[92:95]
    v_mfma_f32_16x16x32_bf16 v[124:127], v[216:219], v[168:171], v[124:127]
    ds_read_b64_tr_b16 v[204:205], v248 offset:0
    ds_read_b64_tr_b16 v[206:207], v248 offset:4096
    s_waitcnt lgkmcnt(8)
    v_mfma_f32_16x16x32_bf16 v[64:67], v[220:223], v[148:151], v[64:67]
    v_mfma_f32_16x16x32_bf16 v[96:99], v[220:223], v[156:159], v[96:99]
    v_mfma_f32_16x16x32_bf16 v[128:131], v[220:223], v[164:167], v[128:131]
    ds_read_b64_tr_b16 v[208:209], v248 offset:8192
    ds_read_b64_tr_b16 v[210:211], v248 offset:12288
    s_waitcnt lgkmcnt(8)
    v_mfma_f32_16x16x32_bf16 v[64:67], v[224:227], v[152:155], v[64:67]
    v_mfma_f32_16x16x32_bf16 v[96:99], v[224:227], v[160:163], v[96:99]
    v_mfma_f32_16x16x32_bf16 v[128:131], v[224:227], v[168:171], v[128:131]
    ds_read_b64_tr_b16 v[212:213], v249 offset:0
    ds_read_b64_tr_b16 v[214:215], v249 offset:4096
    s_waitcnt lgkmcnt(8)
    v_mfma_f32_16x16x32_bf16 v[68:71], v[196:199], v[148:151], v[68:71]
    v_mfma_f32_16x16x32_bf16 v[100:103], v[196:199], v[156:159], v[100:103]
    v_mfma_f32_16x16x32_bf16 v[132:135], v[196:199], v[164:167], v[132:135]
    ds_read_b64_tr_b16 v[216:217], v249 offset:8192
    ds_read_b64_tr_b16 v[218:219], v249 offset:12288
    s_waitcnt lgkmcnt(8)
    v_mfma_f32_16x16x32_bf16 v[68:71], v[200:203], v[152:155], v[68:71]
    v_mfma_f32_16x16x32_bf16 v[100:103], v[200:203], v[160:163], v[100:103]
    v_mfma_f32_16x16x32_bf16 v[132:135], v[200:203], v[168:171], v[132:135]
    ds_read_b64_tr_b16 v[220:221], v250 offset:0
    ds_read_b64_tr_b16 v[222:223], v250 offset:4096
    s_waitcnt lgkmcnt(8)
    v_mfma_f32_16x16x32_bf16 v[72:75], v[204:207], v[148:151], v[72:75]
    v_mfma_f32_16x16x32_bf16 v[104:107], v[204:207], v[156:159], v[104:107]
    v_mfma_f32_16x16x32_bf16 v[136:139], v[204:207], v[164:167], v[136:139]
    ds_read_b64_tr_b16 v[224:225], v250 offset:8192
    ds_read_b64_tr_b16 v[226:227], v250 offset:12288
    s_waitcnt lgkmcnt(8)
    v_mfma_f32_16x16x32_bf16 v[72:75], v[208:211], v[152:155], v[72:75]
    v_mfma_f32_16x16x32_bf16 v[104:107], v[208:211], v[160:163], v[104:107]
    v_mfma_f32_16x16x32_bf16 v[136:139], v[208:211], v[168:171], v[136:139]
    s_waitcnt lgkmcnt(6)
    v_mfma_f32_16x16x32_bf16 v[76:79], v[212:215], v[148:151], v[76:79]
    v_mfma_f32_16x16x32_bf16 v[108:111], v[212:215], v[156:159], v[108:111]
    v_mfma_f32_16x16x32_bf16 v[140:143], v[212:215], v[164:167], v[140:143]
    s_waitcnt lgkmcnt(4)
    v_mfma_f32_16x16x32_bf16 v[76:79], v[216:219], v[152:155], v[76:79]
    v_mfma_f32_16x16x32_bf16 v[108:111], v[216:219], v[160:163], v[108:111]
    v_mfma_f32_16x16x32_bf16 v[140:143], v[216:219], v[168:171], v[140:143]
    s_waitcnt lgkmcnt(2)
    v_mfma_f32_16x16x32_bf16 v[80:83], v[220:223], v[148:151], v[80:83]
    v_mfma_f32_16x16x32_bf16 v[112:115], v[220:223], v[156:159], v[112:115]
    v_mfma_f32_16x16x32_bf16 v[144:147], v[220:223], v[164:167], v[144:147]
    s_waitcnt lgkmcnt(0)
    v_mfma_f32_16x16x32_bf16 v[80:83], v[224:227], v[152:155], v[80:83]
    v_mfma_f32_16x16x32_bf16 v[112:115], v[224:227], v[160:163], v[112:115]
    v_mfma_f32_16x16x32_bf16 v[144:147], v[224:227], v[168:171], v[144:147]
    s_waitcnt vmcnt(20)
    s_barrier
    s_add_u32 m0, s38, 49152
    s_add_u32 s31, s40, 0
    buffer_load_dwordx4 v242, s[12:15], s31 offen lds
    s_add_u32 m0, s38, 53248
    s_add_u32 s31, s40, 4096
    buffer_load_dwordx4 v242, s[12:15], s31 offen lds
    s_add_u32 m0, s38, 57344
    s_add_u32 s31, s40, 32768
    buffer_load_dwordx4 v242, s[12:15], s31 offen lds
    s_add_u32 m0, s38, 61440
    s_add_u32 s31, s40, 36864
    buffer_load_dwordx4 v242, s[12:15], s31 offen lds
    s_add_u32 s40, s40, 65536
    buffer_load_dwordx4 v[148:151], v1, s[8:11], s35 offen offset:0
    buffer_load_dwordx4 v[152:155], v1, s[8:11], s35 offen offset:64
    buffer_load_dwordx4 v[156:159], v1, s[8:11], s36 offen offset:0
    buffer_load_dwordx4 v[160:163], v1, s[8:11], s36 offen offset:64
    buffer_load_dwordx4 v[164:167], v1, s[8:11], s37 offen offset:0
    buffer_load_dwordx4 v[168:171], v1, s[8:11], s37 offen offset:64
    s_add_u32 s35, s35, 128
    s_add_u32 s36, s36, 128
    s_add_u32 s37, s37, 128
    ds_read_b64_tr_b16 v[196:197], v243 offset:16384
    ds_read_b64_tr_b16 v[198:199], v243 offset:20480
    ds_read_b64_tr_b16 v[200:201], v243 offset:24576
    ds_read_b64_tr_b16 v[202:203], v243 offset:28672
    ds_read_b64_tr_b16 v[204:205], v244 offset:16384
    ds_read_b64_tr_b16 v[206:207], v244 offset:20480
    ds_read_b64_tr_b16 v[208:209], v244 offset:24576
    ds_read_b64_tr_b16 v[210:211], v244 offset:28672
    ds_read_b64_tr_b16 v[212:213], v245 offset:16384
    ds_read_b64_tr_b16 v[214:215], v245 offset:20480
    s_waitcnt lgkmcnt(8)
    v_mfma_f32_16x16x32_bf16 v[52:55], v[196:199], v[172:175], v[52:55]
    v_mfma_f32_16x16x32_bf16 v[84:87], v[196:199], v[180:183], v[84:87]
    v_mfma_f32_16x16x32_bf16 v[116:119], v[196:199], v[188:191], v[116:119]
    ds_read_b64_tr_b16 v[216:217], v245 offset:24576
    ds_read_b64_tr_b16 v[218:219], v245 offset:28672
    s_waitcnt lgkmcnt(8)
    v_mfma_f32_16x16x32_bf16 v[52:55], v[200:203], v[176:179], v[52:55]
    v_mfma_f32_16x16x32_bf16 v[84:87], v[200:203], v[184:187], v[84:87]
    v_mfma_f32_16x16x32_bf16 v[116:119], v[200:203], v[192:195], v[116:119]
    ds_read_b64_tr_b16 v[220:221], v246 offset:16384
    ds_read_b64_tr_b16 v[222:223], v246 offset:20480
    s_waitcnt lgkmcnt(8)
    v_mfma_f32_16x16x32_bf16 v[56:59], v[204:207], v[172:175], v[56:59]
    v_mfma_f32_16x16x32_bf16 v[88:91], v[204:207], v[180:183], v[88:91]
    v_mfma_f32_16x16x32_bf16 v[120:123], v[204:207], v[188:191], v[120:123]
    ds_read_b64_tr_b16 v[224:225], v246 offset:24576
    ds_read_b64_tr_b16 v[226:227], v246 offset:28672
    s_waitcnt lgkmcnt(8)
    v_mfma_f32_16x16x32_bf16 v[56:59], v[208:211], v[176:179], v[56:59]
    v_mfma_f32_16x16x32_bf16 v[88:91], v[208:211], v[184:187], v[88:91]
    v_mfma_f32_16x16x32_bf16 v[120:123], v[208:211], v[192:195], v[120:123]
    ds_read_b64_tr_b16 v[196:197], v247 offset:16384
    ds_read_b64_tr_b16 v[198:199], v247 offset:20480
    s_waitcnt lgkmcnt(8)
    v_mfma_f32_16x16x32_bf16 v[60:63], v[212:215], v[172:175], v[60:63]
    v_mfma_f32_16x16x32_bf16 v[92:95], v[212:215], v[180:183], v[92:95]
    v_mfma_f32_16x16x32_bf16 v[124:127], v[212:215], v[188:191], v[124:127]
    ds_read_b64_tr_b16 v[200:201], v247 offset:24576
    ds_read_b64_tr_b16 v[202:203], v247 offset:28672
    s_waitcnt lgkmcnt(8)
    v_mfma_f32_16x16x32_bf16 v[60:63], v[216:219], v[176:179], v[60:63]
    v_mfma_f32_16x16x32_bf16 v[92:95], v[216:219], v[184:187], v[92:95]
    v_mfma_f32_16x16x32_bf16 v[124:127], v[216:219], v[192:195], v[124:127]
    ds_read_b64_tr_b16 v[204:205], v248 offset:16384
    ds_read_b64_tr_b16 v[206:207], v248 offset:20480
    s_waitcnt lgkmcnt(8)
    v_mfma_f32_16x16x32_bf16 v[64:67], v[220:223], v[172:175], v[64:67]
    v_mfma_f32_16x16x32_bf16 v[96:99], v[220:223], v[180:183], v[96:99]
    v_mfma_f32_16x16x32_bf16 v[128:131], v[220:223], v[188:191], v[128:131]
    ds_read_b64_tr_b16 v[208:209], v248 offset:24576
    ds_read_b64_tr_b16 v[210:211], v248 offset:28672
    s_waitcnt lgkmcnt(8)
    v_mfma_f32_16x16x32_bf16 v[64:67], v[224:227], v[176:179], v[64:67]
    v_mfma_f32_16x16x32_bf16 v[96:99], v[224:227], v[184:187], v[96:99]
    v_mfma_f32_16x16x32_bf16 v[128:131], v[224:227], v[192:195], v[128:131]
    ds_read_b64_tr_b16 v[212:213], v249 offset:16384
    ds_read_b64_tr_b16 v[214:215], v249 offset:20480
    s_waitcnt lgkmcnt(8)
    v_mfma_f32_16x16x32_bf16 v[68:71], v[196:199], v[172:175], v[68:71]
    v_mfma_f32_16x16x32_bf16 v[100:103], v[196:199], v[180:183], v[100:103]
    v_mfma_f32_16x16x32_bf16 v[132:135], v[196:199], v[188:191], v[132:135]
    ds_read_b64_tr_b16 v[216:217], v249 offset:24576
    ds_read_b64_tr_b16 v[218:219], v249 offset:28672
    s_waitcnt lgkmcnt(8)
    v_mfma_f32_16x16x32_bf16 v[68:71], v[200:203], v[176:179], v[68:71]
    v_mfma_f32_16x16x32_bf16 v[100:103], v[200:203], v[184:187], v[100:103]
    v_mfma_f32_16x16x32_bf16 v[132:135], v[200:203], v[192:195], v[132:135]
    ds_read_b64_tr_b16 v[220:221], v250 offset:16384
    ds_read_b64_tr_b16 v[222:223], v250 offset:20480
    s_waitcnt lgkmcnt(8)
    v_mfma_f32_16x16x32_bf16 v[72:75], v[204:207], v[172:175], v[72:75]
    v_mfma_f32_16x16x32_bf16 v[104:107], v[204:207], v[180:183], v[104:107]
    v_mfma_f32_16x16x32_bf16 v[136:139], v[204:207], v[188:191], v[136:139]
    ds_read_b64_tr_b16 v[224:225], v250 offset:24576
    ds_read_b64_tr_b16 v[226:227], v250 offset:28672
    s_waitcnt lgkmcnt(8)
    v_mfma_f32_16x16x32_bf16 v[72:75], v[208:211], v[176:179], v[72:75]
    v_mfma_f32_16x16x32_bf16 v[104:107], v[208:211], v[184:187], v[104:107]
    v_mfma_f32_16x16x32_bf16 v[136:139], v[208:211], v[192:195], v[136:139]
    s_waitcnt lgkmcnt(6)
    v_mfma_f32_16x16x32_bf16 v[76:79], v[212:215], v[172:175], v[76:79]
    v_mfma_f32_16x16x32_bf16 v[108:111], v[212:215], v[180:183], v[108:111]
    v_mfma_f32_16x16x32_bf16 v[140:143], v[212:215], v[188:191], v[140:143]
    s_waitcnt lgkmcnt(4)
    v_mfma_f32_16x16x32_bf16 v[76:79], v[216:219], v[176:179], v[76:79]
    v_mfma_f32_16x16x32_bf16 v[108:111], v[216:219], v[184:187], v[108:111]
    v_mfma_f32_16x16x32_bf16 v[140:143], v[216:219], v[192:195], v[140:143]
    s_waitcnt lgkmcnt(2)
    v_mfma_f32_16x16x32_bf16 v[80:83], v[220:223], v[172:175], v[80:83]
    v_mfma_f32_16x16x32_bf16 v[112:115], v[220:223], v[180:183], v[112:115]
    v_mfma_f32_16x16x32_bf16 v[144:147], v[220:223], v[188:191], v[144:147]
    s_waitcnt lgkmcnt(0)
    v_mfma_f32_16x16x32_bf16 v[80:83], v[224:227], v[176:179], v[80:83]
    v_mfma_f32_16x16x32_bf16 v[112:115], v[224:227], v[184:187], v[112:115]
    v_mfma_f32_16x16x32_bf16 v[144:147], v[224:227], v[192:195], v[144:147]
    s_waitcnt vmcnt(20)
    s_barrier
    s_add_u32 m0, s38, 65536
    s_add_u32 s31, s40, 0
    buffer_load_dwordx4 v242, s[12:15], s31 offen lds
    s_add_u32 m0, s38, 69632
    s_add_u32 s31, s40, 4096
    buffer_load_dwordx4 v242, s[12:15], s31 offen lds
    s_add_u32 m0, s38, 73728
    s_add_u32 s31, s40, 32768
    buffer_load_dwordx4 v242, s[12:15], s31 offen lds
    s_add_u32 m0, s38, 77824
    s_add_u32 s31, s40, 36864
    buffer_load_dwordx4 v242, s[12:15], s31 offen lds
    s_add_u32 s40, s40, 65536
    buffer_load_dwordx4 v[172:175], v1, s[8:11], s35 offen offset:0
    buffer_load_dwordx4 v[176:179], v1, s[8:11], s35 offen offset:64
    buffer_load_dwordx4 v[180:183], v1, s[8:11], s36 offen offset:0
    buffer_load_dwordx4 v[184:187], v1, s[8:11], s36 offen offset:64
    buffer_load_dwordx4 v[188:191], v1, s[8:11], s37 offen offset:0
    buffer_load_dwordx4 v[192:195], v1, s[8:11], s37 offen offset:64
    s_add_u32 s35, s35, 128
    s_add_u32 s36, s36, 128
    s_add_u32 s37, s37, 128
    ds_read_b64_tr_b16 v[196:197], v243 offset:32768
    ds_read_b64_tr_b16 v[198:199], v243 offset:36864
    ds_read_b64_tr_b16 v[200:201], v243 offset:40960
    ds_read_b64_tr_b16 v[202:203], v243 offset:45056
    ds_read_b64_tr_b16 v[204:205], v244 offset:32768
    ds_read_b64_tr_b16 v[206:207], v244 offset:36864
    ds_read_b64_tr_b16 v[208:209], v244 offset:40960
    ds_read_b64_tr_b16 v[210:211], v244 offset:45056
    ds_read_b64_tr_b16 v[212:213], v245 offset:32768
    ds_read_b64_tr_b16 v[214:215], v245 offset:36864
    s_waitcnt lgkmcnt(8)
    v_mfma_f32_16x16x32_bf16 v[52:55], v[196:199], v[4:7], v[52:55]
    v_mfma_f32_16x16x32_bf16 v[84:87], v[196:199], v[12:15], v[84:87]
    v_mfma_f32_16x16x32_bf16 v[116:119], v[196:199], v[20:23], v[116:119]
    ds_read_b64_tr_b16 v[216:217], v245 offset:40960
    ds_read_b64_tr_b16 v[218:219], v245 offset:45056
    s_waitcnt lgkmcnt(8)
    v_mfma_f32_16x16x32_bf16 v[52:55], v[200:203], v[8:11], v[52:55]
    v_mfma_f32_16x16x32_bf16 v[84:87], v[200:203], v[16:19], v[84:87]
    v_mfma_f32_16x16x32_bf16 v[116:119], v[200:203], v[24:27], v[116:119]
    ds_read_b64_tr_b16 v[220:221], v246 offset:32768
    ds_read_b64_tr_b16 v[222:223], v246 offset:36864
    s_waitcnt lgkmcnt(8)
    v_mfma_f32_16x16x32_bf16 v[56:59], v[204:207], v[4:7], v[56:59]
    v_mfma_f32_16x16x32_bf16 v[88:91], v[204:207], v[12:15], v[88:91]
    v_mfma_f32_16x16x32_bf16 v[120:123], v[204:207], v[20:23], v[120:123]
    ds_read_b64_tr_b16 v[224:225], v246 offset:40960
    ds_read_b64_tr_b16 v[226:227], v246 offset:45056
    s_waitcnt lgkmcnt(8)
    v_mfma_f32_16x16x32_bf16 v[56:59], v[208:211], v[8:11], v[56:59]
    v_mfma_f32_16x16x32_bf16 v[88:91], v[208:211], v[16:19], v[88:91]
    v_mfma_f32_16x16x32_bf16 v[120:123], v[208:211], v[24:27], v[120:123]
    ds_read_b64_tr_b16 v[196:197], v247 offset:32768
    ds_read_b64_tr_b16 v[198:199], v247 offset:36864
    s_waitcnt lgkmcnt(8)
    v_mfma_f32_16x16x32_bf16 v[60:63], v[212:215], v[4:7], v[60:63]
    v_mfma_f32_16x16x32_bf16 v[92:95], v[212:215], v[12:15], v[92:95]
    v_mfma_f32_16x16x32_bf16 v[124:127], v[212:215], v[20:23], v[124:127]
    ds_read_b64_tr_b16 v[200:201], v247 offset:40960
    ds_read_b64_tr_b16 v[202:203], v247 offset:45056
    s_waitcnt lgkmcnt(8)
    v_mfma_f32_16x16x32_bf16 v[60:63], v[216:219], v[8:11], v[60:63]
    v_mfma_f32_16x16x32_bf16 v[92:95], v[216:219], v[16:19], v[92:95]
    v_mfma_f32_16x16x32_bf16 v[124:127], v[216:219], v[24:27], v[124:127]
    ds_read_b64_tr_b16 v[204:205], v248 offset:32768
    ds_read_b64_tr_b16 v[206:207], v248 offset:36864
    s_waitcnt lgkmcnt(8)
    v_mfma_f32_16x16x32_bf16 v[64:67], v[220:223], v[4:7], v[64:67]
    v_mfma_f32_16x16x32_bf16 v[96:99], v[220:223], v[12:15], v[96:99]
    v_mfma_f32_16x16x32_bf16 v[128:131], v[220:223], v[20:23], v[128:131]
    ds_read_b64_tr_b16 v[208:209], v248 offset:40960
    ds_read_b64_tr_b16 v[210:211], v248 offset:45056
    s_waitcnt lgkmcnt(8)
    v_mfma_f32_16x16x32_bf16 v[64:67], v[224:227], v[8:11], v[64:67]
    v_mfma_f32_16x16x32_bf16 v[96:99], v[224:227], v[16:19], v[96:99]
    v_mfma_f32_16x16x32_bf16 v[128:131], v[224:227], v[24:27], v[128:131]
    ds_read_b64_tr_b16 v[212:213], v249 offset:32768
    ds_read_b64_tr_b16 v[214:215], v249 offset:36864
    s_waitcnt lgkmcnt(8)
    v_mfma_f32_16x16x32_bf16 v[68:71], v[196:199], v[4:7], v[68:71]
    v_mfma_f32_16x16x32_bf16 v[100:103], v[196:199], v[12:15], v[100:103]
    v_mfma_f32_16x16x32_bf16 v[132:135], v[196:199], v[20:23], v[132:135]
    ds_read_b64_tr_b16 v[216:217], v249 offset:40960
    ds_read_b64_tr_b16 v[218:219], v249 offset:45056
    s_waitcnt lgkmcnt(8)
    v_mfma_f32_16x16x32_bf16 v[68:71], v[200:203], v[8:11], v[68:71]
    v_mfma_f32_16x16x32_bf16 v[100:103], v[200:203], v[16:19], v[100:103]
    v_mfma_f32_16x16x32_bf16 v[132:135], v[200:203], v[24:27], v[132:135]
    ds_read_b64_tr_b16 v[220:221], v250 offset:32768
    ds_read_b64_tr_b16 v[222:223], v250 offset:36864
    s_waitcnt lgkmcnt(8)
    v_mfma_f32_16x16x32_bf16 v[72:75], v[204:207], v[4:7], v[72:75]
    v_mfma_f32_16x16x32_bf16 v[104:107], v[204:207], v[12:15], v[104:107]
    v_mfma_f32_16x16x32_bf16 v[136:139], v[204:207], v[20:23], v[136:139]
    ds_read_b64_tr_b16 v[224:225], v250 offset:40960
    ds_read_b64_tr_b16 v[226:227], v250 offset:45056
    s_waitcnt lgkmcnt(8)
    v_mfma_f32_16x16x32_bf16 v[72:75], v[208:211], v[8:11], v[72:75]
    v_mfma_f32_16x16x32_bf16 v[104:107], v[208:211], v[16:19], v[104:107]
    v_mfma_f32_16x16x32_bf16 v[136:139], v[208:211], v[24:27], v[136:139]
    s_waitcnt lgkmcnt(6)
    v_mfma_f32_16x16x32_bf16 v[76:79], v[212:215], v[4:7], v[76:79]
    v_mfma_f32_16x16x32_bf16 v[108:111], v[212:215], v[12:15], v[108:111]
    v_mfma_f32_16x16x32_bf16 v[140:143], v[212:215], v[20:23], v[140:143]
    s_waitcnt lgkmcnt(4)
    v_mfma_f32_16x16x32_bf16 v[76:79], v[216:219], v[8:11], v[76:79]
    v_mfma_f32_16x16x32_bf16 v[108:111], v[216:219], v[16:19], v[108:111]
    v_mfma_f32_16x16x32_bf16 v[140:143], v[216:219], v[24:27], v[140:143]
    s_waitcnt lgkmcnt(2)
    v_mfma_f32_16x16x32_bf16 v[80:83], v[220:223], v[4:7], v[80:83]
    v_mfma_f32_16x16x32_bf16 v[112:115], v[220:223], v[12:15], v[112:115]
    v_mfma_f32_16x16x32_bf16 v[144:147], v[220:223], v[20:23], v[144:147]
    s_waitcnt lgkmcnt(0)
    v_mfma_f32_16x16x32_bf16 v[80:83], v[224:227], v[8:11], v[80:83]
    v_mfma_f32_16x16x32_bf16 v[112:115], v[224:227], v[16:19], v[112:115]
    v_mfma_f32_16x16x32_bf16 v[144:147], v[224:227], v[24:27], v[144:147]
    s_waitcnt vmcnt(20)
    s_barrier
    s_add_u32 m0, s38, 81920
    s_add_u32 s31, s40, 0
    buffer_load_dwordx4 v242, s[12:15], s31 offen lds
    s_add_u32 m0, s38, 86016
    s_add_u32 s31, s40, 4096
    buffer_load_dwordx4 v242, s[12:15], s31 offen lds
    s_add_u32 m0, s38, 90112
    s_add_u32 s31, s40, 32768
    buffer_load_dwordx4 v242, s[12:15], s31 offen lds
    s_add_u32 m0, s38, 94208
    s_add_u32 s31, s40, 36864
    buffer_load_dwordx4 v242, s[12:15], s31 offen lds
    s_add_u32 s40, s40, 65536
    buffer_load_dwordx4 v[4:7], v1, s[8:11], s35 offen offset:0
    buffer_load_dwordx4 v[8:11], v1, s[8:11], s35 offen offset:64
    buffer_load_dwordx4 v[12:15], v1, s[8:11], s36 offen offset:0
    buffer_load_dwordx4 v[16:19], v1, s[8:11], s36 offen offset:64
    buffer_load_dwordx4 v[20:23], v1, s[8:11], s37 offen offset:0
    buffer_load_dwordx4 v[24:27], v1, s[8:11], s37 offen offset:64
    s_add_u32 s35, s35, 128
    s_add_u32 s36, s36, 128
    s_add_u32 s37, s37, 128
    ds_read_b64_tr_b16 v[196:197], v243 offset:49152
    ds_read_b64_tr_b16 v[198:199], v243 offset:53248
    ds_read_b64_tr_b16 v[200:201], v243 offset:57344
    ds_read_b64_tr_b16 v[202:203], v243 offset:61440
    ds_read_b64_tr_b16 v[204:205], v244 offset:49152
    ds_read_b64_tr_b16 v[206:207], v244 offset:53248
    ds_read_b64_tr_b16 v[208:209], v244 offset:57344
    ds_read_b64_tr_b16 v[210:211], v244 offset:61440
    ds_read_b64_tr_b16 v[212:213], v245 offset:49152
    ds_read_b64_tr_b16 v[214:215], v245 offset:53248
    s_waitcnt lgkmcnt(8)
    v_mfma_f32_16x16x32_bf16 v[52:55], v[196:199], v[28:31], v[52:55]
    v_mfma_f32_16x16x32_bf16 v[84:87], v[196:199], v[36:39], v[84:87]
    v_mfma_f32_16x16x32_bf16 v[116:119], v[196:199], v[44:47], v[116:119]
    ds_read_b64_tr_b16 v[216:217], v245 offset:57344
    ds_read_b64_tr_b16 v[218:219], v245 offset:61440
    s_waitcnt lgkmcnt(8)
    v_mfma_f32_16x16x32_bf16 v[52:55], v[200:203], v[32:35], v[52:55]
    v_mfma_f32_16x16x32_bf16 v[84:87], v[200:203], v[40:43], v[84:87]
    v_mfma_f32_16x16x32_bf16 v[116:119], v[200:203], v[48:51], v[116:119]
    ds_read_b64_tr_b16 v[220:221], v246 offset:49152
    ds_read_b64_tr_b16 v[222:223], v246 offset:53248
    s_waitcnt lgkmcnt(8)
    v_mfma_f32_16x16x32_bf16 v[56:59], v[204:207], v[28:31], v[56:59]
    v_mfma_f32_16x16x32_bf16 v[88:91], v[204:207], v[36:39], v[88:91]
    v_mfma_f32_16x16x32_bf16 v[120:123], v[204:207], v[44:47], v[120:123]
    ds_read_b64_tr_b16 v[224:225], v246 offset:57344
    ds_read_b64_tr_b16 v[226:227], v246 offset:61440
    s_waitcnt lgkmcnt(8)
    v_mfma_f32_16x16x32_bf16 v[56:59], v[208:211], v[32:35], v[56:59]
    v_mfma_f32_16x16x32_bf16 v[88:91], v[208:211], v[40:43], v[88:91]
    v_mfma_f32_16x16x32_bf16 v[120:123], v[208:211], v[48:51], v[120:123]
    ds_read_b64_tr_b16 v[196:197], v247 offset:49152
    ds_read_b64_tr_b16 v[198:199], v247 offset:53248
    s_waitcnt lgkmcnt(8)
    v_mfma_f32_16x16x32_bf16 v[60:63], v[212:215], v[28:31], v[60:63]
    v_mfma_f32_16x16x32_bf16 v[92:95], v[212:215], v[36:39], v[92:95]
    v_mfma_f32_16x16x32_bf16 v[124:127], v[212:215], v[44:47], v[124:127]
    ds_read_b64_tr_b16 v[200:201], v247 offset:57344
    ds_read_b64_tr_b16 v[202:203], v247 offset:61440
    s_waitcnt lgkmcnt(8)
    v_mfma_f32_16x16x32_bf16 v[60:63], v[216:219], v[32:35], v[60:63]
    v_mfma_f32_16x16x32_bf16 v[92:95], v[216:219], v[40:43], v[92:95]
    v_mfma_f32_16x16x32_bf16 v[124:127], v[216:219], v[48:51], v[124:127]
    ds_read_b64_tr_b16 v[204:205], v248 offset:49152
    ds_read_b64_tr_b16 v[206:207], v248 offset:53248
    s_waitcnt lgkmcnt(8)
    v_mfma_f32_16x16x32_bf16 v[64:67], v[220:223], v[28:31], v[64:67]
    v_mfma_f32_16x16x32_bf16 v[96:99], v[220:223], v[36:39], v[96:99]
    v_mfma_f32_16x16x32_bf16 v[128:131], v[220:223], v[44:47], v[128:131]
    ds_read_b64_tr_b16 v[208:209], v248 offset:57344
    ds_read_b64_tr_b16 v[210:211], v248 offset:61440
    s_waitcnt lgkmcnt(8)
    v_mfma_f32_16x16x32_bf16 v[64:67], v[224:227], v[32:35], v[64:67]
    v_mfma_f32_16x16x32_bf16 v[96:99], v[224:227], v[40:43], v[96:99]
    v_mfma_f32_16x16x32_bf16 v[128:131], v[224:227], v[48:51], v[128:131]
    ds_read_b64_tr_b16 v[212:213], v249 offset:49152
    ds_read_b64_tr_b16 v[214:215], v249 offset:53248
    s_waitcnt lgkmcnt(8)
    v_mfma_f32_16x16x32_bf16 v[68:71], v[196:199], v[28:31], v[68:71]
    v_mfma_f32_16x16x32_bf16 v[100:103], v[196:199], v[36:39], v[100:103]
    v_mfma_f32_16x16x32_bf16 v[132:135], v[196:199], v[44:47], v[132:135]
    ds_read_b64_tr_b16 v[216:217], v249 offset:57344
    ds_read_b64_tr_b16 v[218:219], v249 offset:61440
    s_waitcnt lgkmcnt(8)
    v_mfma_f32_16x16x32_bf16 v[68:71], v[200:203], v[32:35], v[68:71]
    v_mfma_f32_16x16x32_bf16 v[100:103], v[200:203], v[40:43], v[100:103]
    v_mfma_f32_16x16x32_bf16 v[132:135], v[200:203], v[48:51], v[132:135]
    ds_read_b64_tr_b16 v[220:221], v250 offset:49152
    ds_read_b64_tr_b16 v[222:223], v250 offset:53248
    s_waitcnt lgkmcnt(8)
    v_mfma_f32_16x16x32_bf16 v[72:75], v[204:207], v[28:31], v[72:75]
    v_mfma_f32_16x16x32_bf16 v[104:107], v[204:207], v[36:39], v[104:107]
    v_mfma_f32_16x16x32_bf16 v[136:139], v[204:207], v[44:47], v[136:139]
    ds_read_b64_tr_b16 v[224:225], v250 offset:57344
    ds_read_b64_tr_b16 v[226:227], v250 offset:61440
    s_waitcnt lgkmcnt(8)
    v_mfma_f32_16x16x32_bf16 v[72:75], v[208:211], v[32:35], v[72:75]
    v_mfma_f32_16x16x32_bf16 v[104:107], v[208:211], v[40:43], v[104:107]
    v_mfma_f32_16x16x32_bf16 v[136:139], v[208:211], v[48:51], v[136:139]
    s_waitcnt lgkmcnt(6)
    v_mfma_f32_16x16x32_bf16 v[76:79], v[212:215], v[28:31], v[76:79]
    v_mfma_f32_16x16x32_bf16 v[108:111], v[212:215], v[36:39], v[108:111]
    v_mfma_f32_16x16x32_bf16 v[140:143], v[212:215], v[44:47], v[140:143]
    s_waitcnt lgkmcnt(4)
    v_mfma_f32_16x16x32_bf16 v[76:79], v[216:219], v[32:35], v[76:79]
    v_mfma_f32_16x16x32_bf16 v[108:111], v[216:219], v[40:43], v[108:111]
    v_mfma_f32_16x16x32_bf16 v[140:143], v[216:219], v[48:51], v[140:143]
    s_waitcnt lgkmcnt(2)
    v_mfma_f32_16x16x32_bf16 v[80:83], v[220:223], v[28:31], v[80:83]
    v_mfma_f32_16x16x32_bf16 v[112:115], v[220:223], v[36:39], v[112:115]
    v_mfma_f32_16x16x32_bf16 v[144:147], v[220:223], v[44:47], v[144:147]
    s_waitcnt lgkmcnt(0)
    v_mfma_f32_16x16x32_bf16 v[80:83], v[224:227], v[32:35], v[80:83]
    v_mfma_f32_16x16x32_bf16 v[112:115], v[224:227], v[40:43], v[112:115]
    v_mfma_f32_16x16x32_bf16 v[144:147], v[224:227], v[48:51], v[144:147]
    s_waitcnt vmcnt(20)
    s_barrier
    s_add_u32 m0, s38, 98304
    s_add_u32 s31, s40, 0
    buffer_load_dwordx4 v242, s[12:15], s31 offen lds
    s_add_u32 m0, s38, 102400
    s_add_u32 s31, s40, 4096
    buffer_load_dwordx4 v242, s[12:15], s31 offen lds
    s_add_u32 m0, s38, 106496
    s_add_u32 s31, s40, 32768
    buffer_load_dwordx4 v242, s[12:15], s31 offen lds
    s_add_u32 m0, s38, 110592
    s_add_u32 s31, s40, 36864
    buffer_load_dwordx4 v242, s[12:15], s31 offen lds
    s_add_u32 s40, s40, 65536
    buffer_load_dwordx4 v[28:31], v1, s[8:11], s35 offen offset:0
    buffer_load_dwordx4 v[32:35], v1, s[8:11], s35 offen offset:64
    buffer_load_dwordx4 v[36:39], v1, s[8:11], s36 offen offset:0
    buffer_load_dwordx4 v[40:43], v1, s[8:11], s36 offen offset:64
    buffer_load_dwordx4 v[44:47], v1, s[8:11], s37 offen offset:0
    buffer_load_dwordx4 v[48:51], v1, s[8:11], s37 offen offset:64
    s_add_u32 s35, s35, 128
    s_add_u32 s36, s36, 128
    s_add_u32 s37, s37, 128
    ds_read_b64_tr_b16 v[196:197], v232 offset:0
    ds_read_b64_tr_b16 v[198:199], v232 offset:4096
    ds_read_b64_tr_b16 v[200:201], v232 offset:8192
    ds_read_b64_tr_b16 v[202:203], v232 offset:12288
    ds_read_b64_tr_b16 v[204:205], v233 offset:0
    ds_read_b64_tr_b16 v[206:207], v233 offset:4096
    ds_read_b64_tr_b16 v[208:209], v233 offset:8192
    ds_read_b64_tr_b16 v[210:211], v233 offset:12288
    ds_read_b64_tr_b16 v[212:213], v234 offset:0
    ds_read_b64_tr_b16 v[214:215], v234 offset:4096
    s_waitcnt lgkmcnt(8)
    v_mfma_f32_16x16x32_bf16 v[52:55], v[196:199], v[148:151], v[52:55]
    v_mfma_f32_16x16x32_bf16 v[84:87], v[196:199], v[156:159], v[84:87]
    v_mfma_f32_16x16x32_bf16 v[116:119], v[196:199], v[164:167], v[116:119]
    ds_read_b64_tr_b16 v[216:217], v234 offset:8192
    ds_read_b64_tr_b16 v[218:219], v234 offset:12288
    s_waitcnt lgkmcnt(8)
    v_mfma_f32_16x16x32_bf16 v[52:55], v[200:203], v[152:155], v[52:55]
    v_mfma_f32_16x16x32_bf16 v[84:87], v[200:203], v[160:163], v[84:87]
    v_mfma_f32_16x16x32_bf16 v[116:119], v[200:203], v[168:171], v[116:119]
    ds_read_b64_tr_b16 v[220:221], v235 offset:0
    ds_read_b64_tr_b16 v[222:223], v235 offset:4096
    s_waitcnt lgkmcnt(8)
    v_mfma_f32_16x16x32_bf16 v[56:59], v[204:207], v[148:151], v[56:59]
    v_mfma_f32_16x16x32_bf16 v[88:91], v[204:207], v[156:159], v[88:91]
    v_mfma_f32_16x16x32_bf16 v[120:123], v[204:207], v[164:167], v[120:123]
    ds_read_b64_tr_b16 v[224:225], v235 offset:8192
    ds_read_b64_tr_b16 v[226:227], v235 offset:12288
    s_waitcnt lgkmcnt(8)
    v_mfma_f32_16x16x32_bf16 v[56:59], v[208:211], v[152:155], v[56:59]
    v_mfma_f32_16x16x32_bf16 v[88:91], v[208:211], v[160:163], v[88:91]
    v_mfma_f32_16x16x32_bf16 v[120:123], v[208:211], v[168:171], v[120:123]
    ds_read_b64_tr_b16 v[196:197], v236 offset:0
    ds_read_b64_tr_b16 v[198:199], v236 offset:4096
    s_waitcnt lgkmcnt(8)
    v_mfma_f32_16x16x32_bf16 v[60:63], v[212:215], v[148:151], v[60:63]
    v_mfma_f32_16x16x32_bf16 v[92:95], v[212:215], v[156:159], v[92:95]
    v_mfma_f32_16x16x32_bf16 v[124:127], v[212:215], v[164:167], v[124:127]
    ds_read_b64_tr_b16 v[200:201], v236 offset:8192
    ds_read_b64_tr_b16 v[202:203], v236 offset:12288
    s_waitcnt lgkmcnt(8)
    v_mfma_f32_16x16x32_bf16 v[60:63], v[216:219], v[152:155], v[60:63]
    v_mfma_f32_16x16x32_bf16 v[92:95], v[216:219], v[160:163], v[92:95]
    v_mfma_f32_16x16x32_bf16 v[124:127], v[216:219], v[168:171], v[124:127]
    ds_read_b64_tr_b16 v[204:205], v237 offset:0
    ds_read_b64_tr_b16 v[206:207], v237 offset:4096
    s_waitcnt lgkmcnt(8)
    v_mfma_f32_16x16x32_bf16 v[64:67], v[220:223], v[148:151], v[64:67]
    v_mfma_f32_16x16x32_bf16 v[96:99], v[220:223], v[156:159], v[96:99]
    v_mfma_f32_16x16x32_bf16 v[128:131], v[220:223], v[164:167], v[128:131]
    ds_read_b64_tr_b16 v[208:209], v237 offset:8192
    ds_read_b64_tr_b16 v[210:211], v237 offset:12288
    s_waitcnt lgkmcnt(8)
    v_mfma_f32_16x16x32_bf16 v[64:67], v[224:227], v[152:155], v[64:67]
    v_mfma_f32_16x16x32_bf16 v[96:99], v[224:227], v[160:163], v[96:99]
    v_mfma_f32_16x16x32_bf16 v[128:131], v[224:227], v[168:171], v[128:131]
    ds_read_b64_tr_b16 v[212:213], v238 offset:0
    ds_read_b64_tr_b16 v[214:215], v238 offset:4096
    s_waitcnt lgkmcnt(8)
    v_mfma_f32_16x16x32_bf16 v[68:71], v[196:199], v[148:151], v[68:71]
    v_mfma_f32_16x16x32_bf16 v[100:103], v[196:199], v[156:159], v[100:103]
    v_mfma_f32_16x16x32_bf16 v[132:135], v[196:199], v[164:167], v[132:135]
    ds_read_b64_tr_b16 v[216:217], v238 offset:8192
    ds_read_b64_tr_b16 v[218:219], v238 offset:12288
    s_waitcnt lgkmcnt(8)
    v_mfma_f32_16x16x32_bf16 v[68:71], v[200:203], v[152:155], v[68:71]
    v_mfma_f32_16x16x32_bf16 v[100:103], v[200:203], v[160:163], v[100:103]
    v_mfma_f32_16x16x32_bf16 v[132:135], v[200:203], v[168:171], v[132:135]
    ds_read_b64_tr_b16 v[220:221], v239 offset:0
    ds_read_b64_tr_b16 v[222:223], v239 offset:4096
    s_waitcnt lgkmcnt(8)
    v_mfma_f32_16x16x32_bf16 v[72:75], v[204:207], v[148:151], v[72:75]
    v_mfma_f32_16x16x32_bf16 v[104:107], v[204:207], v[156:159], v[104:107]
    v_mfma_f32_16x16x32_bf16 v[136:139], v[204:207], v[164:167], v[136:139]
    ds_read_b64_tr_b16 v[224:225], v239 offset:8192
    ds_read_b64_tr_b16 v[226:227], v239 offset:12288
    s_waitcnt lgkmcnt(8)
    v_mfma_f32_16x16x32_bf16 v[72:75], v[208:211], v[152:155], v[72:75]
    v_mfma_f32_16x16x32_bf16 v[104:107], v[208:211], v[160:163], v[104:107]
    v_mfma_f32_16x16x32_bf16 v[136:139], v[208:211], v[168:171], v[136:139]
    s_waitcnt lgkmcnt(6)
    v_mfma_f32_16x16x32_bf16 v[76:79], v[212:215], v[148:151], v[76:79]
    v_mfma_f32_16x16x32_bf16 v[108:111], v[212:215], v[156:159], v[108:111]
    v_mfma_f32_16x16x32_bf16 v[140:143], v[212:215], v[164:167], v[140:143]
    s_waitcnt lgkmcnt(4)
    v_mfma_f32_16x16x32_bf16 v[76:79], v[216:219], v[152:155], v[76:79]
    v_mfma_f32_16x16x32_bf16 v[108:111], v[216:219], v[160:163], v[108:111]
    v_mfma_f32_16x16x32_bf16 v[140:143], v[216:219], v[168:171], v[140:143]
    s_waitcnt lgkmcnt(2)
    v_mfma_f32_16x16x32_bf16 v[80:83], v[220:223], v[148:151], v[80:83]
    v_mfma_f32_16x16x32_bf16 v[112:115], v[220:223], v[156:159], v[112:115]
    v_mfma_f32_16x16x32_bf16 v[144:147], v[220:223], v[164:167], v[144:147]
    s_waitcnt lgkmcnt(0)
    v_mfma_f32_16x16x32_bf16 v[80:83], v[224:227], v[152:155], v[80:83]
    v_mfma_f32_16x16x32_bf16 v[112:115], v[224:227], v[160:163], v[112:115]
    v_mfma_f32_16x16x32_bf16 v[144:147], v[224:227], v[168:171], v[144:147]
    s_waitcnt vmcnt(20)
    s_barrier
    s_add_u32 m0, s38, 114688
    s_add_u32 s31, s40, 0
    buffer_load_dwordx4 v242, s[12:15], s31 offen lds
    s_add_u32 m0, s38, 118784
    s_add_u32 s31, s40, 4096
    buffer_load_dwordx4 v242, s[12:15], s31 offen lds
    s_add_u32 m0, s38, 122880
    s_add_u32 s31, s40, 32768
    buffer_load_dwordx4 v242, s[12:15], s31 offen lds
    s_add_u32 m0, s38, 126976
    s_add_u32 s31, s40, 36864
    buffer_load_dwordx4 v242, s[12:15], s31 offen lds
    s_add_u32 s40, s40, 65536
    buffer_load_dwordx4 v[148:151], v1, s[8:11], s35 offen offset:0
    buffer_load_dwordx4 v[152:155], v1, s[8:11], s35 offen offset:64
    buffer_load_dwordx4 v[156:159], v1, s[8:11], s36 offen offset:0
    buffer_load_dwordx4 v[160:163], v1, s[8:11], s36 offen offset:64
    buffer_load_dwordx4 v[164:167], v1, s[8:11], s37 offen offset:0
    buffer_load_dwordx4 v[168:171], v1, s[8:11], s37 offen offset:64
    s_add_u32 s35, s35, 128
    s_add_u32 s36, s36, 128
    s_add_u32 s37, s37, 128
    ds_read_b64_tr_b16 v[196:197], v232 offset:16384
    ds_read_b64_tr_b16 v[198:199], v232 offset:20480
    ds_read_b64_tr_b16 v[200:201], v232 offset:24576
    ds_read_b64_tr_b16 v[202:203], v232 offset:28672
    ds_read_b64_tr_b16 v[204:205], v233 offset:16384
    ds_read_b64_tr_b16 v[206:207], v233 offset:20480
    ds_read_b64_tr_b16 v[208:209], v233 offset:24576
    ds_read_b64_tr_b16 v[210:211], v233 offset:28672
    ds_read_b64_tr_b16 v[212:213], v234 offset:16384
    ds_read_b64_tr_b16 v[214:215], v234 offset:20480
    s_waitcnt lgkmcnt(8)
    v_mfma_f32_16x16x32_bf16 v[52:55], v[196:199], v[172:175], v[52:55]
    v_mfma_f32_16x16x32_bf16 v[84:87], v[196:199], v[180:183], v[84:87]
    v_mfma_f32_16x16x32_bf16 v[116:119], v[196:199], v[188:191], v[116:119]
    ds_read_b64_tr_b16 v[216:217], v234 offset:24576
    ds_read_b64_tr_b16 v[218:219], v234 offset:28672
    s_waitcnt lgkmcnt(8)
    v_mfma_f32_16x16x32_bf16 v[52:55], v[200:203], v[176:179], v[52:55]
    v_mfma_f32_16x16x32_bf16 v[84:87], v[200:203], v[184:187], v[84:87]
    v_mfma_f32_16x16x32_bf16 v[116:119], v[200:203], v[192:195], v[116:119]
    ds_read_b64_tr_b16 v[220:221], v235 offset:16384
    ds_read_b64_tr_b16 v[222:223], v235 offset:20480
    s_waitcnt lgkmcnt(8)
    v_mfma_f32_16x16x32_bf16 v[56:59], v[204:207], v[172:175], v[56:59]
    v_mfma_f32_16x16x32_bf16 v[88:91], v[204:207], v[180:183], v[88:91]
    v_mfma_f32_16x16x32_bf16 v[120:123], v[204:207], v[188:191], v[120:123]
    ds_read_b64_tr_b16 v[224:225], v235 offset:24576
    ds_read_b64_tr_b16 v[226:227], v235 offset:28672
    s_waitcnt lgkmcnt(8)
    v_mfma_f32_16x16x32_bf16 v[56:59], v[208:211], v[176:179], v[56:59]
    v_mfma_f32_16x16x32_bf16 v[88:91], v[208:211], v[184:187], v[88:91]
    v_mfma_f32_16x16x32_bf16 v[120:123], v[208:211], v[192:195], v[120:123]
    ds_read_b64_tr_b16 v[196:197], v236 offset:16384
    ds_read_b64_tr_b16 v[198:199], v236 offset:20480
    s_waitcnt lgkmcnt(8)
    v_mfma_f32_16x16x32_bf16 v[60:63], v[212:215], v[172:175], v[60:63]
    v_mfma_f32_16x16x32_bf16 v[92:95], v[212:215], v[180:183], v[92:95]
    v_mfma_f32_16x16x32_bf16 v[124:127], v[212:215], v[188:191], v[124:127]
    ds_read_b64_tr_b16 v[200:201], v236 offset:24576
    ds_read_b64_tr_b16 v[202:203], v236 offset:28672
    s_waitcnt lgkmcnt(8)
    v_mfma_f32_16x16x32_bf16 v[60:63], v[216:219], v[176:179], v[60:63]
    v_mfma_f32_16x16x32_bf16 v[92:95], v[216:219], v[184:187], v[92:95]
    v_mfma_f32_16x16x32_bf16 v[124:127], v[216:219], v[192:195], v[124:127]
    ds_read_b64_tr_b16 v[204:205], v237 offset:16384
    ds_read_b64_tr_b16 v[206:207], v237 offset:20480
    s_waitcnt lgkmcnt(8)
    v_mfma_f32_16x16x32_bf16 v[64:67], v[220:223], v[172:175], v[64:67]
    v_mfma_f32_16x16x32_bf16 v[96:99], v[220:223], v[180:183], v[96:99]
    v_mfma_f32_16x16x32_bf16 v[128:131], v[220:223], v[188:191], v[128:131]
    ds_read_b64_tr_b16 v[208:209], v237 offset:24576
    ds_read_b64_tr_b16 v[210:211], v237 offset:28672
    s_waitcnt lgkmcnt(8)
    v_mfma_f32_16x16x32_bf16 v[64:67], v[224:227], v[176:179], v[64:67]
    v_mfma_f32_16x16x32_bf16 v[96:99], v[224:227], v[184:187], v[96:99]
    v_mfma_f32_16x16x32_bf16 v[128:131], v[224:227], v[192:195], v[128:131]
    ds_read_b64_tr_b16 v[212:213], v238 offset:16384
    ds_read_b64_tr_b16 v[214:215], v238 offset:20480
    s_waitcnt lgkmcnt(8)
    v_mfma_f32_16x16x32_bf16 v[68:71], v[196:199], v[172:175], v[68:71]
    v_mfma_f32_16x16x32_bf16 v[100:103], v[196:199], v[180:183], v[100:103]
    v_mfma_f32_16x16x32_bf16 v[132:135], v[196:199], v[188:191], v[132:135]
    ds_read_b64_tr_b16 v[216:217], v238 offset:24576
    ds_read_b64_tr_b16 v[218:219], v238 offset:28672
    s_waitcnt lgkmcnt(8)
    v_mfma_f32_16x16x32_bf16 v[68:71], v[200:203], v[176:179], v[68:71]
    v_mfma_f32_16x16x32_bf16 v[100:103], v[200:203], v[184:187], v[100:103]
    v_mfma_f32_16x16x32_bf16 v[132:135], v[200:203], v[192:195], v[132:135]
    ds_read_b64_tr_b16 v[220:221], v239 offset:16384
    ds_read_b64_tr_b16 v[222:223], v239 offset:20480
    s_waitcnt lgkmcnt(8)
    v_mfma_f32_16x16x32_bf16 v[72:75], v[204:207], v[172:175], v[72:75]
    v_mfma_f32_16x16x32_bf16 v[104:107], v[204:207], v[180:183], v[104:107]
    v_mfma_f32_16x16x32_bf16 v[136:139], v[204:207], v[188:191], v[136:139]
    ds_read_b64_tr_b16 v[224:225], v239 offset:24576
    ds_read_b64_tr_b16 v[226:227], v239 offset:28672
    s_waitcnt lgkmcnt(8)
    v_mfma_f32_16x16x32_bf16 v[72:75], v[208:211], v[176:179], v[72:75]
    v_mfma_f32_16x16x32_bf16 v[104:107], v[208:211], v[184:187], v[104:107]
    v_mfma_f32_16x16x32_bf16 v[136:139], v[208:211], v[192:195], v[136:139]
    s_waitcnt lgkmcnt(6)
    v_mfma_f32_16x16x32_bf16 v[76:79], v[212:215], v[172:175], v[76:79]
    v_mfma_f32_16x16x32_bf16 v[108:111], v[212:215], v[180:183], v[108:111]
    v_mfma_f32_16x16x32_bf16 v[140:143], v[212:215], v[188:191], v[140:143]
    s_waitcnt lgkmcnt(4)
    v_mfma_f32_16x16x32_bf16 v[76:79], v[216:219], v[176:179], v[76:79]
    v_mfma_f32_16x16x32_bf16 v[108:111], v[216:219], v[184:187], v[108:111]
    v_mfma_f32_16x16x32_bf16 v[140:143], v[216:219], v[192:195], v[140:143]
    s_waitcnt lgkmcnt(2)
    v_mfma_f32_16x16x32_bf16 v[80:83], v[220:223], v[172:175], v[80:83]
    v_mfma_f32_16x16x32_bf16 v[112:115], v[220:223], v[180:183], v[112:115]
    v_mfma_f32_16x16x32_bf16 v[144:147], v[220:223], v[188:191], v[144:147]
    s_waitcnt lgkmcnt(0)
    v_mfma_f32_16x16x32_bf16 v[80:83], v[224:227], v[176:179], v[80:83]
    v_mfma_f32_16x16x32_bf16 v[112:115], v[224:227], v[184:187], v[112:115]
    v_mfma_f32_16x16x32_bf16 v[144:147], v[224:227], v[192:195], v[144:147]
    s_waitcnt vmcnt(20)
    s_barrier
    buffer_load_dwordx4 v[172:175], v1, s[8:11], s35 offen offset:0
    buffer_load_dwordx4 v[176:179], v1, s[8:11], s35 offen offset:64
    buffer_load_dwordx4 v[180:183], v1, s[8:11], s36 offen offset:0
    buffer_load_dwordx4 v[184:187], v1, s[8:11], s36 offen offset:64
    buffer_load_dwordx4 v[188:191], v1, s[8:11], s37 offen offset:0
    buffer_load_dwordx4 v[192:195], v1, s[8:11], s37 offen offset:64
    s_add_u32 s35, s35, 128
    s_add_u32 s36, s36, 128
    s_add_u32 s37, s37, 128
    ds_read_b64_tr_b16 v[196:197], v232 offset:32768
    ds_read_b64_tr_b16 v[198:199], v232 offset:36864
    ds_read_b64_tr_b16 v[200:201], v232 offset:40960
    ds_read_b64_tr_b16 v[202:203], v232 offset:45056
    ds_read_b64_tr_b16 v[204:205], v233 offset:32768
    ds_read_b64_tr_b16 v[206:207], v233 offset:36864
    ds_read_b64_tr_b16 v[208:209], v233 offset:40960
    ds_read_b64_tr_b16 v[210:211], v233 offset:45056
    ds_read_b64_tr_b16 v[212:213], v234 offset:32768
    ds_read_b64_tr_b16 v[214:215], v234 offset:36864
    s_waitcnt lgkmcnt(8)
    v_mfma_f32_16x16x32_bf16 v[52:55], v[196:199], v[4:7], v[52:55]
    v_mfma_f32_16x16x32_bf16 v[84:87], v[196:199], v[12:15], v[84:87]
    v_mfma_f32_16x16x32_bf16 v[116:119], v[196:199], v[20:23], v[116:119]
    ds_read_b64_tr_b16 v[216:217], v234 offset:40960
    ds_read_b64_tr_b16 v[218:219], v234 offset:45056
    s_waitcnt lgkmcnt(8)
    v_mfma_f32_16x16x32_bf16 v[52:55], v[200:203], v[8:11], v[52:55]
    v_mfma_f32_16x16x32_bf16 v[84:87], v[200:203], v[16:19], v[84:87]
    v_mfma_f32_16x16x32_bf16 v[116:119], v[200:203], v[24:27], v[116:119]
    ds_read_b64_tr_b16 v[220:221], v235 offset:32768
    ds_read_b64_tr_b16 v[222:223], v235 offset:36864
    s_waitcnt lgkmcnt(8)
    v_mfma_f32_16x16x32_bf16 v[56:59], v[204:207], v[4:7], v[56:59]
    v_mfma_f32_16x16x32_bf16 v[88:91], v[204:207], v[12:15], v[88:91]
    v_mfma_f32_16x16x32_bf16 v[120:123], v[204:207], v[20:23], v[120:123]
    ds_read_b64_tr_b16 v[224:225], v235 offset:40960
    ds_read_b64_tr_b16 v[226:227], v235 offset:45056
    s_waitcnt lgkmcnt(8)
    v_mfma_f32_16x16x32_bf16 v[56:59], v[208:211], v[8:11], v[56:59]
    v_mfma_f32_16x16x32_bf16 v[88:91], v[208:211], v[16:19], v[88:91]
    v_mfma_f32_16x16x32_bf16 v[120:123], v[208:211], v[24:27], v[120:123]
    ds_read_b64_tr_b16 v[196:197], v236 offset:32768
    ds_read_b64_tr_b16 v[198:199], v236 offset:36864
    s_waitcnt lgkmcnt(8)
    v_mfma_f32_16x16x32_bf16 v[60:63], v[212:215], v[4:7], v[60:63]
    v_mfma_f32_16x16x32_bf16 v[92:95], v[212:215], v[12:15], v[92:95]
    v_mfma_f32_16x16x32_bf16 v[124:127], v[212:215], v[20:23], v[124:127]
    ds_read_b64_tr_b16 v[200:201], v236 offset:40960
    ds_read_b64_tr_b16 v[202:203], v236 offset:45056
    s_waitcnt lgkmcnt(8)
    v_mfma_f32_16x16x32_bf16 v[60:63], v[216:219], v[8:11], v[60:63]
    v_mfma_f32_16x16x32_bf16 v[92:95], v[216:219], v[16:19], v[92:95]
    v_mfma_f32_16x16x32_bf16 v[124:127], v[216:219], v[24:27], v[124:127]
    ds_read_b64_tr_b16 v[204:205], v237 offset:32768
    ds_read_b64_tr_b16 v[206:207], v237 offset:36864
    s_waitcnt lgkmcnt(8)
    v_mfma_f32_16x16x32_bf16 v[64:67], v[220:223], v[4:7], v[64:67]
    v_mfma_f32_16x16x32_bf16 v[96:99], v[220:223], v[12:15], v[96:99]
    v_mfma_f32_16x16x32_bf16 v[128:131], v[220:223], v[20:23], v[128:131]
    ds_read_b64_tr_b16 v[208:209], v237 offset:40960
    ds_read_b64_tr_b16 v[210:211], v237 offset:45056
    s_waitcnt lgkmcnt(8)
    v_mfma_f32_16x16x32_bf16 v[64:67], v[224:227], v[8:11], v[64:67]
    v_mfma_f32_16x16x32_bf16 v[96:99], v[224:227], v[16:19], v[96:99]
    v_mfma_f32_16x16x32_bf16 v[128:131], v[224:227], v[24:27], v[128:131]
    ds_read_b64_tr_b16 v[212:213], v238 offset:32768
    ds_read_b64_tr_b16 v[214:215], v238 offset:36864
    s_waitcnt lgkmcnt(8)
    v_mfma_f32_16x16x32_bf16 v[68:71], v[196:199], v[4:7], v[68:71]
    v_mfma_f32_16x16x32_bf16 v[100:103], v[196:199], v[12:15], v[100:103]
    v_mfma_f32_16x16x32_bf16 v[132:135], v[196:199], v[20:23], v[132:135]
    ds_read_b64_tr_b16 v[216:217], v238 offset:40960
    ds_read_b64_tr_b16 v[218:219], v238 offset:45056
    s_waitcnt lgkmcnt(8)
    v_mfma_f32_16x16x32_bf16 v[68:71], v[200:203], v[8:11], v[68:71]
    v_mfma_f32_16x16x32_bf16 v[100:103], v[200:203], v[16:19], v[100:103]
    v_mfma_f32_16x16x32_bf16 v[132:135], v[200:203], v[24:27], v[132:135]
    ds_read_b64_tr_b16 v[220:221], v239 offset:32768
    ds_read_b64_tr_b16 v[222:223], v239 offset:36864
    s_waitcnt lgkmcnt(8)
    v_mfma_f32_16x16x32_bf16 v[72:75], v[204:207], v[4:7], v[72:75]
    v_mfma_f32_16x16x32_bf16 v[104:107], v[204:207], v[12:15], v[104:107]
    v_mfma_f32_16x16x32_bf16 v[136:139], v[204:207], v[20:23], v[136:139]
    ds_read_b64_tr_b16 v[224:225], v239 offset:40960
    ds_read_b64_tr_b16 v[226:227], v239 offset:45056
    s_waitcnt lgkmcnt(8)
    v_mfma_f32_16x16x32_bf16 v[72:75], v[208:211], v[8:11], v[72:75]
    v_mfma_f32_16x16x32_bf16 v[104:107], v[208:211], v[16:19], v[104:107]
    v_mfma_f32_16x16x32_bf16 v[136:139], v[208:211], v[24:27], v[136:139]
    s_waitcnt lgkmcnt(6)
    v_mfma_f32_16x16x32_bf16 v[76:79], v[212:215], v[4:7], v[76:79]
    v_mfma_f32_16x16x32_bf16 v[108:111], v[212:215], v[12:15], v[108:111]
    v_mfma_f32_16x16x32_bf16 v[140:143], v[212:215], v[20:23], v[140:143]
    s_waitcnt lgkmcnt(4)
    v_mfma_f32_16x16x32_bf16 v[76:79], v[216:219], v[8:11], v[76:79]
    v_mfma_f32_16x16x32_bf16 v[108:111], v[216:219], v[16:19], v[108:111]
    v_mfma_f32_16x16x32_bf16 v[140:143], v[216:219], v[24:27], v[140:143]
    s_waitcnt lgkmcnt(2)
    v_mfma_f32_16x16x32_bf16 v[80:83], v[220:223], v[4:7], v[80:83]
    v_mfma_f32_16x16x32_bf16 v[112:115], v[220:223], v[12:15], v[112:115]
    v_mfma_f32_16x16x32_bf16 v[144:147], v[220:223], v[20:23], v[144:147]
    s_waitcnt lgkmcnt(0)
    v_mfma_f32_16x16x32_bf16 v[80:83], v[224:227], v[8:11], v[80:83]
    v_mfma_f32_16x16x32_bf16 v[112:115], v[224:227], v[16:19], v[112:115]
    v_mfma_f32_16x16x32_bf16 v[144:147], v[224:227], v[24:27], v[144:147]
    s_waitcnt vmcnt(16)
    s_barrier
    buffer_load_dwordx4 v[4:7], v1, s[8:11], s35 offen offset:0
    buffer_load_dwordx4 v[8:11], v1, s[8:11], s35 offen offset:64
    buffer_load_dwordx4 v[12:15], v1, s[8:11], s36 offen offset:0
    buffer_load_dwordx4 v[16:19], v1, s[8:11], s36 offen offset:64
    buffer_load_dwordx4 v[20:23], v1, s[8:11], s37 offen offset:0
    buffer_load_dwordx4 v[24:27], v1, s[8:11], s37 offen offset:64
    s_add_u32 s35, s35, 128
    s_add_u32 s36, s36, 128
    s_add_u32 s37, s37, 128
    ds_read_b64_tr_b16 v[196:197], v232 offset:49152
    ds_read_b64_tr_b16 v[198:199], v232 offset:53248
    ds_read_b64_tr_b16 v[200:201], v232 offset:57344
    ds_read_b64_tr_b16 v[202:203], v232 offset:61440
    ds_read_b64_tr_b16 v[204:205], v233 offset:49152
    ds_read_b64_tr_b16 v[206:207], v233 offset:53248
    ds_read_b64_tr_b16 v[208:209], v233 offset:57344
    ds_read_b64_tr_b16 v[210:211], v233 offset:61440
    ds_read_b64_tr_b16 v[212:213], v234 offset:49152
    ds_read_b64_tr_b16 v[214:215], v234 offset:53248
    s_waitcnt lgkmcnt(8)
    v_mfma_f32_16x16x32_bf16 v[52:55], v[196:199], v[28:31], v[52:55]
    v_mfma_f32_16x16x32_bf16 v[84:87], v[196:199], v[36:39], v[84:87]
    v_mfma_f32_16x16x32_bf16 v[116:119], v[196:199], v[44:47], v[116:119]
    ds_read_b64_tr_b16 v[216:217], v234 offset:57344
    ds_read_b64_tr_b16 v[218:219], v234 offset:61440
    s_waitcnt lgkmcnt(8)
    v_mfma_f32_16x16x32_bf16 v[52:55], v[200:203], v[32:35], v[52:55]
    v_mfma_f32_16x16x32_bf16 v[84:87], v[200:203], v[40:43], v[84:87]
    v_mfma_f32_16x16x32_bf16 v[116:119], v[200:203], v[48:51], v[116:119]
    ds_read_b64_tr_b16 v[220:221], v235 offset:49152
    ds_read_b64_tr_b16 v[222:223], v235 offset:53248
    s_waitcnt lgkmcnt(8)
    v_mfma_f32_16x16x32_bf16 v[56:59], v[204:207], v[28:31], v[56:59]
    v_mfma_f32_16x16x32_bf16 v[88:91], v[204:207], v[36:39], v[88:91]
    v_mfma_f32_16x16x32_bf16 v[120:123], v[204:207], v[44:47], v[120:123]
    ds_read_b64_tr_b16 v[224:225], v235 offset:57344
    ds_read_b64_tr_b16 v[226:227], v235 offset:61440
    s_waitcnt lgkmcnt(8)
    v_mfma_f32_16x16x32_bf16 v[56:59], v[208:211], v[32:35], v[56:59]
    v_mfma_f32_16x16x32_bf16 v[88:91], v[208:211], v[40:43], v[88:91]
    v_mfma_f32_16x16x32_bf16 v[120:123], v[208:211], v[48:51], v[120:123]
    ds_read_b64_tr_b16 v[196:197], v236 offset:49152
    ds_read_b64_tr_b16 v[198:199], v236 offset:53248
    s_waitcnt lgkmcnt(8)
    v_mfma_f32_16x16x32_bf16 v[60:63], v[212:215], v[28:31], v[60:63]
    v_mfma_f32_16x16x32_bf16 v[92:95], v[212:215], v[36:39], v[92:95]
    v_mfma_f32_16x16x32_bf16 v[124:127], v[212:215], v[44:47], v[124:127]
    ds_read_b64_tr_b16 v[200:201], v236 offset:57344
    ds_read_b64_tr_b16 v[202:203], v236 offset:61440
    s_waitcnt lgkmcnt(8)
    v_mfma_f32_16x16x32_bf16 v[60:63], v[216:219], v[32:35], v[60:63]
    v_mfma_f32_16x16x32_bf16 v[92:95], v[216:219], v[40:43], v[92:95]
    v_mfma_f32_16x16x32_bf16 v[124:127], v[216:219], v[48:51], v[124:127]
    ds_read_b64_tr_b16 v[204:205], v237 offset:49152
    ds_read_b64_tr_b16 v[206:207], v237 offset:53248
    s_waitcnt lgkmcnt(8)
    v_mfma_f32_16x16x32_bf16 v[64:67], v[220:223], v[28:31], v[64:67]
    v_mfma_f32_16x16x32_bf16 v[96:99], v[220:223], v[36:39], v[96:99]
    v_mfma_f32_16x16x32_bf16 v[128:131], v[220:223], v[44:47], v[128:131]
    ds_read_b64_tr_b16 v[208:209], v237 offset:57344
    ds_read_b64_tr_b16 v[210:211], v237 offset:61440
    s_waitcnt lgkmcnt(8)
    v_mfma_f32_16x16x32_bf16 v[64:67], v[224:227], v[32:35], v[64:67]
    v_mfma_f32_16x16x32_bf16 v[96:99], v[224:227], v[40:43], v[96:99]
    v_mfma_f32_16x16x32_bf16 v[128:131], v[224:227], v[48:51], v[128:131]
    ds_read_b64_tr_b16 v[212:213], v238 offset:49152
    ds_read_b64_tr_b16 v[214:215], v238 offset:53248
    s_waitcnt lgkmcnt(8)
    v_mfma_f32_16x16x32_bf16 v[68:71], v[196:199], v[28:31], v[68:71]
    v_mfma_f32_16x16x32_bf16 v[100:103], v[196:199], v[36:39], v[100:103]
    v_mfma_f32_16x16x32_bf16 v[132:135], v[196:199], v[44:47], v[132:135]
    ds_read_b64_tr_b16 v[216:217], v238 offset:57344
    ds_read_b64_tr_b16 v[218:219], v238 offset:61440
    s_waitcnt lgkmcnt(8)
    v_mfma_f32_16x16x32_bf16 v[68:71], v[200:203], v[32:35], v[68:71]
    v_mfma_f32_16x16x32_bf16 v[100:103], v[200:203], v[40:43], v[100:103]
    v_mfma_f32_16x16x32_bf16 v[132:135], v[200:203], v[48:51], v[132:135]
    ds_read_b64_tr_b16 v[220:221], v239 offset:49152
    ds_read_b64_tr_b16 v[222:223], v239 offset:53248
    s_waitcnt lgkmcnt(8)
    v_mfma_f32_16x16x32_bf16 v[72:75], v[204:207], v[28:31], v[72:75]
    v_mfma_f32_16x16x32_bf16 v[104:107], v[204:207], v[36:39], v[104:107]
    v_mfma_f32_16x16x32_bf16 v[136:139], v[204:207], v[44:47], v[136:139]
    ds_read_b64_tr_b16 v[224:225], v239 offset:57344
    ds_read_b64_tr_b16 v[226:227], v239 offset:61440
    s_waitcnt lgkmcnt(8)
    v_mfma_f32_16x16x32_bf16 v[72:75], v[208:211], v[32:35], v[72:75]
    v_mfma_f32_16x16x32_bf16 v[104:107], v[208:211], v[40:43], v[104:107]
    v_mfma_f32_16x16x32_bf16 v[136:139], v[208:211], v[48:51], v[136:139]
    s_waitcnt lgkmcnt(6)
    v_mfma_f32_16x16x32_bf16 v[76:79], v[212:215], v[28:31], v[76:79]
    v_mfma_f32_16x16x32_bf16 v[108:111], v[212:215], v[36:39], v[108:111]
    v_mfma_f32_16x16x32_bf16 v[140:143], v[212:215], v[44:47], v[140:143]
    s_waitcnt lgkmcnt(4)
    v_mfma_f32_16x16x32_bf16 v[76:79], v[216:219], v[32:35], v[76:79]
    v_mfma_f32_16x16x32_bf16 v[108:111], v[216:219], v[40:43], v[108:111]
    v_mfma_f32_16x16x32_bf16 v[140:143], v[216:219], v[48:51], v[140:143]
    s_waitcnt lgkmcnt(2)
    v_mfma_f32_16x16x32_bf16 v[80:83], v[220:223], v[28:31], v[80:83]
    v_mfma_f32_16x16x32_bf16 v[112:115], v[220:223], v[36:39], v[112:115]
    v_mfma_f32_16x16x32_bf16 v[144:147], v[220:223], v[44:47], v[144:147]
    s_waitcnt lgkmcnt(0)
    v_mfma_f32_16x16x32_bf16 v[80:83], v[224:227], v[32:35], v[80:83]
    v_mfma_f32_16x16x32_bf16 v[112:115], v[224:227], v[40:43], v[112:115]
    v_mfma_f32_16x16x32_bf16 v[144:147], v[224:227], v[48:51], v[144:147]
    s_waitcnt vmcnt(12)
    s_barrier
    buffer_load_dwordx4 v[28:31], v1, s[8:11], s35 offen offset:0
    buffer_load_dwordx4 v[32:35], v1, s[8:11], s35 offen offset:64
    buffer_load_dwordx4 v[36:39], v1, s[8:11], s36 offen offset:0
    buffer_load_dwordx4 v[40:43], v1, s[8:11], s36 offen offset:64
    buffer_load_dwordx4 v[44:47], v1, s[8:11], s37 offen offset:0
    buffer_load_dwordx4 v[48:51], v1, s[8:11], s37 offen offset:64
    s_add_u32 s35, s35, 128
    s_add_u32 s36, s36, 128
    s_add_u32 s37, s37, 128
    ds_read_b64_tr_b16 v[196:197], v243 offset:0
    ds_read_b64_tr_b16 v[198:199], v243 offset:4096
    ds_read_b64_tr_b16 v[200:201], v243 offset:8192
    ds_read_b64_tr_b16 v[202:203], v243 offset:12288
    ds_read_b64_tr_b16 v[204:205], v244 offset:0
    ds_read_b64_tr_b16 v[206:207], v244 offset:4096
    ds_read_b64_tr_b16 v[208:209], v244 offset:8192
    ds_read_b64_tr_b16 v[210:211], v244 offset:12288
    ds_read_b64_tr_b16 v[212:213], v245 offset:0
    ds_read_b64_tr_b16 v[214:215], v245 offset:4096
    s_waitcnt lgkmcnt(8)
    v_mfma_f32_16x16x32_bf16 v[52:55], v[196:199], v[148:151], v[52:55]
    v_mfma_f32_16x16x32_bf16 v[84:87], v[196:199], v[156:159], v[84:87]
    v_mfma_f32_16x16x32_bf16 v[116:119], v[196:199], v[164:167], v[116:119]
    ds_read_b64_tr_b16 v[216:217], v245 offset:8192
    ds_read_b64_tr_b16 v[218:219], v245 offset:12288
    s_waitcnt lgkmcnt(8)
    v_mfma_f32_16x16x32_bf16 v[52:55], v[200:203], v[152:155], v[52:55]
    v_mfma_f32_16x16x32_bf16 v[84:87], v[200:203], v[160:163], v[84:87]
    v_mfma_f32_16x16x32_bf16 v[116:119], v[200:203], v[168:171], v[116:119]
    ds_read_b64_tr_b16 v[220:221], v246 offset:0
    ds_read_b64_tr_b16 v[222:223], v246 offset:4096
    s_waitcnt lgkmcnt(8)
    v_mfma_f32_16x16x32_bf16 v[56:59], v[204:207], v[148:151], v[56:59]
    v_mfma_f32_16x16x32_bf16 v[88:91], v[204:207], v[156:159], v[88:91]
    v_mfma_f32_16x16x32_bf16 v[120:123], v[204:207], v[164:167], v[120:123]
    ds_read_b64_tr_b16 v[224:225], v246 offset:8192
    ds_read_b64_tr_b16 v[226:227], v246 offset:12288
    s_waitcnt lgkmcnt(8)
    v_mfma_f32_16x16x32_bf16 v[56:59], v[208:211], v[152:155], v[56:59]
    v_mfma_f32_16x16x32_bf16 v[88:91], v[208:211], v[160:163], v[88:91]
    v_mfma_f32_16x16x32_bf16 v[120:123], v[208:211], v[168:171], v[120:123]
    ds_read_b64_tr_b16 v[196:197], v247 offset:0
    ds_read_b64_tr_b16 v[198:199], v247 offset:4096
    s_waitcnt lgkmcnt(8)
    v_mfma_f32_16x16x32_bf16 v[60:63], v[212:215], v[148:151], v[60:63]
    v_mfma_f32_16x16x32_bf16 v[92:95], v[212:215], v[156:159], v[92:95]
    v_mfma_f32_16x16x32_bf16 v[124:127], v[212:215], v[164:167], v[124:127]
    ds_read_b64_tr_b16 v[200:201], v247 offset:8192
    ds_read_b64_tr_b16 v[202:203], v247 offset:12288
    s_waitcnt lgkmcnt(8)
    v_mfma_f32_16x16x32_bf16 v[60:63], v[216:219], v[152:155], v[60:63]
    v_mfma_f32_16x16x32_bf16 v[92:95], v[216:219], v[160:163], v[92:95]
    v_mfma_f32_16x16x32_bf16 v[124:127], v[216:219], v[168:171], v[124:127]
    ds_read_b64_tr_b16 v[204:205], v248 offset:0
    ds_read_b64_tr_b16 v[206:207], v248 offset:4096
    s_waitcnt lgkmcnt(8)
    v_mfma_f32_16x16x32_bf16 v[64:67], v[220:223], v[148:151], v[64:67]
    v_mfma_f32_16x16x32_bf16 v[96:99], v[220:223], v[156:159], v[96:99]
    v_mfma_f32_16x16x32_bf16 v[128:131], v[220:223], v[164:167], v[128:131]
    ds_read_b64_tr_b16 v[208:209], v248 offset:8192
    ds_read_b64_tr_b16 v[210:211], v248 offset:12288
    s_waitcnt lgkmcnt(8)
    v_mfma_f32_16x16x32_bf16 v[64:67], v[224:227], v[152:155], v[64:67]
    v_mfma_f32_16x16x32_bf16 v[96:99], v[224:227], v[160:163], v[96:99]
    v_mfma_f32_16x16x32_bf16 v[128:131], v[224:227], v[168:171], v[128:131]
    ds_read_b64_tr_b16 v[212:213], v249 offset:0
    ds_read_b64_tr_b16 v[214:215], v249 offset:4096
    s_waitcnt lgkmcnt(8)
    v_mfma_f32_16x16x32_bf16 v[68:71], v[196:199], v[148:151], v[68:71]
    v_mfma_f32_16x16x32_bf16 v[100:103], v[196:199], v[156:159], v[100:103]
    v_mfma_f32_16x16x32_bf16 v[132:135], v[196:199], v[164:167], v[132:135]
    ds_read_b64_tr_b16 v[216:217], v249 offset:8192
    ds_read_b64_tr_b16 v[218:219], v249 offset:12288
    s_waitcnt lgkmcnt(8)
    v_mfma_f32_16x16x32_bf16 v[68:71], v[200:203], v[152:155], v[68:71]
    v_mfma_f32_16x16x32_bf16 v[100:103], v[200:203], v[160:163], v[100:103]
    v_mfma_f32_16x16x32_bf16 v[132:135], v[200:203], v[168:171], v[132:135]
    ds_read_b64_tr_b16 v[220:221], v250 offset:0
    ds_read_b64_tr_b16 v[222:223], v250 offset:4096
    s_waitcnt lgkmcnt(8)
    v_mfma_f32_16x16x32_bf16 v[72:75], v[204:207], v[148:151], v[72:75]
    v_mfma_f32_16x16x32_bf16 v[104:107], v[204:207], v[156:159], v[104:107]
    v_mfma_f32_16x16x32_bf16 v[136:139], v[204:207], v[164:167], v[136:139]
    ds_read_b64_tr_b16 v[224:225], v250 offset:8192
    ds_read_b64_tr_b16 v[226:227], v250 offset:12288
    s_waitcnt lgkmcnt(8)
    v_mfma_f32_16x16x32_bf16 v[72:75], v[208:211], v[152:155], v[72:75]
    v_mfma_f32_16x16x32_bf16 v[104:107], v[208:211], v[160:163], v[104:107]
    v_mfma_f32_16x16x32_bf16 v[136:139], v[208:211], v[168:171], v[136:139]
    s_waitcnt lgkmcnt(6)
    v_mfma_f32_16x16x32_bf16 v[76:79], v[212:215], v[148:151], v[76:79]
    v_mfma_f32_16x16x32_bf16 v[108:111], v[212:215], v[156:159], v[108:111]
    v_mfma_f32_16x16x32_bf16 v[140:143], v[212:215], v[164:167], v[140:143]
    s_waitcnt lgkmcnt(4)
    v_mfma_f32_16x16x32_bf16 v[76:79], v[216:219], v[152:155], v[76:79]
    v_mfma_f32_16x16x32_bf16 v[108:111], v[216:219], v[160:163], v[108:111]
    v_mfma_f32_16x16x32_bf16 v[140:143], v[216:219], v[168:171], v[140:143]
    s_waitcnt lgkmcnt(2)
    v_mfma_f32_16x16x32_bf16 v[80:83], v[220:223], v[148:151], v[80:83]
    v_mfma_f32_16x16x32_bf16 v[112:115], v[220:223], v[156:159], v[112:115]
    v_mfma_f32_16x16x32_bf16 v[144:147], v[220:223], v[164:167], v[144:147]
    s_waitcnt lgkmcnt(0)
    v_mfma_f32_16x16x32_bf16 v[80:83], v[224:227], v[152:155], v[80:83]
    v_mfma_f32_16x16x32_bf16 v[112:115], v[224:227], v[160:163], v[112:115]
    v_mfma_f32_16x16x32_bf16 v[144:147], v[224:227], v[168:171], v[144:147]
    s_waitcnt vmcnt(12)
    s_barrier
    ds_read_b64_tr_b16 v[196:197], v243 offset:16384
    ds_read_b64_tr_b16 v[198:199], v243 offset:20480
    ds_read_b64_tr_b16 v[200:201], v243 offset:24576
    ds_read_b64_tr_b16 v[202:203], v243 offset:28672
    ds_read_b64_tr_b16 v[204:205], v244 offset:16384
    ds_read_b64_tr_b16 v[206:207], v244 offset:20480
    ds_read_b64_tr_b16 v[208:209], v244 offset:24576
    ds_read_b64_tr_b16 v[210:211], v244 offset:28672
    ds_read_b64_tr_b16 v[212:213], v245 offset:16384
    ds_read_b64_tr_b16 v[214:215], v245 offset:20480
    s_waitcnt lgkmcnt(8)
    v_mfma_f32_16x16x32_bf16 v[52:55], v[196:199], v[172:175], v[52:55]
    v_mfma_f32_16x16x32_bf16 v[84:87], v[196:199], v[180:183], v[84:87]
    v_mfma_f32_16x16x32_bf16 v[116:119], v[196:199], v[188:191], v[116:119]
    ds_read_b64_tr_b16 v[216:217], v245 offset:24576
    ds_read_b64_tr_b16 v[218:219], v245 offset:28672
    s_waitcnt lgkmcnt(8)
    v_mfma_f32_16x16x32_bf16 v[52:55], v[200:203], v[176:179], v[52:55]
    v_mfma_f32_16x16x32_bf16 v[84:87], v[200:203], v[184:187], v[84:87]
    v_mfma_f32_16x16x32_bf16 v[116:119], v[200:203], v[192:195], v[116:119]
    ds_read_b64_tr_b16 v[220:221], v246 offset:16384
    ds_read_b64_tr_b16 v[222:223], v246 offset:20480
    s_waitcnt lgkmcnt(8)
    v_mfma_f32_16x16x32_bf16 v[56:59], v[204:207], v[172:175], v[56:59]
    v_mfma_f32_16x16x32_bf16 v[88:91], v[204:207], v[180:183], v[88:91]
    v_mfma_f32_16x16x32_bf16 v[120:123], v[204:207], v[188:191], v[120:123]
    ds_read_b64_tr_b16 v[224:225], v246 offset:24576
    ds_read_b64_tr_b16 v[226:227], v246 offset:28672
    s_waitcnt lgkmcnt(8)
    v_mfma_f32_16x16x32_bf16 v[56:59], v[208:211], v[176:179], v[56:59]
    v_mfma_f32_16x16x32_bf16 v[88:91], v[208:211], v[184:187], v[88:91]
    v_mfma_f32_16x16x32_bf16 v[120:123], v[208:211], v[192:195], v[120:123]
    ds_read_b64_tr_b16 v[196:197], v247 offset:16384
    ds_read_b64_tr_b16 v[198:199], v247 offset:20480
    s_waitcnt lgkmcnt(8)
    v_mfma_f32_16x16x32_bf16 v[60:63], v[212:215], v[172:175], v[60:63]
    v_mfma_f32_16x16x32_bf16 v[92:95], v[212:215], v[180:183], v[92:95]
    v_mfma_f32_16x16x32_bf16 v[124:127], v[212:215], v[188:191], v[124:127]
    ds_read_b64_tr_b16 v[200:201], v247 offset:24576
    ds_read_b64_tr_b16 v[202:203], v247 offset:28672
    s_waitcnt lgkmcnt(8)
    v_mfma_f32_16x16x32_bf16 v[60:63], v[216:219], v[176:179], v[60:63]
    v_mfma_f32_16x16x32_bf16 v[92:95], v[216:219], v[184:187], v[92:95]
    v_mfma_f32_16x16x32_bf16 v[124:127], v[216:219], v[192:195], v[124:127]
    ds_read_b64_tr_b16 v[204:205], v248 offset:16384
    ds_read_b64_tr_b16 v[206:207], v248 offset:20480
    s_waitcnt lgkmcnt(8)
    v_mfma_f32_16x16x32_bf16 v[64:67], v[220:223], v[172:175], v[64:67]
    v_mfma_f32_16x16x32_bf16 v[96:99], v[220:223], v[180:183], v[96:99]
    v_mfma_f32_16x16x32_bf16 v[128:131], v[220:223], v[188:191], v[128:131]
    ds_read_b64_tr_b16 v[208:209], v248 offset:24576
    ds_read_b64_tr_b16 v[210:211], v248 offset:28672
    s_waitcnt lgkmcnt(8)
    v_mfma_f32_16x16x32_bf16 v[64:67], v[224:227], v[176:179], v[64:67]
    v_mfma_f32_16x16x32_bf16 v[96:99], v[224:227], v[184:187], v[96:99]
    v_mfma_f32_16x16x32_bf16 v[128:131], v[224:227], v[192:195], v[128:131]
    ds_read_b64_tr_b16 v[212:213], v249 offset:16384
    ds_read_b64_tr_b16 v[214:215], v249 offset:20480
    s_waitcnt lgkmcnt(8)
    v_mfma_f32_16x16x32_bf16 v[68:71], v[196:199], v[172:175], v[68:71]
    v_mfma_f32_16x16x32_bf16 v[100:103], v[196:199], v[180:183], v[100:103]
    v_mfma_f32_16x16x32_bf16 v[132:135], v[196:199], v[188:191], v[132:135]
    ds_read_b64_tr_b16 v[216:217], v249 offset:24576
    ds_read_b64_tr_b16 v[218:219], v249 offset:28672
    s_waitcnt lgkmcnt(8)
    v_mfma_f32_16x16x32_bf16 v[68:71], v[200:203], v[176:179], v[68:71]
    v_mfma_f32_16x16x32_bf16 v[100:103], v[200:203], v[184:187], v[100:103]
    v_mfma_f32_16x16x32_bf16 v[132:135], v[200:203], v[192:195], v[132:135]
    ds_read_b64_tr_b16 v[220:221], v250 offset:16384
    ds_read_b64_tr_b16 v[222:223], v250 offset:20480
    s_waitcnt lgkmcnt(8)
    v_mfma_f32_16x16x32_bf16 v[72:75], v[204:207], v[172:175], v[72:75]
    v_mfma_f32_16x16x32_bf16 v[104:107], v[204:207], v[180:183], v[104:107]
    v_mfma_f32_16x16x32_bf16 v[136:139], v[204:207], v[188:191], v[136:139]
    ds_read_b64_tr_b16 v[224:225], v250 offset:24576
    ds_read_b64_tr_b16 v[226:227], v250 offset:28672
    s_waitcnt lgkmcnt(8)
    v_mfma_f32_16x16x32_bf16 v[72:75], v[208:211], v[176:179], v[72:75]
    v_mfma_f32_16x16x32_bf16 v[104:107], v[208:211], v[184:187], v[104:107]
    v_mfma_f32_16x16x32_bf16 v[136:139], v[208:211], v[192:195], v[136:139]
    s_waitcnt lgkmcnt(6)
    v_mfma_f32_16x16x32_bf16 v[76:79], v[212:215], v[172:175], v[76:79]
    v_mfma_f32_16x16x32_bf16 v[108:111], v[212:215], v[180:183], v[108:111]
    v_mfma_f32_16x16x32_bf16 v[140:143], v[212:215], v[188:191], v[140:143]
    s_waitcnt lgkmcnt(4)
    v_mfma_f32_16x16x32_bf16 v[76:79], v[216:219], v[176:179], v[76:79]
    v_mfma_f32_16x16x32_bf16 v[108:111], v[216:219], v[184:187], v[108:111]
    v_mfma_f32_16x16x32_bf16 v[140:143], v[216:219], v[192:195], v[140:143]
    s_waitcnt lgkmcnt(2)
    v_mfma_f32_16x16x32_bf16 v[80:83], v[220:223], v[172:175], v[80:83]
    v_mfma_f32_16x16x32_bf16 v[112:115], v[220:223], v[180:183], v[112:115]
    v_mfma_f32_16x16x32_bf16 v[144:147], v[220:223], v[188:191], v[144:147]
    s_waitcnt lgkmcnt(0)
    v_mfma_f32_16x16x32_bf16 v[80:83], v[224:227], v[176:179], v[80:83]
    v_mfma_f32_16x16x32_bf16 v[112:115], v[224:227], v[184:187], v[112:115]
    v_mfma_f32_16x16x32_bf16 v[144:147], v[224:227], v[192:195], v[144:147]
    s_waitcnt vmcnt(6)
    s_barrier
    ds_read_b64_tr_b16 v[196:197], v243 offset:32768
    ds_read_b64_tr_b16 v[198:199], v243 offset:36864
    ds_read_b64_tr_b16 v[200:201], v243 offset:40960
    ds_read_b64_tr_b16 v[202:203], v243 offset:45056
    ds_read_b64_tr_b16 v[204:205], v244 offset:32768
    ds_read_b64_tr_b16 v[206:207], v244 offset:36864
    ds_read_b64_tr_b16 v[208:209], v244 offset:40960
    ds_read_b64_tr_b16 v[210:211], v244 offset:45056
    ds_read_b64_tr_b16 v[212:213], v245 offset:32768
    ds_read_b64_tr_b16 v[214:215], v245 offset:36864
    s_waitcnt lgkmcnt(8)
    v_mfma_f32_16x16x32_bf16 v[52:55], v[196:199], v[4:7], v[52:55]
    v_mfma_f32_16x16x32_bf16 v[84:87], v[196:199], v[12:15], v[84:87]
    v_mfma_f32_16x16x32_bf16 v[116:119], v[196:199], v[20:23], v[116:119]
    ds_read_b64_tr_b16 v[216:217], v245 offset:40960
    ds_read_b64_tr_b16 v[218:219], v245 offset:45056
    s_waitcnt lgkmcnt(8)
    v_mfma_f32_16x16x32_bf16 v[52:55], v[200:203], v[8:11], v[52:55]
    v_mfma_f32_16x16x32_bf16 v[84:87], v[200:203], v[16:19], v[84:87]
    v_mfma_f32_16x16x32_bf16 v[116:119], v[200:203], v[24:27], v[116:119]
    ds_read_b64_tr_b16 v[220:221], v246 offset:32768
    ds_read_b64_tr_b16 v[222:223], v246 offset:36864
    s_waitcnt lgkmcnt(8)
    v_mfma_f32_16x16x32_bf16 v[56:59], v[204:207], v[4:7], v[56:59]
    v_mfma_f32_16x16x32_bf16 v[88:91], v[204:207], v[12:15], v[88:91]
    v_mfma_f32_16x16x32_bf16 v[120:123], v[204:207], v[20:23], v[120:123]
    ds_read_b64_tr_b16 v[224:225], v246 offset:40960
    ds_read_b64_tr_b16 v[226:227], v246 offset:45056
    s_waitcnt lgkmcnt(8)
    v_mfma_f32_16x16x32_bf16 v[56:59], v[208:211], v[8:11], v[56:59]
    v_mfma_f32_16x16x32_bf16 v[88:91], v[208:211], v[16:19], v[88:91]
    v_mfma_f32_16x16x32_bf16 v[120:123], v[208:211], v[24:27], v[120:123]
    ds_read_b64_tr_b16 v[196:197], v247 offset:32768
    ds_read_b64_tr_b16 v[198:199], v247 offset:36864
    s_waitcnt lgkmcnt(8)
    v_mfma_f32_16x16x32_bf16 v[60:63], v[212:215], v[4:7], v[60:63]
    v_mfma_f32_16x16x32_bf16 v[92:95], v[212:215], v[12:15], v[92:95]
    v_mfma_f32_16x16x32_bf16 v[124:127], v[212:215], v[20:23], v[124:127]
    ds_read_b64_tr_b16 v[200:201], v247 offset:40960
    ds_read_b64_tr_b16 v[202:203], v247 offset:45056
    s_waitcnt lgkmcnt(8)
    v_mfma_f32_16x16x32_bf16 v[60:63], v[216:219], v[8:11], v[60:63]
    v_mfma_f32_16x16x32_bf16 v[92:95], v[216:219], v[16:19], v[92:95]
    v_mfma_f32_16x16x32_bf16 v[124:127], v[216:219], v[24:27], v[124:127]
    ds_read_b64_tr_b16 v[204:205], v248 offset:32768
    ds_read_b64_tr_b16 v[206:207], v248 offset:36864
    s_waitcnt lgkmcnt(8)
    v_mfma_f32_16x16x32_bf16 v[64:67], v[220:223], v[4:7], v[64:67]
    v_mfma_f32_16x16x32_bf16 v[96:99], v[220:223], v[12:15], v[96:99]
    v_mfma_f32_16x16x32_bf16 v[128:131], v[220:223], v[20:23], v[128:131]
    ds_read_b64_tr_b16 v[208:209], v248 offset:40960
    ds_read_b64_tr_b16 v[210:211], v248 offset:45056
    s_waitcnt lgkmcnt(8)
    v_mfma_f32_16x16x32_bf16 v[64:67], v[224:227], v[8:11], v[64:67]
    v_mfma_f32_16x16x32_bf16 v[96:99], v[224:227], v[16:19], v[96:99]
    v_mfma_f32_16x16x32_bf16 v[128:131], v[224:227], v[24:27], v[128:131]
    ds_read_b64_tr_b16 v[212:213], v249 offset:32768
    ds_read_b64_tr_b16 v[214:215], v249 offset:36864
    s_waitcnt lgkmcnt(8)
    v_mfma_f32_16x16x32_bf16 v[68:71], v[196:199], v[4:7], v[68:71]
    v_mfma_f32_16x16x32_bf16 v[100:103], v[196:199], v[12:15], v[100:103]
    v_mfma_f32_16x16x32_bf16 v[132:135], v[196:199], v[20:23], v[132:135]
    ds_read_b64_tr_b16 v[216:217], v249 offset:40960
    ds_read_b64_tr_b16 v[218:219], v249 offset:45056
    s_waitcnt lgkmcnt(8)
    v_mfma_f32_16x16x32_bf16 v[68:71], v[200:203], v[8:11], v[68:71]
    v_mfma_f32_16x16x32_bf16 v[100:103], v[200:203], v[16:19], v[100:103]
    v_mfma_f32_16x16x32_bf16 v[132:135], v[200:203], v[24:27], v[132:135]
    ds_read_b64_tr_b16 v[220:221], v250 offset:32768
    ds_read_b64_tr_b16 v[222:223], v250 offset:36864
    s_waitcnt lgkmcnt(8)
    v_mfma_f32_16x16x32_bf16 v[72:75], v[204:207], v[4:7], v[72:75]
    v_mfma_f32_16x16x32_bf16 v[104:107], v[204:207], v[12:15], v[104:107]
    v_mfma_f32_16x16x32_bf16 v[136:139], v[204:207], v[20:23], v[136:139]
    ds_read_b64_tr_b16 v[224:225], v250 offset:40960
    ds_read_b64_tr_b16 v[226:227], v250 offset:45056
    s_waitcnt lgkmcnt(8)
    v_mfma_f32_16x16x32_bf16 v[72:75], v[208:211], v[8:11], v[72:75]
    v_mfma_f32_16x16x32_bf16 v[104:107], v[208:211], v[16:19], v[104:107]
    v_mfma_f32_16x16x32_bf16 v[136:139], v[208:211], v[24:27], v[136:139]
    s_waitcnt lgkmcnt(6)
    v_mfma_f32_16x16x32_bf16 v[76:79], v[212:215], v[4:7], v[76:79]
    v_mfma_f32_16x16x32_bf16 v[108:111], v[212:215], v[12:15], v[108:111]
    v_mfma_f32_16x16x32_bf16 v[140:143], v[212:215], v[20:23], v[140:143]
    s_waitcnt lgkmcnt(4)
    v_mfma_f32_16x16x32_bf16 v[76:79], v[216:219], v[8:11], v[76:79]
    v_mfma_f32_16x16x32_bf16 v[108:111], v[216:219], v[16:19], v[108:111]
    v_mfma_f32_16x16x32_bf16 v[140:143], v[216:219], v[24:27], v[140:143]
    s_waitcnt lgkmcnt(2)
    v_mfma_f32_16x16x32_bf16 v[80:83], v[220:223], v[4:7], v[80:83]
    v_mfma_f32_16x16x32_bf16 v[112:115], v[220:223], v[12:15], v[112:115]
    v_mfma_f32_16x16x32_bf16 v[144:147], v[220:223], v[20:23], v[144:147]
    s_waitcnt lgkmcnt(0)
    v_mfma_f32_16x16x32_bf16 v[80:83], v[224:227], v[8:11], v[80:83]
    v_mfma_f32_16x16x32_bf16 v[112:115], v[224:227], v[16:19], v[112:115]
    v_mfma_f32_16x16x32_bf16 v[144:147], v[224:227], v[24:27], v[144:147]
    s_waitcnt vmcnt(0)
    s_barrier
    ds_read_b64_tr_b16 v[196:197], v243 offset:49152
    ds_read_b64_tr_b16 v[198:199], v243 offset:53248
    ds_read_b64_tr_b16 v[200:201], v243 offset:57344
    ds_read_b64_tr_b16 v[202:203], v243 offset:61440
    ds_read_b64_tr_b16 v[204:205], v244 offset:49152
    ds_read_b64_tr_b16 v[206:207], v244 offset:53248
    ds_read_b64_tr_b16 v[208:209], v244 offset:57344
    ds_read_b64_tr_b16 v[210:211], v244 offset:61440
    ds_read_b64_tr_b16 v[212:213], v245 offset:49152
    ds_read_b64_tr_b16 v[214:215], v245 offset:53248
    s_waitcnt lgkmcnt(8)
    v_mfma_f32_16x16x32_bf16 v[52:55], v[196:199], v[28:31], v[52:55]
    v_mfma_f32_16x16x32_bf16 v[84:87], v[196:199], v[36:39], v[84:87]
    v_mfma_f32_16x16x32_bf16 v[116:119], v[196:199], v[44:47], v[116:119]
    ds_read_b64_tr_b16 v[216:217], v245 offset:57344
    ds_read_b64_tr_b16 v[218:219], v245 offset:61440
    s_waitcnt lgkmcnt(8)
    v_mfma_f32_16x16x32_bf16 v[52:55], v[200:203], v[32:35], v[52:55]
    v_mfma_f32_16x16x32_bf16 v[84:87], v[200:203], v[40:43], v[84:87]
    v_mfma_f32_16x16x32_bf16 v[116:119], v[200:203], v[48:51], v[116:119]
    ds_read_b64_tr_b16 v[220:221], v246 offset:49152
    ds_read_b64_tr_b16 v[222:223], v246 offset:53248
    s_waitcnt lgkmcnt(8)
    v_mfma_f32_16x16x32_bf16 v[56:59], v[204:207], v[28:31], v[56:59]
    v_mfma_f32_16x16x32_bf16 v[88:91], v[204:207], v[36:39], v[88:91]
    v_mfma_f32_16x16x32_bf16 v[120:123], v[204:207], v[44:47], v[120:123]
    ds_read_b64_tr_b16 v[224:225], v246 offset:57344
    ds_read_b64_tr_b16 v[226:227], v246 offset:61440
    s_waitcnt lgkmcnt(8)
    v_mfma_f32_16x16x32_bf16 v[56:59], v[208:211], v[32:35], v[56:59]
    v_mfma_f32_16x16x32_bf16 v[88:91], v[208:211], v[40:43], v[88:91]
    v_mfma_f32_16x16x32_bf16 v[120:123], v[208:211], v[48:51], v[120:123]
    ds_read_b64_tr_b16 v[196:197], v247 offset:49152
    ds_read_b64_tr_b16 v[198:199], v247 offset:53248
    s_waitcnt lgkmcnt(8)
    v_mfma_f32_16x16x32_bf16 v[60:63], v[212:215], v[28:31], v[60:63]
    v_mfma_f32_16x16x32_bf16 v[92:95], v[212:215], v[36:39], v[92:95]
    v_mfma_f32_16x16x32_bf16 v[124:127], v[212:215], v[44:47], v[124:127]
    ds_read_b64_tr_b16 v[200:201], v247 offset:57344
    ds_read_b64_tr_b16 v[202:203], v247 offset:61440
    s_waitcnt lgkmcnt(8)
    v_mfma_f32_16x16x32_bf16 v[60:63], v[216:219], v[32:35], v[60:63]
    v_mfma_f32_16x16x32_bf16 v[92:95], v[216:219], v[40:43], v[92:95]
    v_mfma_f32_16x16x32_bf16 v[124:127], v[216:219], v[48:51], v[124:127]
    ds_read_b64_tr_b16 v[204:205], v248 offset:49152
    ds_read_b64_tr_b16 v[206:207], v248 offset:53248
    s_waitcnt lgkmcnt(8)
    v_mfma_f32_16x16x32_bf16 v[64:67], v[220:223], v[28:31], v[64:67]
    v_mfma_f32_16x16x32_bf16 v[96:99], v[220:223], v[36:39], v[96:99]
    v_mfma_f32_16x16x32_bf16 v[128:131], v[220:223], v[44:47], v[128:131]
    ds_read_b64_tr_b16 v[208:209], v248 offset:57344
    ds_read_b64_tr_b16 v[210:211], v248 offset:61440
    s_waitcnt lgkmcnt(8)
    v_mfma_f32_16x16x32_bf16 v[64:67], v[224:227], v[32:35], v[64:67]
    v_mfma_f32_16x16x32_bf16 v[96:99], v[224:227], v[40:43], v[96:99]
    v_mfma_f32_16x16x32_bf16 v[128:131], v[224:227], v[48:51], v[128:131]
    ds_read_b64_tr_b16 v[212:213], v249 offset:49152
    ds_read_b64_tr_b16 v[214:215], v249 offset:53248
    s_waitcnt lgkmcnt(8)
    v_mfma_f32_16x16x32_bf16 v[68:71], v[196:199], v[28:31], v[68:71]
    v_mfma_f32_16x16x32_bf16 v[100:103], v[196:199], v[36:39], v[100:103]
    v_mfma_f32_16x16x32_bf16 v[132:135], v[196:199], v[44:47], v[132:135]
    ds_read_b64_tr_b16 v[216:217], v249 offset:57344
    ds_read_b64_tr_b16 v[218:219], v249 offset:61440
    s_waitcnt lgkmcnt(8)
    v_mfma_f32_16x16x32_bf16 v[68:71], v[200:203], v[32:35], v[68:71]
    v_mfma_f32_16x16x32_bf16 v[100:103], v[200:203], v[40:43], v[100:103]
    v_mfma_f32_16x16x32_bf16 v[132:135], v[200:203], v[48:51], v[132:135]
    ds_read_b64_tr_b16 v[220:221], v250 offset:49152
    ds_read_b64_tr_b16 v[222:223], v250 offset:53248
    s_waitcnt lgkmcnt(8)
    v_mfma_f32_16x16x32_bf16 v[72:75], v[204:207], v[28:31], v[72:75]
    v_mfma_f32_16x16x32_bf16 v[104:107], v[204:207], v[36:39], v[104:107]
    v_mfma_f32_16x16x32_bf16 v[136:139], v[204:207], v[44:47], v[136:139]
    ds_read_b64_tr_b16 v[224:225], v250 offset:57344
    ds_read_b64_tr_b16 v[226:227], v250 offset:61440
    s_waitcnt lgkmcnt(8)
    v_mfma_f32_16x16x32_bf16 v[72:75], v[208:211], v[32:35], v[72:75]
    v_mfma_f32_16x16x32_bf16 v[104:107], v[208:211], v[40:43], v[104:107]
    v_mfma_f32_16x16x32_bf16 v[136:139], v[208:211], v[48:51], v[136:139]
    s_waitcnt lgkmcnt(6)
    v_mfma_f32_16x16x32_bf16 v[76:79], v[212:215], v[28:31], v[76:79]
    v_mfma_f32_16x16x32_bf16 v[108:111], v[212:215], v[36:39], v[108:111]
    v_mfma_f32_16x16x32_bf16 v[140:143], v[212:215], v[44:47], v[140:143]
    s_waitcnt lgkmcnt(4)
    v_mfma_f32_16x16x32_bf16 v[76:79], v[216:219], v[32:35], v[76:79]
    v_mfma_f32_16x16x32_bf16 v[108:111], v[216:219], v[40:43], v[108:111]
    v_mfma_f32_16x16x32_bf16 v[140:143], v[216:219], v[48:51], v[140:143]
    s_waitcnt lgkmcnt(2)
    v_mfma_f32_16x16x32_bf16 v[80:83], v[220:223], v[28:31], v[80:83]
    v_mfma_f32_16x16x32_bf16 v[112:115], v[220:223], v[36:39], v[112:115]
    v_mfma_f32_16x16x32_bf16 v[144:147], v[220:223], v[44:47], v[144:147]
    s_waitcnt lgkmcnt(0)
    v_mfma_f32_16x16x32_bf16 v[80:83], v[224:227], v[32:35], v[80:83]
    v_mfma_f32_16x16x32_bf16 v[112:115], v[224:227], v[40:43], v[112:115]
    v_mfma_f32_16x16x32_bf16 v[144:147], v[224:227], v[48:51], v[144:147]
    s_mov_b32 s39, 0
    buffer_store_dwordx4 v[52:55], v2, s[24:27], s39 offen offset:0
    buffer_store_dwordx4 v[56:59], v2, s[24:27], s39 offen offset:64
    buffer_store_dwordx4 v[60:63], v2, s[24:27], s39 offen offset:128
    buffer_store_dwordx4 v[64:67], v2, s[24:27], s39 offen offset:192
    buffer_store_dwordx4 v[68:71], v2, s[24:27], s39 offen offset:256
    buffer_store_dwordx4 v[72:75], v2, s[24:27], s39 offen offset:320
    buffer_store_dwordx4 v[76:79], v2, s[24:27], s39 offen offset:384
    buffer_store_dwordx4 v[80:83], v2, s[24:27], s39 offen offset:448
    s_mov_b32 s39, 65536
    buffer_store_dwordx4 v[84:87], v2, s[24:27], s39 offen offset:0
    buffer_store_dwordx4 v[88:91], v2, s[24:27], s39 offen offset:64
    buffer_store_dwordx4 v[92:95], v2, s[24:27], s39 offen offset:128
    buffer_store_dwordx4 v[96:99], v2, s[24:27], s39 offen offset:192
    buffer_store_dwordx4 v[100:103], v2, s[24:27], s39 offen offset:256
    buffer_store_dwordx4 v[104:107], v2, s[24:27], s39 offen offset:320
    buffer_store_dwordx4 v[108:111], v2, s[24:27], s39 offen offset:384
    buffer_store_dwordx4 v[112:115], v2, s[24:27], s39 offen offset:448
    s_mov_b32 s39, 131072
    buffer_store_dwordx4 v[116:119], v2, s[24:27], s39 offen offset:0
    buffer_store_dwordx4 v[120:123], v2, s[24:27], s39 offen offset:64
    buffer_store_dwordx4 v[124:127], v2, s[24:27], s39 offen offset:128
    buffer_store_dwordx4 v[128:131], v2, s[24:27], s39 offen offset:192
    buffer_store_dwordx4 v[132:135], v2, s[24:27], s39 offen offset:256
    buffer_store_dwordx4 v[136:139], v2, s[24:27], s39 offen offset:320
    buffer_store_dwordx4 v[140:143], v2, s[24:27], s39 offen offset:384
    buffer_store_dwordx4 v[144:147], v2, s[24:27], s39 offen offset:448
L_op_done:
    s_endpgm
.globl reduce_kernel
.p2align 8
.type reduce_kernel,@function
reduce_kernel:
    s_cmp_ge_u32 s2, 768
    s_cbranch_scc1 L_red_done
    s_load_dwordx2 s[4:5], s[0:1], 96
    s_load_dwordx2 s[6:7], s[0:1], 80
    s_lshl_b32 s3, s2, 8
    v_add_u32 v1, s3, v0
    v_lshlrev_b32 v2, 5, v1
    v_lshlrev_b32 v3, 4, v1
    s_waitcnt lgkmcnt(0)
    s_add_u32 s8, s4, 25165824
    s_addc_u32 s9, s5, 0
    s_and_b32 s9, s9, 0xffff
    s_mov_b32 s10, 25165824
    s_mov_b32 s11, 0x00020000
    s_and_b32 s7, s7, 0xffff
    s_mov_b32 s12, s6
    s_mov_b32 s13, s7
    s_mov_b32 s14, 3145728
    s_mov_b32 s15, 0x00020000
    s_mov_b32 s16, 0
    buffer_load_dwordx4 v[8:11], v2, s[8:11], s16 offen
    buffer_load_dwordx4 v[12:15], v2, s[8:11], s16 offen offset:16
    s_mov_b32 s16, 6291456
    buffer_load_dwordx4 v[16:19], v2, s[8:11], s16 offen
    buffer_load_dwordx4 v[20:23], v2, s[8:11], s16 offen offset:16
    s_mov_b32 s16, 12582912
    buffer_load_dwordx4 v[24:27], v2, s[8:11], s16 offen
    buffer_load_dwordx4 v[28:31], v2, s[8:11], s16 offen offset:16
    s_mov_b32 s16, 18874368
    buffer_load_dwordx4 v[32:35], v2, s[8:11], s16 offen
    buffer_load_dwordx4 v[36:39], v2, s[8:11], s16 offen offset:16
    s_waitcnt vmcnt(0)
    v_add_f32 v8, v8, v16
    v_add_f32 v24, v24, v32
    v_add_f32 v9, v9, v17
    v_add_f32 v25, v25, v33
    v_add_f32 v10, v10, v18
    v_add_f32 v26, v26, v34
    v_add_f32 v11, v11, v19
    v_add_f32 v27, v27, v35
    v_add_f32 v12, v12, v20
    v_add_f32 v28, v28, v36
    v_add_f32 v13, v13, v21
    v_add_f32 v29, v29, v37
    v_add_f32 v14, v14, v22
    v_add_f32 v30, v30, v38
    v_add_f32 v15, v15, v23
    v_add_f32 v31, v31, v39
    v_add_f32 v8, v8, v24
    v_add_f32 v9, v9, v25
    v_add_f32 v10, v10, v26
    v_add_f32 v11, v11, v27
    v_add_f32 v12, v12, v28
    v_add_f32 v13, v13, v29
    v_add_f32 v14, v14, v30
    v_add_f32 v15, v15, v31
    v_cvt_pk_bf16_f32 v4, v8, v9
    v_cvt_pk_bf16_f32 v5, v10, v11
    v_cvt_pk_bf16_f32 v6, v12, v13
    v_cvt_pk_bf16_f32 v7, v14, v15
    buffer_store_dwordx4 v[4:7], v3, s[12:15], 0 offen
L_red_done:
    s_endpgm
.section .rodata,"a"
.p2align 6
.amdhsa_kernel concat_heads__mha_block_cached__gqa_block_cached__near_ridge_kernel
  .amdhsa_next_free_vgpr 256
  .amdhsa_next_free_sgpr 64
  .amdhsa_accum_offset 256
  .amdhsa_group_segment_fixed_size 0
  .amdhsa_kernarg_size 104
  .amdhsa_user_sgpr_count 2
  .amdhsa_user_sgpr_kernarg_segment_ptr 1
  .amdhsa_system_sgpr_workgroup_id_x 1
.end_amdhsa_kernel
.p2align 6
.amdhsa_kernel oproj_kernel
  .amdhsa_next_free_vgpr 256
  .amdhsa_next_free_sgpr 64
  .amdhsa_accum_offset 256
  .amdhsa_group_segment_fixed_size 0
  .amdhsa_kernarg_size 104
  .amdhsa_user_sgpr_count 2
  .amdhsa_user_sgpr_kernarg_segment_ptr 1
  .amdhsa_system_sgpr_workgroup_id_x 1
.end_amdhsa_kernel
.p2align 6
.amdhsa_kernel reduce_kernel
  .amdhsa_next_free_vgpr 64
  .amdhsa_next_free_sgpr 64
  .amdhsa_accum_offset 64
  .amdhsa_group_segment_fixed_size 0
  .amdhsa_kernarg_size 104
  .amdhsa_user_sgpr_count 2
  .amdhsa_user_sgpr_kernarg_segment_ptr 1
  .amdhsa_system_sgpr_workgroup_id_x 1
.end_amdhsa_kernel
```
